```python
import torch

def _softmax(x, axis=-1):
    return torch.softmax(x, dim=axis)
def _gelu(x):
    return torch.nn.functional.gelu(x, approximate="tanh")
def _silu(x):
    return torch.nn.functional.silu(x)
def _sigmoid(x):
    return torch.sigmoid(x)
def _layernorm(x, axis=-1, eps=1e-5):
    m = x.mean(dim=axis, keepdim=True)
    v = x.var(dim=axis, keepdim=True, unbiased=False)
    return (x - m) / torch.sqrt(v + eps)
def _scatter_add(tgt, idx, src, axis=0):
    return tgt.clone().index_add_(axis, idx, src)
def _segment_sum(src, seg, n):
    out = torch.zeros((n,) + src.shape[1:], dtype=src.dtype)
    return out.index_add_(0, seg, src)
def _pad(x, pw):
    flat = tuple(v for pair in reversed(pw) for v in pair)
    return torch.nn.functional.pad(x, flat)

kernel_name = 'gated_mix__linear_attn_block__ssm_conv_s4__prompt'

def setup_inputs():

    _w = (lambda a: (lambda t: t.to(torch.bfloat16) if t.is_floating_point() else t)(torch.as_tensor(a)))
    def _A_setup():
        B, S, D = 1, 2048, 576
        return {
            "x": _w((lambda *s: torch.randn(*s, dtype=torch.bfloat16) * 0.05)(B, S, D)),
            "wqkv": _w((lambda *s: torch.randn(*s, dtype=torch.bfloat16) * 0.8)(D, 3 * D)),
            "wo": _w((lambda *s: torch.randn(*s, dtype=torch.bfloat16) * 0.05)(D, D)),
        }
    _A_in = _A_setup()

    def _B_setup():
        B, L, D, N = 1, 2048, 576, 128
        A_re = -(lambda _x: torch.exp(torch.as_tensor(_x)))((lambda *s: torch.randn(*s, dtype=torch.bfloat16) * 3.2)(D, N))
        A_im = torch.pi * (lambda *s: torch.randn(*s, dtype=torch.bfloat16) * 0.05)(D, N)
        B_re = (lambda *s: torch.randn(*s, dtype=torch.bfloat16) * 0.2)(D, N)
        B_im = (lambda *s: torch.randn(*s, dtype=torch.bfloat16) * 0.2)(D, N)
        C_re = (lambda *s: torch.randn(*s, dtype=torch.bfloat16) * 0.2)(D, N)
        C_im = (lambda *s: torch.randn(*s, dtype=torch.bfloat16) * 0.2)(D, N)
        log_dt = (lambda *s: torch.randn(*s, dtype=torch.bfloat16) * 0.05)(D) * 0.5 - 4.0
        Dskip = (lambda *s: torch.randn(*s, dtype=torch.bfloat16) * 0.05)(D)
        return {
            "u": _w((lambda *s: torch.randn(*s, dtype=torch.bfloat16) * 0.05)(B, L, D)),
            "A_re": _w(A_re),
            "A_im": _w(A_im),
            "B_re": _w(B_re),
            "B_im": _w(B_im),
            "C_re": _w(C_re),
            "C_im": _w(C_im),
            "log_dt": _w(log_dt),
            "Dskip": _w(Dskip),
        }
    _B_in = _B_setup()

    return {
        "A_x": _A_in["x"],
        "A_wqkv": _A_in["wqkv"],
        "A_wo": _A_in["wo"],
        "B_u": _B_in["u"],
        "B_A_re": _B_in["A_re"],
        "B_A_im": _B_in["A_im"],
        "B_B_re": _B_in["B_re"],
        "B_B_im": _B_in["B_im"],
        "B_C_re": _B_in["C_re"],
        "B_C_im": _B_in["C_im"],
        "B_log_dt": _B_in["log_dt"],
        "B_Dskip": _B_in["Dskip"],
        "gate_w": _w((lambda *s: torch.randn(*s, dtype=torch.bfloat16) * 0.05)(576) * 16.0),
    }

def reference(A_x, A_wqkv, A_wo, B_u, B_A_re, B_A_im, B_B_re, B_B_im, B_C_re, B_C_im, B_log_dt, B_Dskip, gate_w):
    def _A_ref(x, wqkv, wo):
        B, S, D = x.shape
        H = 32; Dh = D // H
        qkv = (lambda x, *d: x.permute(*d))((x @ wqkv).reshape(B, S, 3, H, Dh), 2, 0, 3, 1, 4)
        q, k, v = qkv[0], qkv[1], qkv[2]
        phi = lambda t: torch.where(t > 0, t + 1, torch.exp(t)) + 1e-6
        pq, pk = phi(q), phi(k)
        kv = torch.einsum("bhsd,bhse->bhde", pk, v)
        z = torch.einsum("bhsd->bhd", pk)
        num = torch.einsum("bhqd,bhde->bhqe", pq, kv)
        den = torch.einsum("bhqd,bhd->bhq", pq, z)[..., None] + 1e-6
        o = num / den
        return (lambda x, *d: x.permute(*d))(o, 0, 2, 1, 3).reshape(B, S, D) @ wo

    def _B_ref(u, A_re, A_im, B_re, B_im, C_re, C_im, log_dt, Dskip):
        Bsz, L, D = u.shape
        dt = torch.exp(log_dt)[:, None]
        A = A_re + 1j * A_im
        Bc = B_re + 1j * B_im
        Cc = C_re + 1j * C_im
        logdA = dt * A
        dB = dt * Bc
        l = (lambda x, dt: x.to(dt))(torch.arange(L), A_re.dtype)
        P = torch.exp(logdA[:, :, None] * l[None, None, :])
        K = torch.einsum("dn,dnl,dn->dl", Cc, P, dB).real
        L2 = 2 * L
        Kp = _pad(K, ((0, 0), (0, L)))
        up = (lambda x, *d: x.permute(*d))(u, 0, 2, 1)
        up = _pad(up, ((0, 0), (0, 0), (0, L)))
        Kf = (lambda x, axes=(-2,-1): torch.fft.rfft2(x.float(), dim=axes))(Kp[:, None, :], axes=(-2, -1))
        Uf = (lambda x, axes=(-2,-1): torch.fft.rfft2(x.float(), dim=axes))(up[:, :, None, :], axes=(-2, -1))
        Yf = Uf * Kf[None, :, :, :]
        y = (lambda x, s, axes=(-2,-1): torch.fft.irfft2(x, s=s, dim=axes).to(torch.bfloat16))(Yf, (1, L2), axes=(-2, -1))[:, :, 0, :L]
        y = (lambda x, *d: x.permute(*d))(y, 0, 2, 1) + u * Dskip[None, None, :]
        return y

    x = A_x
    g = _sigmoid((x * gate_w).sum(-1, keepdims=True))
    a = _A_ref(x, A_wqkv, A_wo)
    b = _B_ref(x, B_A_re, B_A_im, B_B_re, B_B_im, B_C_re, B_C_im, B_log_dt, B_Dskip)
    return g * a + (1 - g) * b
```

```asm
; @launch kernel=k1_kernel grid=(480,1,1) block=(256,1,1) lds=81920
; @launch kernel=km_kernel grid=(256,1,1) block=(256,1,1) lds=156672
.amdgcn_target "amdgcn-amd-amdhsa--gfx950"
.text
.globl k1_kernel
.p2align 8
.type k1_kernel,@function
k1_kernel:
    s_cmp_ge_u32 s2, 480
    s_cbranch_scc1 K1_EXIT
    s_load_dwordx16 s[16:31], s[0:1], 0
    s_load_dwordx16 s[32:47], s[0:1], 64
    v_lshrrev_b32 v2, 6, v0
    v_and_b32 v1, 63, v0
    s_nop 0
    v_readfirstlane_b32 s3, v2

    s_cmp_lt_u32 s2, 288
    s_cbranch_scc1 K1_PREP
    s_sub_u32 s97, s2, 288

K1_GEMM:
    s_setprio 3
    s_and_b32 s4, s97, 7
    s_lshr_b32 s5, s97, 3
    s_and_b32 s6, s4, 3
    s_lshl_b32 s6, s6, 2
    s_and_b32 s7, s5, 3
    s_add_u32 s6, s6, s7
    s_lshr_b32 s4, s4, 2
    s_mul_i32 s4, s4, 6
    s_lshr_b32 s5, s5, 2
    s_add_u32 s7, s4, s5

    s_mul_i32 s4, s7, 11
    s_lshr_b32 s4, s4, 5
    s_mul_i32 s5, s4, 3
    s_sub_u32 s5, s7, s5
    s_sub_u32 s11, s7, s4
    s_sub_u32 s11, s11, 1

    s_mul_i32 s12, s4, 288
    s_mul_i32 s13, s11, 144
    s_add_u32 s13, s13, 1152
    s_cmp_eq_u32 s5, 0
    s_cselect_b32 s12, s12, s13
    s_cselect_b32 s13, 0, 1008
    s_lshl_b32 s8, s3, 12
    s_lshl_b32 s9, s3, 9

    v_and_b32 v10, 15, v1
    v_lshrrev_b32 v11, 4, v1

    s_lshl_b32 s14, s6, 7
    s_lshl_b32 s15, s3, 5
    s_add_u32 s14, s14, s15
    v_lshrrev_b32 v13, 3, v1
    v_and_b32 v14, 7, v1
    v_add_u32 v12, s14, v13
    v_mul_u32_u24 v12, 1152, v12
    v_lshl_add_u32 v2, v14, 4, v12
    s_mov_b32 s64, 0
    s_mov_b32 s65, 9216
    s_mov_b32 s66, 18432
    s_mov_b32 s67, 27648
    s_lshl_b32 s15, s3, 11
    s_add_u32 s15, s15, 73728
    v_xor_b32 v14, v14, v13
    v_lshlrev_b32 v14, 4, v14
    v_lshl_add_u32 v14, v13, 7, v14
    v_add_u32 v3, s15, v14
    v_and_b32 v13, 7, v10
    v_xor_b32 v13, v13, v11
    v_lshlrev_b32 v14, 7, v10
    v_add_u32 v14, s15, v14
    v_lshl_add_u32 v241, v13, 4, v14
    v_xor_b32 v13, 4, v13
    v_lshl_add_u32 v242, v13, 4, v14

    s_waitcnt lgkmcnt(0)
    s_mov_b32 s48, s16
    s_and_b32 s49, s17, 0xffff
    s_mov_b32 s50, 0x240000
    s_mov_b32 s51, 0x20000
    buffer_load_dwordx4 v[16:19], v2, s[48:51], s64 offen offset:0
    buffer_load_dwordx4 v[20:23], v2, s[48:51], s65 offen offset:0
    buffer_load_dwordx4 v[24:27], v2, s[48:51], s66 offen offset:0
    buffer_load_dwordx4 v[28:31], v2, s[48:51], s67 offen offset:0
    buffer_load_dwordx4 v[32:35], v2, s[48:51], s64 offen offset:128
    buffer_load_dwordx4 v[36:39], v2, s[48:51], s65 offen offset:128
    buffer_load_dwordx4 v[40:43], v2, s[48:51], s66 offen offset:128
    buffer_load_dwordx4 v[44:47], v2, s[48:51], s67 offen offset:128
    v_mov_b32 v244, s12
    s_add_u32 s15, s12, s13
    v_mov_b32 v245, s15
    s_lshl_b32 s15, s3, 8
    v_add_u32 v12, s15, v1
    v_mul_u32_u24 v13, 3641, v12
    v_lshrrev_b32 v13, 16, v13
    v_mul_u32_u24 v14, 18, v13
    v_sub_u32 v14, v12, v14

    v_and_b32 v12, 0x33, v13
    v_and_b32 v15, 4, v13
    v_lshl_or_b32 v12, v15, 1, v12
    v_bfe_u32 v15, v13, 3, 1
    v_lshl_or_b32 v12, v15, 2, v12
    v_cmp_le_u32 vcc, 9, v14
    v_mul_u32_u24 v12, 3456, v12
    v_lshl_add_u32 v12, v14, 4, v12
    v_cndmask_b32 v15, v244, v245, vcc
    v_add_u32 v4, v12, v15

    v_add_u32 v14, 10, v14
    v_cmp_le_u32 vcc, 18, v14
    v_subrev_u32 v15, 18, v14
    v_add_u32 v13, 3, v13
    v_cndmask_b32 v14, v14, v15, vcc
    v_addc_co_u32 v13, vcc, 0, v13, vcc

    v_and_b32 v12, 0x33, v13
    v_and_b32 v15, 4, v13
    v_lshl_or_b32 v12, v15, 1, v12
    v_bfe_u32 v15, v13, 3, 1
    v_lshl_or_b32 v12, v15, 2, v12
    v_cmp_le_u32 vcc, 9, v14
    v_mul_u32_u24 v12, 3456, v12
    v_lshl_add_u32 v12, v14, 4, v12
    v_cndmask_b32 v15, v244, v245, vcc
    v_add_u32 v5, v12, v15

    v_add_u32 v14, 10, v14
    v_cmp_le_u32 vcc, 18, v14
    v_subrev_u32 v15, 18, v14
    v_add_u32 v13, 3, v13
    v_cndmask_b32 v14, v14, v15, vcc
    v_addc_co_u32 v13, vcc, 0, v13, vcc

    v_and_b32 v12, 0x33, v13
    v_and_b32 v15, 4, v13
    v_lshl_or_b32 v12, v15, 1, v12
    v_bfe_u32 v15, v13, 3, 1
    v_lshl_or_b32 v12, v15, 2, v12
    v_cmp_le_u32 vcc, 9, v14
    v_mul_u32_u24 v12, 3456, v12
    v_lshl_add_u32 v12, v14, 4, v12
    v_cndmask_b32 v15, v244, v245, vcc
    v_add_u32 v6, v12, v15

    v_add_u32 v14, 10, v14
    v_cmp_le_u32 vcc, 18, v14
    v_subrev_u32 v15, 18, v14
    v_add_u32 v13, 3, v13
    v_cndmask_b32 v14, v14, v15, vcc
    v_addc_co_u32 v13, vcc, 0, v13, vcc

    v_and_b32 v12, 0x33, v13
    v_and_b32 v15, 4, v13
    v_lshl_or_b32 v12, v15, 1, v12
    v_bfe_u32 v15, v13, 3, 1
    v_lshl_or_b32 v12, v15, 2, v12
    v_cmp_le_u32 vcc, 9, v14
    v_mul_u32_u24 v12, 3456, v12
    v_lshl_add_u32 v12, v14, 4, v12
    v_cndmask_b32 v15, v244, v245, vcc
    v_add_u32 v7, v12, v15

    s_lshl_b32 s15, s3, 5
    s_add_u32 s15, s15, 1024
    v_add_u32 v12, s15, v1
    v_mul_u32_u24 v13, 3641, v12
    v_lshrrev_b32 v13, 16, v13
    v_mul_u32_u24 v14, 18, v13
    v_sub_u32 v14, v12, v14

    v_and_b32 v12, 0x33, v13
    v_and_b32 v15, 4, v13
    v_lshl_or_b32 v12, v15, 1, v12
    v_bfe_u32 v15, v13, 3, 1
    v_lshl_or_b32 v12, v15, 2, v12
    v_cmp_le_u32 vcc, 9, v14
    v_mul_u32_u24 v12, 3456, v12
    v_lshl_add_u32 v12, v14, 4, v12
    v_cndmask_b32 v15, v244, v245, vcc
    v_add_u32 v8, v12, v15

    v_lshrrev_b32 v12, 2, v10
    v_and_b32 v13, 1, v11
    v_lshl_add_u32 v12, v13, 2, v12
    v_lshrrev_b32 v13, 1, v11
    v_lshl_add_u32 v12, v13, 4, v12
    v_mul_u32_u24 v12, 288, v12
    v_and_b32 v13, 3, v1
    v_lshl_add_u32 v9, v13, 3, v12
    v_add_u32 v240, 36864, v9

    s_mov_b32 s52, s18
    s_and_b32 s53, s19, 0xffff
    s_mov_b32 s54, 0x1e6000
    s_mov_b32 s55, 0x20000
    s_mov_b32 s56, s46
    s_and_b32 s57, s47, 0xffff
    s_mov_b32 s58, 0xb70000
    s_mov_b32 s59, 0x20000
    s_mov_b32 s60, 0x3fb8aa3b
    s_mov_b32 s61, 0x3fb8aa3b
    s_mov_b32 s62, 0x358637bd
    s_mov_b32 s63, 0x358637bd
    s_cmp_eq_u32 s5, 0
    s_cbranch_scc0 K1_GEMM_KV
    s_add_u32 m0, s8, 0x0
    s_mov_b32 s10, 0x0
    buffer_load_dwordx4 v4, s[52:55], s10 offen lds
    s_add_u32 m0, s8, 0x400
    s_mov_b32 s10, 0x0
    buffer_load_dwordx4 v5, s[52:55], s10 offen lds
    s_add_u32 m0, s8, 0x800
    s_mov_b32 s10, 0x0
    buffer_load_dwordx4 v6, s[52:55], s10 offen lds
    s_add_u32 m0, s8, 0xc00
    s_mov_b32 s10, 0x0
    buffer_load_dwordx4 v7, s[52:55], s10 offen lds
    s_add_u32 m0, s9, 0x4000
    s_mov_b32 exec_hi, 0
    buffer_load_dwordx4 v8, s[52:55], s10 offen lds
    s_mov_b32 exec_hi, -1
    s_add_u32 m0, s8, 0x4800
    s_mov_b32 s10, 0x36000
    buffer_load_dwordx4 v4, s[52:55], s10 offen lds
    s_add_u32 m0, s8, 0x4c00
    s_mov_b32 s10, 0x36000
    buffer_load_dwordx4 v5, s[52:55], s10 offen lds
    s_add_u32 m0, s8, 0x5000
    s_mov_b32 s10, 0x36000
    buffer_load_dwordx4 v6, s[52:55], s10 offen lds
    s_add_u32 m0, s8, 0x5400
    s_mov_b32 s10, 0x36000
    buffer_load_dwordx4 v7, s[52:55], s10 offen lds
    s_add_u32 m0, s9, 0x8800
    s_mov_b32 exec_hi, 0
    buffer_load_dwordx4 v8, s[52:55], s10 offen lds
    s_mov_b32 exec_hi, -1
    s_waitcnt vmcnt(14)
    ds_write_b128 v3, v[16:19] offset:0
    ds_write_b128 v3, v[20:23] offset:1024
    ds_read_b128 v[96:99], v241
    ds_read_b128 v[104:107], v242
    ds_write_b128 v3, v[24:27] offset:0
    ds_write_b128 v3, v[28:31] offset:1024
    ds_read_b128 v[100:103], v241
    ds_read_b128 v[108:111], v242
    s_waitcnt vmcnt(5)
    s_barrier
    ds_read_b64_tr_b16 v[128:129], v9 offset:0
    ds_read_b64_tr_b16 v[130:131], v9 offset:2304
    ds_read_b64_tr_b16 v[132:133], v9 offset:32
    ds_read_b64_tr_b16 v[134:135], v9 offset:2336
    ds_read_b64_tr_b16 v[136:137], v9 offset:64
    ds_read_b64_tr_b16 v[138:139], v9 offset:2368
    ds_read_b64_tr_b16 v[140:141], v9 offset:96
    ds_read_b64_tr_b16 v[142:143], v9 offset:2400
    ds_read_b64_tr_b16 v[144:145], v9 offset:128
    ds_read_b64_tr_b16 v[146:147], v9 offset:2432
    ds_read_b64_tr_b16 v[148:149], v9 offset:160
    ds_read_b64_tr_b16 v[150:151], v9 offset:2464
    ds_read_b64_tr_b16 v[152:153], v9 offset:192
    ds_read_b64_tr_b16 v[154:155], v9 offset:2496
    ds_read_b64_tr_b16 v[156:157], v9 offset:224
    ds_read_b64_tr_b16 v[158:159], v9 offset:2528
    ds_read_b64_tr_b16 v[160:161], v9 offset:256
    ds_read_b64_tr_b16 v[162:163], v9 offset:2560
    s_waitcnt lgkmcnt(15)
    s_waitcnt lgkmcnt(12)
    v_mfma_f32_16x16x32_bf16 v[168:171], v[128:131], v[96:99], 0
    v_mfma_f32_16x16x32_bf16 v[204:207], v[128:131], v[100:103], 0
    ds_read_b64_tr_b16 v[164:165], v9 offset:9216
    ds_read_b64_tr_b16 v[166:167], v9 offset:11520
    s_add_u32 m0, s8, 0x9000
    s_mov_b32 s10, 0x6c000
    buffer_load_dwordx4 v4, s[52:55], s10 offen lds
    v_mfma_f32_16x16x32_bf16 v[172:175], v[132:135], v[96:99], 0
    v_mfma_f32_16x16x32_bf16 v[208:211], v[132:135], v[100:103], 0
    ds_read_b64_tr_b16 v[128:129], v9 offset:9248
    ds_read_b64_tr_b16 v[130:131], v9 offset:11552
    s_add_u32 m0, s8, 0x9400
    s_mov_b32 s10, 0x6c000
    buffer_load_dwordx4 v5, s[52:55], s10 offen lds
    v_mfma_f32_16x16x32_bf16 v[176:179], v[136:139], v[96:99], 0
    v_mfma_f32_16x16x32_bf16 v[212:215], v[136:139], v[100:103], 0
    ds_read_b64_tr_b16 v[132:133], v9 offset:9280
    ds_read_b64_tr_b16 v[134:135], v9 offset:11584
    s_add_u32 m0, s8, 0x9800
    s_mov_b32 s10, 0x6c000
    buffer_load_dwordx4 v6, s[52:55], s10 offen lds
    s_waitcnt lgkmcnt(12)
    v_mfma_f32_16x16x32_bf16 v[180:183], v[140:143], v[96:99], 0
    v_mfma_f32_16x16x32_bf16 v[216:219], v[140:143], v[100:103], 0
    ds_read_b64_tr_b16 v[136:137], v9 offset:9312
    ds_read_b64_tr_b16 v[138:139], v9 offset:11616
    s_add_u32 m0, s8, 0x9c00
    s_mov_b32 s10, 0x6c000
    buffer_load_dwordx4 v7, s[52:55], s10 offen lds
    v_mfma_f32_16x16x32_bf16 v[184:187], v[144:147], v[96:99], 0
    v_mfma_f32_16x16x32_bf16 v[220:223], v[144:147], v[100:103], 0
    ds_read_b64_tr_b16 v[140:141], v9 offset:9344
    ds_read_b64_tr_b16 v[142:143], v9 offset:11648
    s_add_u32 m0, s9, 0xd000
    s_mov_b32 exec_hi, 0
    buffer_load_dwordx4 v8, s[52:55], s10 offen lds
    s_mov_b32 exec_hi, -1
    ds_write_b128 v3, v[32:35] offset:0
    ds_write_b128 v3, v[36:39] offset:1024
    ds_read_b128 v[112:115], v241
    ds_read_b128 v[120:123], v242
    ds_write_b128 v3, v[40:43] offset:0
    ds_write_b128 v3, v[44:47] offset:1024
    ds_read_b128 v[116:119], v241
    ds_read_b128 v[124:127], v242
    v_mfma_f32_16x16x32_bf16 v[188:191], v[148:151], v[96:99], 0
    v_mfma_f32_16x16x32_bf16 v[224:227], v[148:151], v[100:103], 0
    ds_read_b64_tr_b16 v[144:145], v9 offset:9376
    ds_read_b64_tr_b16 v[146:147], v9 offset:11680
    buffer_load_dwordx4 v[48:51], v2, s[48:51], s64 offen offset:256
    s_waitcnt lgkmcnt(15)
    v_mfma_f32_16x16x32_bf16 v[192:195], v[152:155], v[96:99], 0
    v_mfma_f32_16x16x32_bf16 v[228:231], v[152:155], v[100:103], 0
    ds_read_b64_tr_b16 v[148:149], v9 offset:9408
    ds_read_b64_tr_b16 v[150:151], v9 offset:11712
    buffer_load_dwordx4 v[52:55], v2, s[48:51], s65 offen offset:256
    v_mfma_f32_16x16x32_bf16 v[196:199], v[156:159], v[96:99], 0
    v_mfma_f32_16x16x32_bf16 v[232:235], v[156:159], v[100:103], 0
    ds_read_b64_tr_b16 v[152:153], v9 offset:9440
    ds_read_b64_tr_b16 v[154:155], v9 offset:11744
    buffer_load_dwordx4 v[56:59], v2, s[48:51], s66 offen offset:256
    v_mfma_f32_16x16x32_bf16 v[200:203], v[160:163], v[96:99], 0
    v_mfma_f32_16x16x32_bf16 v[236:239], v[160:163], v[100:103], 0
    ds_read_b64_tr_b16 v[156:157], v9 offset:9472
    ds_read_b64_tr_b16 v[158:159], v9 offset:11776
    buffer_load_dwordx4 v[60:63], v2, s[48:51], s67 offen offset:256
    s_waitcnt vmcnt(9)
    s_barrier
    s_waitcnt lgkmcnt(15)
    v_mfma_f32_16x16x32_bf16 v[168:171], v[164:167], v[104:107], v[168:171]
    v_mfma_f32_16x16x32_bf16 v[204:207], v[164:167], v[108:111], v[204:207]
    ds_read_b64_tr_b16 v[160:161], v9 offset:18432
    ds_read_b64_tr_b16 v[162:163], v9 offset:20736
    s_add_u32 m0, s8, 0xd800
    s_mov_b32 s10, 0xa2000
    buffer_load_dwordx4 v4, s[52:55], s10 offen lds
    v_mfma_f32_16x16x32_bf16 v[172:175], v[128:131], v[104:107], v[172:175]
    v_mfma_f32_16x16x32_bf16 v[208:211], v[128:131], v[108:111], v[208:211]
    ds_read_b64_tr_b16 v[164:165], v9 offset:18464
    ds_read_b64_tr_b16 v[166:167], v9 offset:20768
    s_add_u32 m0, s8, 0xdc00
    s_mov_b32 s10, 0xa2000
    buffer_load_dwordx4 v5, s[52:55], s10 offen lds
    v_mfma_f32_16x16x32_bf16 v[176:179], v[132:135], v[104:107], v[176:179]
    v_mfma_f32_16x16x32_bf16 v[212:215], v[132:135], v[108:111], v[212:215]
    ds_read_b64_tr_b16 v[128:129], v9 offset:18496
    ds_read_b64_tr_b16 v[130:131], v9 offset:20800
    s_add_u32 m0, s8, 0xe000
    s_mov_b32 s10, 0xa2000
    buffer_load_dwordx4 v6, s[52:55], s10 offen lds
    s_waitcnt lgkmcnt(12)
    v_mfma_f32_16x16x32_bf16 v[180:183], v[136:139], v[104:107], v[180:183]
    v_mfma_f32_16x16x32_bf16 v[216:219], v[136:139], v[108:111], v[216:219]
    ds_read_b64_tr_b16 v[132:133], v9 offset:18528
    ds_read_b64_tr_b16 v[134:135], v9 offset:20832
    s_add_u32 m0, s8, 0xe400
    s_mov_b32 s10, 0xa2000
    buffer_load_dwordx4 v7, s[52:55], s10 offen lds
    v_mfma_f32_16x16x32_bf16 v[184:187], v[140:143], v[104:107], v[184:187]
    v_mfma_f32_16x16x32_bf16 v[220:223], v[140:143], v[108:111], v[220:223]
    ds_read_b64_tr_b16 v[136:137], v9 offset:18560
    ds_read_b64_tr_b16 v[138:139], v9 offset:20864
    s_add_u32 m0, s9, 0x11800
    s_mov_b32 exec_hi, 0
    buffer_load_dwordx4 v8, s[52:55], s10 offen lds
    s_mov_b32 exec_hi, -1
    v_mfma_f32_16x16x32_bf16 v[188:191], v[144:147], v[104:107], v[188:191]
    v_mfma_f32_16x16x32_bf16 v[224:227], v[144:147], v[108:111], v[224:227]
    ds_read_b64_tr_b16 v[140:141], v9 offset:18592
    ds_read_b64_tr_b16 v[142:143], v9 offset:20896
    buffer_load_dwordx4 v[64:67], v2, s[48:51], s64 offen offset:384
    s_waitcnt lgkmcnt(12)
    v_mfma_f32_16x16x32_bf16 v[192:195], v[148:151], v[104:107], v[192:195]
    v_mfma_f32_16x16x32_bf16 v[228:231], v[148:151], v[108:111], v[228:231]
    ds_read_b64_tr_b16 v[144:145], v9 offset:18624
    ds_read_b64_tr_b16 v[146:147], v9 offset:20928
    buffer_load_dwordx4 v[68:71], v2, s[48:51], s65 offen offset:384
    v_mfma_f32_16x16x32_bf16 v[196:199], v[152:155], v[104:107], v[196:199]
    v_mfma_f32_16x16x32_bf16 v[232:235], v[152:155], v[108:111], v[232:235]
    ds_read_b64_tr_b16 v[148:149], v9 offset:18656
    ds_read_b64_tr_b16 v[150:151], v9 offset:20960
    buffer_load_dwordx4 v[72:75], v2, s[48:51], s66 offen offset:384
    v_mfma_f32_16x16x32_bf16 v[200:203], v[156:159], v[104:107], v[200:203]
    v_mfma_f32_16x16x32_bf16 v[236:239], v[156:159], v[108:111], v[236:239]
    ds_read_b64_tr_b16 v[152:153], v9 offset:18688
    ds_read_b64_tr_b16 v[154:155], v9 offset:20992
    buffer_load_dwordx4 v[76:79], v2, s[48:51], s67 offen offset:384
    s_waitcnt lgkmcnt(12)
    v_mfma_f32_16x16x32_bf16 v[168:171], v[160:163], v[112:115], v[168:171]
    v_mfma_f32_16x16x32_bf16 v[204:207], v[160:163], v[116:119], v[204:207]
    ds_read_b64_tr_b16 v[156:157], v9 offset:27648
    ds_read_b64_tr_b16 v[158:159], v9 offset:29952
    buffer_load_dwordx4 v[80:83], v2, s[48:51], s64 offen offset:512
    v_mfma_f32_16x16x32_bf16 v[172:175], v[164:167], v[112:115], v[172:175]
    v_mfma_f32_16x16x32_bf16 v[208:211], v[164:167], v[116:119], v[208:211]
    ds_read_b64_tr_b16 v[160:161], v9 offset:27680
    ds_read_b64_tr_b16 v[162:163], v9 offset:29984
    buffer_load_dwordx4 v[84:87], v2, s[48:51], s65 offen offset:512
    v_mfma_f32_16x16x32_bf16 v[176:179], v[128:131], v[112:115], v[176:179]
    v_mfma_f32_16x16x32_bf16 v[212:215], v[128:131], v[116:119], v[212:215]
    ds_read_b64_tr_b16 v[164:165], v9 offset:27712
    ds_read_b64_tr_b16 v[166:167], v9 offset:30016
    buffer_load_dwordx4 v[88:91], v2, s[48:51], s66 offen offset:512
    s_waitcnt lgkmcnt(12)
    v_mfma_f32_16x16x32_bf16 v[180:183], v[132:135], v[112:115], v[180:183]
    v_mfma_f32_16x16x32_bf16 v[216:219], v[132:135], v[116:119], v[216:219]
    ds_read_b64_tr_b16 v[128:129], v9 offset:27744
    ds_read_b64_tr_b16 v[130:131], v9 offset:30048
    buffer_load_dwordx4 v[92:95], v2, s[48:51], s67 offen offset:512
    v_mfma_f32_16x16x32_bf16 v[184:187], v[136:139], v[112:115], v[184:187]
    v_mfma_f32_16x16x32_bf16 v[220:223], v[136:139], v[116:119], v[220:223]
    ds_read_b64_tr_b16 v[132:133], v9 offset:27776
    ds_read_b64_tr_b16 v[134:135], v9 offset:30080
    buffer_load_dwordx4 v[16:19], v2, s[48:51], s64 offen offset:640
    s_waitcnt vmcnt(14)
    ds_write_b128 v3, v[48:51] offset:0
    ds_write_b128 v3, v[52:55] offset:1024
    ds_read_b128 v[96:99], v241
    ds_read_b128 v[104:107], v242
    ds_write_b128 v3, v[56:59] offset:0
    ds_write_b128 v3, v[60:63] offset:1024
    ds_read_b128 v[100:103], v241
    ds_read_b128 v[108:111], v242
    v_mfma_f32_16x16x32_bf16 v[188:191], v[140:143], v[112:115], v[188:191]
    v_mfma_f32_16x16x32_bf16 v[224:227], v[140:143], v[116:119], v[224:227]
    ds_read_b64_tr_b16 v[136:137], v9 offset:27808
    ds_read_b64_tr_b16 v[138:139], v9 offset:30112
    buffer_load_dwordx4 v[20:23], v2, s[48:51], s65 offen offset:640
    s_waitcnt lgkmcnt(15)
    v_mfma_f32_16x16x32_bf16 v[192:195], v[144:147], v[112:115], v[192:195]
    v_mfma_f32_16x16x32_bf16 v[228:231], v[144:147], v[116:119], v[228:231]
    ds_read_b64_tr_b16 v[140:141], v9 offset:27840
    ds_read_b64_tr_b16 v[142:143], v9 offset:30144
    buffer_load_dwordx4 v[24:27], v2, s[48:51], s66 offen offset:640
    v_mfma_f32_16x16x32_bf16 v[196:199], v[148:151], v[112:115], v[196:199]
    v_mfma_f32_16x16x32_bf16 v[232:235], v[148:151], v[116:119], v[232:235]
    ds_read_b64_tr_b16 v[144:145], v9 offset:27872
    ds_read_b64_tr_b16 v[146:147], v9 offset:30176
    buffer_load_dwordx4 v[28:31], v2, s[48:51], s67 offen offset:640
    v_mfma_f32_16x16x32_bf16 v[200:203], v[152:155], v[112:115], v[200:203]
    v_mfma_f32_16x16x32_bf16 v[236:239], v[152:155], v[116:119], v[236:239]
    ds_read_b64_tr_b16 v[148:149], v9 offset:27904
    ds_read_b64_tr_b16 v[150:151], v9 offset:30208
    buffer_load_dwordx4 v[32:35], v2, s[48:51], s64 offen offset:768
    s_barrier
    s_waitcnt lgkmcnt(15)
    v_mfma_f32_16x16x32_bf16 v[168:171], v[156:159], v[120:123], v[168:171]
    v_mfma_f32_16x16x32_bf16 v[204:207], v[156:159], v[124:127], v[204:207]
    ds_read_b64_tr_b16 v[152:153], v240 offset:0
    ds_read_b64_tr_b16 v[154:155], v240 offset:2304
    buffer_load_dwordx4 v[36:39], v2, s[48:51], s65 offen offset:768
    v_mfma_f32_16x16x32_bf16 v[172:175], v[160:163], v[120:123], v[172:175]
    v_mfma_f32_16x16x32_bf16 v[208:211], v[160:163], v[124:127], v[208:211]
    ds_read_b64_tr_b16 v[156:157], v240 offset:32
    ds_read_b64_tr_b16 v[158:159], v240 offset:2336
    buffer_load_dwordx4 v[40:43], v2, s[48:51], s66 offen offset:768
    v_mfma_f32_16x16x32_bf16 v[176:179], v[164:167], v[120:123], v[176:179]
    v_mfma_f32_16x16x32_bf16 v[212:215], v[164:167], v[124:127], v[212:215]
    ds_read_b64_tr_b16 v[160:161], v240 offset:64
    ds_read_b64_tr_b16 v[162:163], v240 offset:2368
    buffer_load_dwordx4 v[44:47], v2, s[48:51], s67 offen offset:768
    s_waitcnt lgkmcnt(12)
    v_mfma_f32_16x16x32_bf16 v[180:183], v[128:131], v[120:123], v[180:183]
    v_mfma_f32_16x16x32_bf16 v[216:219], v[128:131], v[124:127], v[216:219]
    ds_read_b64_tr_b16 v[164:165], v240 offset:96
    ds_read_b64_tr_b16 v[166:167], v240 offset:2400
    buffer_load_dwordx4 v[48:51], v2, s[48:51], s64 offen offset:896
    v_mfma_f32_16x16x32_bf16 v[184:187], v[132:135], v[120:123], v[184:187]
    v_mfma_f32_16x16x32_bf16 v[220:223], v[132:135], v[124:127], v[220:223]
    ds_read_b64_tr_b16 v[128:129], v240 offset:128
    ds_read_b64_tr_b16 v[130:131], v240 offset:2432
    buffer_load_dwordx4 v[52:55], v2, s[48:51], s65 offen offset:896
    v_mfma_f32_16x16x32_bf16 v[188:191], v[136:139], v[120:123], v[188:191]
    v_mfma_f32_16x16x32_bf16 v[224:227], v[136:139], v[124:127], v[224:227]
    ds_read_b64_tr_b16 v[132:133], v240 offset:160
    ds_read_b64_tr_b16 v[134:135], v240 offset:2464
    buffer_load_dwordx4 v[56:59], v2, s[48:51], s66 offen offset:896
    s_waitcnt lgkmcnt(12)
    v_mfma_f32_16x16x32_bf16 v[192:195], v[140:143], v[120:123], v[192:195]
    v_mfma_f32_16x16x32_bf16 v[228:231], v[140:143], v[124:127], v[228:231]
    ds_read_b64_tr_b16 v[136:137], v240 offset:192
    ds_read_b64_tr_b16 v[138:139], v240 offset:2496
    buffer_load_dwordx4 v[60:63], v2, s[48:51], s67 offen offset:896
    v_mfma_f32_16x16x32_bf16 v[196:199], v[144:147], v[120:123], v[196:199]
    v_mfma_f32_16x16x32_bf16 v[232:235], v[144:147], v[124:127], v[232:235]
    ds_read_b64_tr_b16 v[140:141], v240 offset:224
    ds_read_b64_tr_b16 v[142:143], v240 offset:2528
    s_add_u32 m0, s8, 0x0
    s_mov_b32 s10, 0xd8000
    buffer_load_dwordx4 v4, s[52:55], s10 offen lds
    v_mfma_f32_16x16x32_bf16 v[200:203], v[148:151], v[120:123], v[200:203]
    v_mfma_f32_16x16x32_bf16 v[236:239], v[148:151], v[124:127], v[236:239]
    ds_read_b64_tr_b16 v[144:145], v240 offset:256
    ds_read_b64_tr_b16 v[146:147], v240 offset:2560
    s_add_u32 m0, s8, 0x400
    s_mov_b32 s10, 0xd8000
    buffer_load_dwordx4 v5, s[52:55], s10 offen lds
    s_waitcnt lgkmcnt(12)
    v_mfma_f32_16x16x32_bf16 v[168:171], v[152:155], v[96:99], v[168:171]
    v_mfma_f32_16x16x32_bf16 v[204:207], v[152:155], v[100:103], v[204:207]
    ds_read_b64_tr_b16 v[148:149], v240 offset:9216
    ds_read_b64_tr_b16 v[150:151], v240 offset:11520
    s_add_u32 m0, s8, 0x800
    s_mov_b32 s10, 0xd8000
    buffer_load_dwordx4 v6, s[52:55], s10 offen lds
    v_mfma_f32_16x16x32_bf16 v[172:175], v[156:159], v[96:99], v[172:175]
    v_mfma_f32_16x16x32_bf16 v[208:211], v[156:159], v[100:103], v[208:211]
    ds_read_b64_tr_b16 v[152:153], v240 offset:9248
    ds_read_b64_tr_b16 v[154:155], v240 offset:11552
    s_add_u32 m0, s8, 0xc00
    s_mov_b32 s10, 0xd8000
    buffer_load_dwordx4 v7, s[52:55], s10 offen lds
    v_mfma_f32_16x16x32_bf16 v[176:179], v[160:163], v[96:99], v[176:179]
    v_mfma_f32_16x16x32_bf16 v[212:215], v[160:163], v[100:103], v[212:215]
    ds_read_b64_tr_b16 v[156:157], v240 offset:9280
    ds_read_b64_tr_b16 v[158:159], v240 offset:11584
    s_add_u32 m0, s9, 0x4000
    s_mov_b32 exec_hi, 0
    buffer_load_dwordx4 v8, s[52:55], s10 offen lds
    s_mov_b32 exec_hi, -1
    s_waitcnt lgkmcnt(12)
    v_mfma_f32_16x16x32_bf16 v[180:183], v[164:167], v[96:99], v[180:183]
    v_mfma_f32_16x16x32_bf16 v[216:219], v[164:167], v[100:103], v[216:219]
    ds_read_b64_tr_b16 v[160:161], v240 offset:9312
    ds_read_b64_tr_b16 v[162:163], v240 offset:11616
    v_mfma_f32_16x16x32_bf16 v[184:187], v[128:131], v[96:99], v[184:187]
    v_mfma_f32_16x16x32_bf16 v[220:223], v[128:131], v[100:103], v[220:223]
    ds_read_b64_tr_b16 v[164:165], v240 offset:9344
    ds_read_b64_tr_b16 v[166:167], v240 offset:11648
    s_waitcnt vmcnt(21)
    ds_write_b128 v3, v[64:67] offset:0
    ds_write_b128 v3, v[68:71] offset:1024
    ds_read_b128 v[112:115], v241
    ds_read_b128 v[120:123], v242
    ds_write_b128 v3, v[72:75] offset:0
    ds_write_b128 v3, v[76:79] offset:1024
    ds_read_b128 v[116:119], v241
    ds_read_b128 v[124:127], v242
    v_mfma_f32_16x16x32_bf16 v[188:191], v[132:135], v[96:99], v[188:191]
    v_mfma_f32_16x16x32_bf16 v[224:227], v[132:135], v[100:103], v[224:227]
    ds_read_b64_tr_b16 v[128:129], v240 offset:9376
    ds_read_b64_tr_b16 v[130:131], v240 offset:11680
    buffer_load_dwordx4 v[64:67], v2, s[48:51], s64 offen offset:1024
    s_waitcnt lgkmcnt(15)
    v_mfma_f32_16x16x32_bf16 v[192:195], v[136:139], v[96:99], v[192:195]
    v_mfma_f32_16x16x32_bf16 v[228:231], v[136:139], v[100:103], v[228:231]
    ds_read_b64_tr_b16 v[132:133], v240 offset:9408
    ds_read_b64_tr_b16 v[134:135], v240 offset:11712
    buffer_load_dwordx4 v[68:71], v2, s[48:51], s65 offen offset:1024
    v_mfma_f32_16x16x32_bf16 v[196:199], v[140:143], v[96:99], v[196:199]
    v_mfma_f32_16x16x32_bf16 v[232:235], v[140:143], v[100:103], v[232:235]
    ds_read_b64_tr_b16 v[136:137], v240 offset:9440
    ds_read_b64_tr_b16 v[138:139], v240 offset:11744
    buffer_load_dwordx4 v[72:75], v2, s[48:51], s66 offen offset:1024
    v_mfma_f32_16x16x32_bf16 v[200:203], v[144:147], v[96:99], v[200:203]
    v_mfma_f32_16x16x32_bf16 v[236:239], v[144:147], v[100:103], v[236:239]
    ds_read_b64_tr_b16 v[140:141], v240 offset:9472
    ds_read_b64_tr_b16 v[142:143], v240 offset:11776
    buffer_load_dwordx4 v[76:79], v2, s[48:51], s67 offen offset:1024
    s_barrier
    s_waitcnt lgkmcnt(15)
    v_mfma_f32_16x16x32_bf16 v[168:171], v[148:151], v[104:107], v[168:171]
    v_mfma_f32_16x16x32_bf16 v[204:207], v[148:151], v[108:111], v[204:207]
    ds_read_b64_tr_b16 v[144:145], v240 offset:18432
    ds_read_b64_tr_b16 v[146:147], v240 offset:20736
    s_add_u32 m0, s8, 0x4800
    s_mov_b32 s10, 0x10e000
    buffer_load_dwordx4 v4, s[52:55], s10 offen lds
    v_mfma_f32_16x16x32_bf16 v[172:175], v[152:155], v[104:107], v[172:175]
    v_mfma_f32_16x16x32_bf16 v[208:211], v[152:155], v[108:111], v[208:211]
    ds_read_b64_tr_b16 v[148:149], v240 offset:18464
    ds_read_b64_tr_b16 v[150:151], v240 offset:20768
    s_add_u32 m0, s8, 0x4c00
    s_mov_b32 s10, 0x10e000
    buffer_load_dwordx4 v5, s[52:55], s10 offen lds
    v_mfma_f32_16x16x32_bf16 v[176:179], v[156:159], v[104:107], v[176:179]
    v_mfma_f32_16x16x32_bf16 v[212:215], v[156:159], v[108:111], v[212:215]
    ds_read_b64_tr_b16 v[152:153], v240 offset:18496
    ds_read_b64_tr_b16 v[154:155], v240 offset:20800
    s_add_u32 m0, s8, 0x5000
    s_mov_b32 s10, 0x10e000
    buffer_load_dwordx4 v6, s[52:55], s10 offen lds
    s_waitcnt lgkmcnt(12)
    v_mfma_f32_16x16x32_bf16 v[180:183], v[160:163], v[104:107], v[180:183]
    v_mfma_f32_16x16x32_bf16 v[216:219], v[160:163], v[108:111], v[216:219]
    ds_read_b64_tr_b16 v[156:157], v240 offset:18528
    ds_read_b64_tr_b16 v[158:159], v240 offset:20832
    s_add_u32 m0, s8, 0x5400
    s_mov_b32 s10, 0x10e000
    buffer_load_dwordx4 v7, s[52:55], s10 offen lds
    v_mfma_f32_16x16x32_bf16 v[184:187], v[164:167], v[104:107], v[184:187]
    v_mfma_f32_16x16x32_bf16 v[220:223], v[164:167], v[108:111], v[220:223]
    ds_read_b64_tr_b16 v[160:161], v240 offset:18560
    ds_read_b64_tr_b16 v[162:163], v240 offset:20864
    s_add_u32 m0, s9, 0x8800
    s_mov_b32 exec_hi, 0
    buffer_load_dwordx4 v8, s[52:55], s10 offen lds
    s_mov_b32 exec_hi, -1
    v_mfma_f32_16x16x32_bf16 v[188:191], v[128:131], v[104:107], v[188:191]
    v_mfma_f32_16x16x32_bf16 v[224:227], v[128:131], v[108:111], v[224:227]
    ds_read_b64_tr_b16 v[164:165], v240 offset:18592
    ds_read_b64_tr_b16 v[166:167], v240 offset:20896
    s_waitcnt lgkmcnt(12)
    v_mfma_f32_16x16x32_bf16 v[192:195], v[132:135], v[104:107], v[192:195]
    v_mfma_f32_16x16x32_bf16 v[228:231], v[132:135], v[108:111], v[228:231]
    ds_read_b64_tr_b16 v[128:129], v240 offset:18624
    ds_read_b64_tr_b16 v[130:131], v240 offset:20928
    v_mfma_f32_16x16x32_bf16 v[196:199], v[136:139], v[104:107], v[196:199]
    v_mfma_f32_16x16x32_bf16 v[232:235], v[136:139], v[108:111], v[232:235]
    ds_read_b64_tr_b16 v[132:133], v240 offset:18656
    ds_read_b64_tr_b16 v[134:135], v240 offset:20960
    v_mfma_f32_16x16x32_bf16 v[200:203], v[140:143], v[104:107], v[200:203]
    v_mfma_f32_16x16x32_bf16 v[236:239], v[140:143], v[108:111], v[236:239]
    ds_read_b64_tr_b16 v[136:137], v240 offset:18688
    ds_read_b64_tr_b16 v[138:139], v240 offset:20992
    s_waitcnt lgkmcnt(12)
    v_mfma_f32_16x16x32_bf16 v[168:171], v[144:147], v[112:115], v[168:171]
    v_mfma_f32_16x16x32_bf16 v[204:207], v[144:147], v[116:119], v[204:207]
    ds_read_b64_tr_b16 v[140:141], v240 offset:27648
    ds_read_b64_tr_b16 v[142:143], v240 offset:29952
    v_mfma_f32_16x16x32_bf16 v[172:175], v[148:151], v[112:115], v[172:175]
    v_mfma_f32_16x16x32_bf16 v[208:211], v[148:151], v[116:119], v[208:211]
    ds_read_b64_tr_b16 v[144:145], v240 offset:27680
    ds_read_b64_tr_b16 v[146:147], v240 offset:29984
    v_mfma_f32_16x16x32_bf16 v[176:179], v[152:155], v[112:115], v[176:179]
    v_mfma_f32_16x16x32_bf16 v[212:215], v[152:155], v[116:119], v[212:215]
    ds_read_b64_tr_b16 v[148:149], v240 offset:27712
    ds_read_b64_tr_b16 v[150:151], v240 offset:30016
    s_waitcnt lgkmcnt(12)
    v_mfma_f32_16x16x32_bf16 v[180:183], v[156:159], v[112:115], v[180:183]
    v_mfma_f32_16x16x32_bf16 v[216:219], v[156:159], v[116:119], v[216:219]
    ds_read_b64_tr_b16 v[152:153], v240 offset:27744
    ds_read_b64_tr_b16 v[154:155], v240 offset:30048
    v_mfma_f32_16x16x32_bf16 v[184:187], v[160:163], v[112:115], v[184:187]
    v_mfma_f32_16x16x32_bf16 v[220:223], v[160:163], v[116:119], v[220:223]
    ds_read_b64_tr_b16 v[156:157], v240 offset:27776
    ds_read_b64_tr_b16 v[158:159], v240 offset:30080
    s_waitcnt vmcnt(26)
    ds_write_b128 v3, v[80:83] offset:0
    ds_write_b128 v3, v[84:87] offset:1024
    ds_read_b128 v[96:99], v241
    ds_read_b128 v[104:107], v242
    ds_write_b128 v3, v[88:91] offset:0
    ds_write_b128 v3, v[92:95] offset:1024
    ds_read_b128 v[100:103], v241
    ds_read_b128 v[108:111], v242
    v_mfma_f32_16x16x32_bf16 v[188:191], v[164:167], v[112:115], v[188:191]
    v_mfma_f32_16x16x32_bf16 v[224:227], v[164:167], v[116:119], v[224:227]
    ds_read_b64_tr_b16 v[160:161], v240 offset:27808
    ds_read_b64_tr_b16 v[162:163], v240 offset:30112
    s_waitcnt lgkmcnt(15)
    v_mfma_f32_16x16x32_bf16 v[192:195], v[128:131], v[112:115], v[192:195]
    v_mfma_f32_16x16x32_bf16 v[228:231], v[128:131], v[116:119], v[228:231]
    ds_read_b64_tr_b16 v[164:165], v240 offset:27840
    ds_read_b64_tr_b16 v[166:167], v240 offset:30144
    v_mfma_f32_16x16x32_bf16 v[196:199], v[132:135], v[112:115], v[196:199]
    v_mfma_f32_16x16x32_bf16 v[232:235], v[132:135], v[116:119], v[232:235]
    ds_read_b64_tr_b16 v[128:129], v240 offset:27872
    ds_read_b64_tr_b16 v[130:131], v240 offset:30176
    v_mfma_f32_16x16x32_bf16 v[200:203], v[136:139], v[112:115], v[200:203]
    v_mfma_f32_16x16x32_bf16 v[236:239], v[136:139], v[116:119], v[236:239]
    ds_read_b64_tr_b16 v[132:133], v240 offset:27904
    ds_read_b64_tr_b16 v[134:135], v240 offset:30208
    s_waitcnt vmcnt(9)
    s_barrier
    s_waitcnt lgkmcnt(15)
    v_mfma_f32_16x16x32_bf16 v[168:171], v[140:143], v[120:123], v[168:171]
    v_mfma_f32_16x16x32_bf16 v[204:207], v[140:143], v[124:127], v[204:207]
    ds_read_b64_tr_b16 v[136:137], v9 offset:0
    ds_read_b64_tr_b16 v[138:139], v9 offset:2304
    s_add_u32 m0, s8, 0x9000
    s_mov_b32 s10, 0x144000
    buffer_load_dwordx4 v4, s[52:55], s10 offen lds
    v_mfma_f32_16x16x32_bf16 v[172:175], v[144:147], v[120:123], v[172:175]
    v_mfma_f32_16x16x32_bf16 v[208:211], v[144:147], v[124:127], v[208:211]
    ds_read_b64_tr_b16 v[140:141], v9 offset:32
    ds_read_b64_tr_b16 v[142:143], v9 offset:2336
    s_add_u32 m0, s8, 0x9400
    s_mov_b32 s10, 0x144000
    buffer_load_dwordx4 v5, s[52:55], s10 offen lds
    v_mfma_f32_16x16x32_bf16 v[176:179], v[148:151], v[120:123], v[176:179]
    v_mfma_f32_16x16x32_bf16 v[212:215], v[148:151], v[124:127], v[212:215]
    ds_read_b64_tr_b16 v[144:145], v9 offset:64
    ds_read_b64_tr_b16 v[146:147], v9 offset:2368
    s_add_u32 m0, s8, 0x9800
    s_mov_b32 s10, 0x144000
    buffer_load_dwordx4 v6, s[52:55], s10 offen lds
    s_waitcnt lgkmcnt(12)
    v_mfma_f32_16x16x32_bf16 v[180:183], v[152:155], v[120:123], v[180:183]
    v_mfma_f32_16x16x32_bf16 v[216:219], v[152:155], v[124:127], v[216:219]
    ds_read_b64_tr_b16 v[148:149], v9 offset:96
    ds_read_b64_tr_b16 v[150:151], v9 offset:2400
    s_add_u32 m0, s8, 0x9c00
    s_mov_b32 s10, 0x144000
    buffer_load_dwordx4 v7, s[52:55], s10 offen lds
    v_mfma_f32_16x16x32_bf16 v[184:187], v[156:159], v[120:123], v[184:187]
    v_mfma_f32_16x16x32_bf16 v[220:223], v[156:159], v[124:127], v[220:223]
    ds_read_b64_tr_b16 v[152:153], v9 offset:128
    ds_read_b64_tr_b16 v[154:155], v9 offset:2432
    s_add_u32 m0, s9, 0xd000
    s_mov_b32 exec_hi, 0
    buffer_load_dwordx4 v8, s[52:55], s10 offen lds
    s_mov_b32 exec_hi, -1
    v_mfma_f32_16x16x32_bf16 v[188:191], v[160:163], v[120:123], v[188:191]
    v_mfma_f32_16x16x32_bf16 v[224:227], v[160:163], v[124:127], v[224:227]
    ds_read_b64_tr_b16 v[156:157], v9 offset:160
    ds_read_b64_tr_b16 v[158:159], v9 offset:2464
    s_waitcnt lgkmcnt(12)
    v_mfma_f32_16x16x32_bf16 v[192:195], v[164:167], v[120:123], v[192:195]
    v_mfma_f32_16x16x32_bf16 v[228:231], v[164:167], v[124:127], v[228:231]
    ds_read_b64_tr_b16 v[160:161], v9 offset:192
    ds_read_b64_tr_b16 v[162:163], v9 offset:2496
    v_mfma_f32_16x16x32_bf16 v[196:199], v[128:131], v[120:123], v[196:199]
    v_mfma_f32_16x16x32_bf16 v[232:235], v[128:131], v[124:127], v[232:235]
    ds_read_b64_tr_b16 v[164:165], v9 offset:224
    ds_read_b64_tr_b16 v[166:167], v9 offset:2528
    v_mfma_f32_16x16x32_bf16 v[200:203], v[132:135], v[120:123], v[200:203]
    v_mfma_f32_16x16x32_bf16 v[236:239], v[132:135], v[124:127], v[236:239]
    ds_read_b64_tr_b16 v[128:129], v9 offset:256
    ds_read_b64_tr_b16 v[130:131], v9 offset:2560
    s_waitcnt lgkmcnt(12)
    v_mfma_f32_16x16x32_bf16 v[168:171], v[136:139], v[96:99], v[168:171]
    v_mfma_f32_16x16x32_bf16 v[204:207], v[136:139], v[100:103], v[204:207]
    ds_read_b64_tr_b16 v[132:133], v9 offset:9216
    ds_read_b64_tr_b16 v[134:135], v9 offset:11520
    v_mfma_f32_16x16x32_bf16 v[172:175], v[140:143], v[96:99], v[172:175]
    v_mfma_f32_16x16x32_bf16 v[208:211], v[140:143], v[100:103], v[208:211]
    ds_read_b64_tr_b16 v[136:137], v9 offset:9248
    ds_read_b64_tr_b16 v[138:139], v9 offset:11552
    v_mfma_f32_16x16x32_bf16 v[176:179], v[144:147], v[96:99], v[176:179]
    v_mfma_f32_16x16x32_bf16 v[212:215], v[144:147], v[100:103], v[212:215]
    ds_read_b64_tr_b16 v[140:141], v9 offset:9280
    ds_read_b64_tr_b16 v[142:143], v9 offset:11584
    s_waitcnt lgkmcnt(12)
    v_mfma_f32_16x16x32_bf16 v[180:183], v[148:151], v[96:99], v[180:183]
    v_mfma_f32_16x16x32_bf16 v[216:219], v[148:151], v[100:103], v[216:219]
    ds_read_b64_tr_b16 v[144:145], v9 offset:9312
    ds_read_b64_tr_b16 v[146:147], v9 offset:11616
    v_mfma_f32_16x16x32_bf16 v[184:187], v[152:155], v[96:99], v[184:187]
    v_mfma_f32_16x16x32_bf16 v[220:223], v[152:155], v[100:103], v[220:223]
    ds_read_b64_tr_b16 v[148:149], v9 offset:9344
    ds_read_b64_tr_b16 v[150:151], v9 offset:11648
    ds_write_b128 v3, v[16:19] offset:0
    ds_write_b128 v3, v[20:23] offset:1024
    ds_read_b128 v[112:115], v241
    ds_read_b128 v[120:123], v242
    ds_write_b128 v3, v[24:27] offset:0
    ds_write_b128 v3, v[28:31] offset:1024
    ds_read_b128 v[116:119], v241
    ds_read_b128 v[124:127], v242
    v_mfma_f32_16x16x32_bf16 v[188:191], v[156:159], v[96:99], v[188:191]
    v_mfma_f32_16x16x32_bf16 v[224:227], v[156:159], v[100:103], v[224:227]
    ds_read_b64_tr_b16 v[152:153], v9 offset:9376
    ds_read_b64_tr_b16 v[154:155], v9 offset:11680
    s_waitcnt lgkmcnt(15)
    v_mfma_f32_16x16x32_bf16 v[192:195], v[160:163], v[96:99], v[192:195]
    v_mfma_f32_16x16x32_bf16 v[228:231], v[160:163], v[100:103], v[228:231]
    ds_read_b64_tr_b16 v[156:157], v9 offset:9408
    ds_read_b64_tr_b16 v[158:159], v9 offset:11712
    v_mfma_f32_16x16x32_bf16 v[196:199], v[164:167], v[96:99], v[196:199]
    v_mfma_f32_16x16x32_bf16 v[232:235], v[164:167], v[100:103], v[232:235]
    ds_read_b64_tr_b16 v[160:161], v9 offset:9440
    ds_read_b64_tr_b16 v[162:163], v9 offset:11744
    v_mfma_f32_16x16x32_bf16 v[200:203], v[128:131], v[96:99], v[200:203]
    v_mfma_f32_16x16x32_bf16 v[236:239], v[128:131], v[100:103], v[236:239]
    ds_read_b64_tr_b16 v[164:165], v9 offset:9472
    ds_read_b64_tr_b16 v[166:167], v9 offset:11776
    s_waitcnt vmcnt(5)
    s_barrier
    s_waitcnt lgkmcnt(15)
    v_mfma_f32_16x16x32_bf16 v[168:171], v[132:135], v[104:107], v[168:171]
    v_mfma_f32_16x16x32_bf16 v[204:207], v[132:135], v[108:111], v[204:207]
    ds_read_b64_tr_b16 v[128:129], v9 offset:18432
    ds_read_b64_tr_b16 v[130:131], v9 offset:20736
    s_add_u32 m0, s8, 0xd800
    s_mov_b32 s10, 0x17a000
    buffer_load_dwordx4 v4, s[52:55], s10 offen lds
    v_mfma_f32_16x16x32_bf16 v[172:175], v[136:139], v[104:107], v[172:175]
    v_mfma_f32_16x16x32_bf16 v[208:211], v[136:139], v[108:111], v[208:211]
    ds_read_b64_tr_b16 v[132:133], v9 offset:18464
    ds_read_b64_tr_b16 v[134:135], v9 offset:20768
    s_add_u32 m0, s8, 0xdc00
    s_mov_b32 s10, 0x17a000
    buffer_load_dwordx4 v5, s[52:55], s10 offen lds
    v_mfma_f32_16x16x32_bf16 v[176:179], v[140:143], v[104:107], v[176:179]
    v_mfma_f32_16x16x32_bf16 v[212:215], v[140:143], v[108:111], v[212:215]
    ds_read_b64_tr_b16 v[136:137], v9 offset:18496
    ds_read_b64_tr_b16 v[138:139], v9 offset:20800
    s_add_u32 m0, s8, 0xe000
    s_mov_b32 s10, 0x17a000
    buffer_load_dwordx4 v6, s[52:55], s10 offen lds
    s_waitcnt lgkmcnt(12)
    v_mfma_f32_16x16x32_bf16 v[180:183], v[144:147], v[104:107], v[180:183]
    v_mfma_f32_16x16x32_bf16 v[216:219], v[144:147], v[108:111], v[216:219]
    ds_read_b64_tr_b16 v[140:141], v9 offset:18528
    ds_read_b64_tr_b16 v[142:143], v9 offset:20832
    s_add_u32 m0, s8, 0xe400
    s_mov_b32 s10, 0x17a000
    buffer_load_dwordx4 v7, s[52:55], s10 offen lds
    v_mfma_f32_16x16x32_bf16 v[184:187], v[148:151], v[104:107], v[184:187]
    v_mfma_f32_16x16x32_bf16 v[220:223], v[148:151], v[108:111], v[220:223]
    ds_read_b64_tr_b16 v[144:145], v9 offset:18560
    ds_read_b64_tr_b16 v[146:147], v9 offset:20864
    s_add_u32 m0, s9, 0x11800
    s_mov_b32 exec_hi, 0
    buffer_load_dwordx4 v8, s[52:55], s10 offen lds
    s_mov_b32 exec_hi, -1
    v_mfma_f32_16x16x32_bf16 v[188:191], v[152:155], v[104:107], v[188:191]
    v_mfma_f32_16x16x32_bf16 v[224:227], v[152:155], v[108:111], v[224:227]
    ds_read_b64_tr_b16 v[148:149], v9 offset:18592
    ds_read_b64_tr_b16 v[150:151], v9 offset:20896
    s_waitcnt lgkmcnt(12)
    v_mfma_f32_16x16x32_bf16 v[192:195], v[156:159], v[104:107], v[192:195]
    v_mfma_f32_16x16x32_bf16 v[228:231], v[156:159], v[108:111], v[228:231]
    ds_read_b64_tr_b16 v[152:153], v9 offset:18624
    ds_read_b64_tr_b16 v[154:155], v9 offset:20928
    v_mfma_f32_16x16x32_bf16 v[196:199], v[160:163], v[104:107], v[196:199]
    v_mfma_f32_16x16x32_bf16 v[232:235], v[160:163], v[108:111], v[232:235]
    ds_read_b64_tr_b16 v[156:157], v9 offset:18656
    ds_read_b64_tr_b16 v[158:159], v9 offset:20960
    v_mfma_f32_16x16x32_bf16 v[200:203], v[164:167], v[104:107], v[200:203]
    v_mfma_f32_16x16x32_bf16 v[236:239], v[164:167], v[108:111], v[236:239]
    ds_read_b64_tr_b16 v[160:161], v9 offset:18688
    ds_read_b64_tr_b16 v[162:163], v9 offset:20992
    s_waitcnt lgkmcnt(12)
    v_mfma_f32_16x16x32_bf16 v[168:171], v[128:131], v[112:115], v[168:171]
    v_mfma_f32_16x16x32_bf16 v[204:207], v[128:131], v[116:119], v[204:207]
    ds_read_b64_tr_b16 v[164:165], v9 offset:27648
    ds_read_b64_tr_b16 v[166:167], v9 offset:29952
    v_mfma_f32_16x16x32_bf16 v[172:175], v[132:135], v[112:115], v[172:175]
    v_mfma_f32_16x16x32_bf16 v[208:211], v[132:135], v[116:119], v[208:211]
    ds_read_b64_tr_b16 v[128:129], v9 offset:27680
    ds_read_b64_tr_b16 v[130:131], v9 offset:29984
    v_mfma_f32_16x16x32_bf16 v[176:179], v[136:139], v[112:115], v[176:179]
    v_mfma_f32_16x16x32_bf16 v[212:215], v[136:139], v[116:119], v[212:215]
    ds_read_b64_tr_b16 v[132:133], v9 offset:27712
    ds_read_b64_tr_b16 v[134:135], v9 offset:30016
    s_waitcnt lgkmcnt(12)
    v_mfma_f32_16x16x32_bf16 v[180:183], v[140:143], v[112:115], v[180:183]
    v_mfma_f32_16x16x32_bf16 v[216:219], v[140:143], v[116:119], v[216:219]
    ds_read_b64_tr_b16 v[136:137], v9 offset:27744
    ds_read_b64_tr_b16 v[138:139], v9 offset:30048
    v_mfma_f32_16x16x32_bf16 v[184:187], v[144:147], v[112:115], v[184:187]
    v_mfma_f32_16x16x32_bf16 v[220:223], v[144:147], v[116:119], v[220:223]
    ds_read_b64_tr_b16 v[140:141], v9 offset:27776
    ds_read_b64_tr_b16 v[142:143], v9 offset:30080
    ds_write_b128 v3, v[32:35] offset:0
    ds_write_b128 v3, v[36:39] offset:1024
    ds_read_b128 v[96:99], v241
    ds_read_b128 v[104:107], v242
    ds_write_b128 v3, v[40:43] offset:0
    ds_write_b128 v3, v[44:47] offset:1024
    ds_read_b128 v[100:103], v241
    ds_read_b128 v[108:111], v242
    v_mfma_f32_16x16x32_bf16 v[188:191], v[148:151], v[112:115], v[188:191]
    v_mfma_f32_16x16x32_bf16 v[224:227], v[148:151], v[116:119], v[224:227]
    ds_read_b64_tr_b16 v[144:145], v9 offset:27808
    ds_read_b64_tr_b16 v[146:147], v9 offset:30112
    s_waitcnt lgkmcnt(15)
    v_mfma_f32_16x16x32_bf16 v[192:195], v[152:155], v[112:115], v[192:195]
    v_mfma_f32_16x16x32_bf16 v[228:231], v[152:155], v[116:119], v[228:231]
    ds_read_b64_tr_b16 v[148:149], v9 offset:27840
    ds_read_b64_tr_b16 v[150:151], v9 offset:30144
    v_mfma_f32_16x16x32_bf16 v[196:199], v[156:159], v[112:115], v[196:199]
    v_mfma_f32_16x16x32_bf16 v[232:235], v[156:159], v[116:119], v[232:235]
    ds_read_b64_tr_b16 v[152:153], v9 offset:27872
    ds_read_b64_tr_b16 v[154:155], v9 offset:30176
    v_mfma_f32_16x16x32_bf16 v[200:203], v[160:163], v[112:115], v[200:203]
    v_mfma_f32_16x16x32_bf16 v[236:239], v[160:163], v[116:119], v[236:239]
    ds_read_b64_tr_b16 v[156:157], v9 offset:27904
    ds_read_b64_tr_b16 v[158:159], v9 offset:30208
    s_waitcnt vmcnt(5)
    s_barrier
    s_waitcnt lgkmcnt(15)
    v_mfma_f32_16x16x32_bf16 v[168:171], v[164:167], v[120:123], v[168:171]
    v_mfma_f32_16x16x32_bf16 v[204:207], v[164:167], v[124:127], v[204:207]
    ds_read_b64_tr_b16 v[160:161], v240 offset:0
    ds_read_b64_tr_b16 v[162:163], v240 offset:2304
    s_add_u32 m0, s8, 0x0
    s_mov_b32 s10, 0x1b0000
    buffer_load_dwordx4 v4, s[52:55], s10 offen lds
    v_mfma_f32_16x16x32_bf16 v[172:175], v[128:131], v[120:123], v[172:175]
    v_mfma_f32_16x16x32_bf16 v[208:211], v[128:131], v[124:127], v[208:211]
    ds_read_b64_tr_b16 v[164:165], v240 offset:32
    ds_read_b64_tr_b16 v[166:167], v240 offset:2336
    s_add_u32 m0, s8, 0x400
    s_mov_b32 s10, 0x1b0000
    buffer_load_dwordx4 v5, s[52:55], s10 offen lds
    v_mfma_f32_16x16x32_bf16 v[176:179], v[132:135], v[120:123], v[176:179]
    v_mfma_f32_16x16x32_bf16 v[212:215], v[132:135], v[124:127], v[212:215]
    ds_read_b64_tr_b16 v[128:129], v240 offset:64
    ds_read_b64_tr_b16 v[130:131], v240 offset:2368
    s_add_u32 m0, s8, 0x800
    s_mov_b32 s10, 0x1b0000
    buffer_load_dwordx4 v6, s[52:55], s10 offen lds
    s_waitcnt lgkmcnt(12)
    v_mfma_f32_16x16x32_bf16 v[180:183], v[136:139], v[120:123], v[180:183]
    v_mfma_f32_16x16x32_bf16 v[216:219], v[136:139], v[124:127], v[216:219]
    ds_read_b64_tr_b16 v[132:133], v240 offset:96
    ds_read_b64_tr_b16 v[134:135], v240 offset:2400
    s_add_u32 m0, s8, 0xc00
    s_mov_b32 s10, 0x1b0000
    buffer_load_dwordx4 v7, s[52:55], s10 offen lds
    v_mfma_f32_16x16x32_bf16 v[184:187], v[140:143], v[120:123], v[184:187]
    v_mfma_f32_16x16x32_bf16 v[220:223], v[140:143], v[124:127], v[220:223]
    ds_read_b64_tr_b16 v[136:137], v240 offset:128
    ds_read_b64_tr_b16 v[138:139], v240 offset:2432
    s_add_u32 m0, s9, 0x4000
    s_mov_b32 exec_hi, 0
    buffer_load_dwordx4 v8, s[52:55], s10 offen lds
    s_mov_b32 exec_hi, -1
    v_mfma_f32_16x16x32_bf16 v[188:191], v[144:147], v[120:123], v[188:191]
    v_mfma_f32_16x16x32_bf16 v[224:227], v[144:147], v[124:127], v[224:227]
    ds_read_b64_tr_b16 v[140:141], v240 offset:160
    ds_read_b64_tr_b16 v[142:143], v240 offset:2464
    s_waitcnt lgkmcnt(12)
    v_mfma_f32_16x16x32_bf16 v[192:195], v[148:151], v[120:123], v[192:195]
    v_mfma_f32_16x16x32_bf16 v[228:231], v[148:151], v[124:127], v[228:231]
    ds_read_b64_tr_b16 v[144:145], v240 offset:192
    ds_read_b64_tr_b16 v[146:147], v240 offset:2496
    v_mfma_f32_16x16x32_bf16 v[196:199], v[152:155], v[120:123], v[196:199]
    v_mfma_f32_16x16x32_bf16 v[232:235], v[152:155], v[124:127], v[232:235]
    ds_read_b64_tr_b16 v[148:149], v240 offset:224
    ds_read_b64_tr_b16 v[150:151], v240 offset:2528
    v_mfma_f32_16x16x32_bf16 v[200:203], v[156:159], v[120:123], v[200:203]
    v_mfma_f32_16x16x32_bf16 v[236:239], v[156:159], v[124:127], v[236:239]
    ds_read_b64_tr_b16 v[152:153], v240 offset:256
    ds_read_b64_tr_b16 v[154:155], v240 offset:2560
    s_waitcnt lgkmcnt(12)
    v_mfma_f32_16x16x32_bf16 v[168:171], v[160:163], v[96:99], v[168:171]
    v_mfma_f32_16x16x32_bf16 v[204:207], v[160:163], v[100:103], v[204:207]
    ds_read_b64_tr_b16 v[156:157], v240 offset:9216
    ds_read_b64_tr_b16 v[158:159], v240 offset:11520
    v_mfma_f32_16x16x32_bf16 v[172:175], v[164:167], v[96:99], v[172:175]
    v_mfma_f32_16x16x32_bf16 v[208:211], v[164:167], v[100:103], v[208:211]
    ds_read_b64_tr_b16 v[160:161], v240 offset:9248
    ds_read_b64_tr_b16 v[162:163], v240 offset:11552
    v_mfma_f32_16x16x32_bf16 v[176:179], v[128:131], v[96:99], v[176:179]
    v_mfma_f32_16x16x32_bf16 v[212:215], v[128:131], v[100:103], v[212:215]
    ds_read_b64_tr_b16 v[164:165], v240 offset:9280
    ds_read_b64_tr_b16 v[166:167], v240 offset:11584
    s_waitcnt lgkmcnt(12)
    v_mfma_f32_16x16x32_bf16 v[180:183], v[132:135], v[96:99], v[180:183]
    v_mfma_f32_16x16x32_bf16 v[216:219], v[132:135], v[100:103], v[216:219]
    ds_read_b64_tr_b16 v[128:129], v240 offset:9312
    ds_read_b64_tr_b16 v[130:131], v240 offset:11616
    v_mfma_f32_16x16x32_bf16 v[184:187], v[136:139], v[96:99], v[184:187]
    v_mfma_f32_16x16x32_bf16 v[220:223], v[136:139], v[100:103], v[220:223]
    ds_read_b64_tr_b16 v[132:133], v240 offset:9344
    ds_read_b64_tr_b16 v[134:135], v240 offset:11648
    ds_write_b128 v3, v[48:51] offset:0
    ds_write_b128 v3, v[52:55] offset:1024
    ds_read_b128 v[112:115], v241
    ds_read_b128 v[120:123], v242
    ds_write_b128 v3, v[56:59] offset:0
    ds_write_b128 v3, v[60:63] offset:1024
    ds_read_b128 v[116:119], v241
    ds_read_b128 v[124:127], v242
    v_mfma_f32_16x16x32_bf16 v[188:191], v[140:143], v[96:99], v[188:191]
    v_mfma_f32_16x16x32_bf16 v[224:227], v[140:143], v[100:103], v[224:227]
    ds_read_b64_tr_b16 v[136:137], v240 offset:9376
    ds_read_b64_tr_b16 v[138:139], v240 offset:11680
    s_waitcnt lgkmcnt(15)
    v_mfma_f32_16x16x32_bf16 v[192:195], v[144:147], v[96:99], v[192:195]
    v_mfma_f32_16x16x32_bf16 v[228:231], v[144:147], v[100:103], v[228:231]
    ds_read_b64_tr_b16 v[140:141], v240 offset:9408
    ds_read_b64_tr_b16 v[142:143], v240 offset:11712
    v_mfma_f32_16x16x32_bf16 v[196:199], v[148:151], v[96:99], v[196:199]
    v_mfma_f32_16x16x32_bf16 v[232:235], v[148:151], v[100:103], v[232:235]
    ds_read_b64_tr_b16 v[144:145], v240 offset:9440
    ds_read_b64_tr_b16 v[146:147], v240 offset:11744
    v_mfma_f32_16x16x32_bf16 v[200:203], v[152:155], v[96:99], v[200:203]
    v_mfma_f32_16x16x32_bf16 v[236:239], v[152:155], v[100:103], v[236:239]
    ds_read_b64_tr_b16 v[148:149], v240 offset:9472
    ds_read_b64_tr_b16 v[150:151], v240 offset:11776
    s_waitcnt vmcnt(5)
    s_barrier
    s_waitcnt lgkmcnt(15)
    v_mfma_f32_16x16x32_bf16 v[168:171], v[156:159], v[104:107], v[168:171]
    v_mfma_f32_16x16x32_bf16 v[204:207], v[156:159], v[108:111], v[204:207]
    ds_read_b64_tr_b16 v[152:153], v240 offset:18432
    ds_read_b64_tr_b16 v[154:155], v240 offset:20736
    v_mfma_f32_16x16x32_bf16 v[172:175], v[160:163], v[104:107], v[172:175]
    v_mfma_f32_16x16x32_bf16 v[208:211], v[160:163], v[108:111], v[208:211]
    ds_read_b64_tr_b16 v[156:157], v240 offset:18464
    ds_read_b64_tr_b16 v[158:159], v240 offset:20768
    v_mfma_f32_16x16x32_bf16 v[176:179], v[164:167], v[104:107], v[176:179]
    v_mfma_f32_16x16x32_bf16 v[212:215], v[164:167], v[108:111], v[212:215]
    ds_read_b64_tr_b16 v[160:161], v240 offset:18496
    ds_read_b64_tr_b16 v[162:163], v240 offset:20800
    s_waitcnt lgkmcnt(12)
    v_mfma_f32_16x16x32_bf16 v[180:183], v[128:131], v[104:107], v[180:183]
    v_mfma_f32_16x16x32_bf16 v[216:219], v[128:131], v[108:111], v[216:219]
    ds_read_b64_tr_b16 v[164:165], v240 offset:18528
    ds_read_b64_tr_b16 v[166:167], v240 offset:20832
    v_mfma_f32_16x16x32_bf16 v[184:187], v[132:135], v[104:107], v[184:187]
    v_mfma_f32_16x16x32_bf16 v[220:223], v[132:135], v[108:111], v[220:223]
    ds_read_b64_tr_b16 v[128:129], v240 offset:18560
    ds_read_b64_tr_b16 v[130:131], v240 offset:20864
    v_mfma_f32_16x16x32_bf16 v[188:191], v[136:139], v[104:107], v[188:191]
    v_mfma_f32_16x16x32_bf16 v[224:227], v[136:139], v[108:111], v[224:227]
    ds_read_b64_tr_b16 v[132:133], v240 offset:18592
    ds_read_b64_tr_b16 v[134:135], v240 offset:20896
    s_waitcnt lgkmcnt(12)
    v_mfma_f32_16x16x32_bf16 v[192:195], v[140:143], v[104:107], v[192:195]
    v_mfma_f32_16x16x32_bf16 v[228:231], v[140:143], v[108:111], v[228:231]
    ds_read_b64_tr_b16 v[136:137], v240 offset:18624
    ds_read_b64_tr_b16 v[138:139], v240 offset:20928
    v_mfma_f32_16x16x32_bf16 v[196:199], v[144:147], v[104:107], v[196:199]
    v_mfma_f32_16x16x32_bf16 v[232:235], v[144:147], v[108:111], v[232:235]
    ds_read_b64_tr_b16 v[140:141], v240 offset:18656
    ds_read_b64_tr_b16 v[142:143], v240 offset:20960
    v_mfma_f32_16x16x32_bf16 v[200:203], v[148:151], v[104:107], v[200:203]
    v_mfma_f32_16x16x32_bf16 v[236:239], v[148:151], v[108:111], v[236:239]
    ds_read_b64_tr_b16 v[144:145], v240 offset:18688
    ds_read_b64_tr_b16 v[146:147], v240 offset:20992
    s_waitcnt lgkmcnt(12)
    v_mfma_f32_16x16x32_bf16 v[168:171], v[152:155], v[112:115], v[168:171]
    v_mfma_f32_16x16x32_bf16 v[204:207], v[152:155], v[116:119], v[204:207]
    ds_read_b64_tr_b16 v[148:149], v240 offset:27648
    ds_read_b64_tr_b16 v[150:151], v240 offset:29952
    v_mfma_f32_16x16x32_bf16 v[172:175], v[156:159], v[112:115], v[172:175]
    v_mfma_f32_16x16x32_bf16 v[208:211], v[156:159], v[116:119], v[208:211]
    ds_read_b64_tr_b16 v[152:153], v240 offset:27680
    ds_read_b64_tr_b16 v[154:155], v240 offset:29984
    v_mfma_f32_16x16x32_bf16 v[176:179], v[160:163], v[112:115], v[176:179]
    v_mfma_f32_16x16x32_bf16 v[212:215], v[160:163], v[116:119], v[212:215]
    ds_read_b64_tr_b16 v[156:157], v240 offset:27712
    ds_read_b64_tr_b16 v[158:159], v240 offset:30016
    s_waitcnt lgkmcnt(12)
    v_mfma_f32_16x16x32_bf16 v[180:183], v[164:167], v[112:115], v[180:183]
    v_mfma_f32_16x16x32_bf16 v[216:219], v[164:167], v[116:119], v[216:219]
    ds_read_b64_tr_b16 v[160:161], v240 offset:27744
    ds_read_b64_tr_b16 v[162:163], v240 offset:30048
    v_mfma_f32_16x16x32_bf16 v[184:187], v[128:131], v[112:115], v[184:187]
    v_mfma_f32_16x16x32_bf16 v[220:223], v[128:131], v[116:119], v[220:223]
    ds_read_b64_tr_b16 v[164:165], v240 offset:27776
    ds_read_b64_tr_b16 v[166:167], v240 offset:30080
    ds_write_b128 v3, v[64:67] offset:0
    ds_write_b128 v3, v[68:71] offset:1024
    ds_read_b128 v[96:99], v241
    ds_read_b128 v[104:107], v242
    ds_write_b128 v3, v[72:75] offset:0
    ds_write_b128 v3, v[76:79] offset:1024
    ds_read_b128 v[100:103], v241
    ds_read_b128 v[108:111], v242
    v_mfma_f32_16x16x32_bf16 v[188:191], v[132:135], v[112:115], v[188:191]
    v_mfma_f32_16x16x32_bf16 v[224:227], v[132:135], v[116:119], v[224:227]
    ds_read_b64_tr_b16 v[128:129], v240 offset:27808
    ds_read_b64_tr_b16 v[130:131], v240 offset:30112
    s_waitcnt lgkmcnt(15)
    v_mfma_f32_16x16x32_bf16 v[192:195], v[136:139], v[112:115], v[192:195]
    v_mfma_f32_16x16x32_bf16 v[228:231], v[136:139], v[116:119], v[228:231]
    ds_read_b64_tr_b16 v[132:133], v240 offset:27840
    ds_read_b64_tr_b16 v[134:135], v240 offset:30144
    v_mfma_f32_16x16x32_bf16 v[196:199], v[140:143], v[112:115], v[196:199]
    v_mfma_f32_16x16x32_bf16 v[232:235], v[140:143], v[116:119], v[232:235]
    ds_read_b64_tr_b16 v[136:137], v240 offset:27872
    ds_read_b64_tr_b16 v[138:139], v240 offset:30176
    v_mfma_f32_16x16x32_bf16 v[200:203], v[144:147], v[112:115], v[200:203]
    v_mfma_f32_16x16x32_bf16 v[236:239], v[144:147], v[116:119], v[236:239]
    ds_read_b64_tr_b16 v[140:141], v240 offset:27904
    ds_read_b64_tr_b16 v[142:143], v240 offset:30208
    s_waitcnt vmcnt(0)
    s_barrier
    s_waitcnt lgkmcnt(15)
    v_mfma_f32_16x16x32_bf16 v[168:171], v[148:151], v[120:123], v[168:171]
    v_mfma_f32_16x16x32_bf16 v[204:207], v[148:151], v[124:127], v[204:207]
    ds_read_b64_tr_b16 v[144:145], v9 offset:0
    ds_read_b64_tr_b16 v[146:147], v9 offset:2304
    v_mfma_f32_16x16x32_bf16 v[172:175], v[152:155], v[120:123], v[172:175]
    v_mfma_f32_16x16x32_bf16 v[208:211], v[152:155], v[124:127], v[208:211]
    ds_read_b64_tr_b16 v[148:149], v9 offset:32
    ds_read_b64_tr_b16 v[150:151], v9 offset:2336
    v_mfma_f32_16x16x32_bf16 v[176:179], v[156:159], v[120:123], v[176:179]
    v_mfma_f32_16x16x32_bf16 v[212:215], v[156:159], v[124:127], v[212:215]
    ds_read_b64_tr_b16 v[152:153], v9 offset:64
    ds_read_b64_tr_b16 v[154:155], v9 offset:2368
    s_waitcnt lgkmcnt(12)
    v_mfma_f32_16x16x32_bf16 v[180:183], v[160:163], v[120:123], v[180:183]
    v_mfma_f32_16x16x32_bf16 v[216:219], v[160:163], v[124:127], v[216:219]
    ds_read_b64_tr_b16 v[156:157], v9 offset:96
    ds_read_b64_tr_b16 v[158:159], v9 offset:2400
    v_mfma_f32_16x16x32_bf16 v[184:187], v[164:167], v[120:123], v[184:187]
    v_mfma_f32_16x16x32_bf16 v[220:223], v[164:167], v[124:127], v[220:223]
    ds_read_b64_tr_b16 v[160:161], v9 offset:128
    ds_read_b64_tr_b16 v[162:163], v9 offset:2432
    v_mfma_f32_16x16x32_bf16 v[188:191], v[128:131], v[120:123], v[188:191]
    v_mfma_f32_16x16x32_bf16 v[224:227], v[128:131], v[124:127], v[224:227]
    ds_read_b64_tr_b16 v[164:165], v9 offset:160
    ds_read_b64_tr_b16 v[166:167], v9 offset:2464
    s_waitcnt lgkmcnt(12)
    v_mfma_f32_16x16x32_bf16 v[192:195], v[132:135], v[120:123], v[192:195]
    v_mfma_f32_16x16x32_bf16 v[228:231], v[132:135], v[124:127], v[228:231]
    ds_read_b64_tr_b16 v[128:129], v9 offset:192
    ds_read_b64_tr_b16 v[130:131], v9 offset:2496
    v_mfma_f32_16x16x32_bf16 v[196:199], v[136:139], v[120:123], v[196:199]
    v_mfma_f32_16x16x32_bf16 v[232:235], v[136:139], v[124:127], v[232:235]
    ds_read_b64_tr_b16 v[132:133], v9 offset:224
    ds_read_b64_tr_b16 v[134:135], v9 offset:2528
    v_mfma_f32_16x16x32_bf16 v[200:203], v[140:143], v[120:123], v[200:203]
    v_mfma_f32_16x16x32_bf16 v[236:239], v[140:143], v[124:127], v[236:239]
    ds_read_b64_tr_b16 v[136:137], v9 offset:256
    ds_read_b64_tr_b16 v[138:139], v9 offset:2560
    s_waitcnt lgkmcnt(12)
    v_mfma_f32_16x16x32_bf16 v[168:171], v[144:147], v[96:99], v[168:171]
    v_mfma_f32_16x16x32_bf16 v[204:207], v[144:147], v[100:103], v[204:207]
    ds_read_b64_tr_b16 v[140:141], v9 offset:9216
    ds_read_b64_tr_b16 v[142:143], v9 offset:11520
    v_mfma_f32_16x16x32_bf16 v[172:175], v[148:151], v[96:99], v[172:175]
    v_mfma_f32_16x16x32_bf16 v[208:211], v[148:151], v[100:103], v[208:211]
    ds_read_b64_tr_b16 v[144:145], v9 offset:9248
    ds_read_b64_tr_b16 v[146:147], v9 offset:11552
    v_mfma_f32_16x16x32_bf16 v[176:179], v[152:155], v[96:99], v[176:179]
    v_mfma_f32_16x16x32_bf16 v[212:215], v[152:155], v[100:103], v[212:215]
    ds_read_b64_tr_b16 v[148:149], v9 offset:9280
    ds_read_b64_tr_b16 v[150:151], v9 offset:11584
    s_waitcnt lgkmcnt(12)
    v_mfma_f32_16x16x32_bf16 v[180:183], v[156:159], v[96:99], v[180:183]
    v_mfma_f32_16x16x32_bf16 v[216:219], v[156:159], v[100:103], v[216:219]
    ds_read_b64_tr_b16 v[152:153], v9 offset:9312
    ds_read_b64_tr_b16 v[154:155], v9 offset:11616
    v_mfma_f32_16x16x32_bf16 v[184:187], v[160:163], v[96:99], v[184:187]
    v_mfma_f32_16x16x32_bf16 v[220:223], v[160:163], v[100:103], v[220:223]
    ds_read_b64_tr_b16 v[156:157], v9 offset:9344
    ds_read_b64_tr_b16 v[158:159], v9 offset:11648
    v_mfma_f32_16x16x32_bf16 v[188:191], v[164:167], v[96:99], v[188:191]
    v_mfma_f32_16x16x32_bf16 v[224:227], v[164:167], v[100:103], v[224:227]
    ds_read_b64_tr_b16 v[160:161], v9 offset:9376
    ds_read_b64_tr_b16 v[162:163], v9 offset:11680
    s_waitcnt lgkmcnt(12)
    v_mfma_f32_16x16x32_bf16 v[192:195], v[128:131], v[96:99], v[192:195]
    v_mfma_f32_16x16x32_bf16 v[228:231], v[128:131], v[100:103], v[228:231]
    ds_read_b64_tr_b16 v[164:165], v9 offset:9408
    ds_read_b64_tr_b16 v[166:167], v9 offset:11712
    v_mfma_f32_16x16x32_bf16 v[196:199], v[132:135], v[96:99], v[196:199]
    v_mfma_f32_16x16x32_bf16 v[232:235], v[132:135], v[100:103], v[232:235]
    ds_read_b64_tr_b16 v[128:129], v9 offset:9440
    ds_read_b64_tr_b16 v[130:131], v9 offset:11744
    v_mfma_f32_16x16x32_bf16 v[200:203], v[136:139], v[96:99], v[200:203]
    v_mfma_f32_16x16x32_bf16 v[236:239], v[136:139], v[100:103], v[236:239]
    ds_read_b64_tr_b16 v[132:133], v9 offset:9472
    ds_read_b64_tr_b16 v[134:135], v9 offset:11776
    s_waitcnt lgkmcnt(12)
    v_mfma_f32_16x16x32_bf16 v[168:171], v[140:143], v[104:107], v[168:171]
    v_mfma_f32_16x16x32_bf16 v[204:207], v[140:143], v[108:111], v[204:207]
    v_mfma_f32_16x16x32_bf16 v[172:175], v[144:147], v[104:107], v[172:175]
    v_mfma_f32_16x16x32_bf16 v[208:211], v[144:147], v[108:111], v[208:211]
    v_mfma_f32_16x16x32_bf16 v[176:179], v[148:151], v[104:107], v[176:179]
    v_mfma_f32_16x16x32_bf16 v[212:215], v[148:151], v[108:111], v[212:215]
    s_waitcnt lgkmcnt(6)
    v_mfma_f32_16x16x32_bf16 v[180:183], v[152:155], v[104:107], v[180:183]
    v_mfma_f32_16x16x32_bf16 v[216:219], v[152:155], v[108:111], v[216:219]
    v_mfma_f32_16x16x32_bf16 v[184:187], v[156:159], v[104:107], v[184:187]
    v_mfma_f32_16x16x32_bf16 v[220:223], v[156:159], v[108:111], v[220:223]
    v_mfma_f32_16x16x32_bf16 v[188:191], v[160:163], v[104:107], v[188:191]
    v_mfma_f32_16x16x32_bf16 v[224:227], v[160:163], v[108:111], v[224:227]
    s_waitcnt lgkmcnt(0)
    v_mfma_f32_16x16x32_bf16 v[192:195], v[164:167], v[104:107], v[192:195]
    v_mfma_f32_16x16x32_bf16 v[228:231], v[164:167], v[108:111], v[228:231]
    v_mfma_f32_16x16x32_bf16 v[196:199], v[128:131], v[104:107], v[196:199]
    v_mfma_f32_16x16x32_bf16 v[232:235], v[128:131], v[108:111], v[232:235]
    v_mfma_f32_16x16x32_bf16 v[200:203], v[132:135], v[104:107], v[200:203]
    v_mfma_f32_16x16x32_bf16 v[236:239], v[132:135], v[108:111], v[236:239]
    s_nop 9
    s_setprio 0
    s_mul_i32 s15, s3, 9728
    v_mul_u32_u24 v12, 304, v10
    v_lshl_add_u32 v12, v11, 3, v12
    v_add_u32 v12, s15, v12
    s_mul_i32 s64, s14, 1152
    s_add_u32 s64, s64, s12
    s_barrier

    v_mov_b32 v243, -1
    v_cvt_pk_bf16_f32 v96, v168, v169
    v_cvt_pk_bf16_f32 v102, v170, v171
    v_cvt_pk_bf16_f32 v108, v172, v173
    v_cvt_pk_bf16_f32 v114, v174, v175
    v_cvt_pk_bf16_f32 v120, v176, v177
    v_cvt_pk_bf16_f32 v126, v178, v179
    v_lshlrev_b32 v98, 16, v96
    v_and_b32 v99, 0xffff0000, v96
    v_lshlrev_b32 v104, 16, v102
    v_and_b32 v105, 0xffff0000, v102
    v_lshlrev_b32 v110, 16, v108
    v_and_b32 v111, 0xffff0000, v108
    v_lshlrev_b32 v116, 16, v114
    v_and_b32 v117, 0xffff0000, v114
    v_lshlrev_b32 v122, 16, v120
    v_and_b32 v123, 0xffff0000, v120
    v_lshlrev_b32 v128, 16, v126
    v_and_b32 v129, 0xffff0000, v126
    v_pk_mul_f32 v[100:101], v[98:99], s[60:61]
    v_pk_mul_f32 v[106:107], v[104:105], s[60:61]
    v_pk_mul_f32 v[112:113], v[110:111], s[60:61]
    v_pk_mul_f32 v[118:119], v[116:117], s[60:61]
    v_pk_mul_f32 v[124:125], v[122:123], s[60:61]
    v_pk_mul_f32 v[130:131], v[128:129], s[60:61]
    v_exp_f32_e64 v100, v100 clamp
    v_exp_f32_e64 v101, v101 clamp
    v_exp_f32_e64 v106, v106 clamp
    v_exp_f32_e64 v107, v107 clamp
    v_exp_f32_e64 v112, v112 clamp
    v_exp_f32_e64 v113, v113 clamp
    v_exp_f32_e64 v118, v118 clamp
    v_exp_f32_e64 v119, v119 clamp
    v_exp_f32_e64 v124, v124 clamp
    v_exp_f32_e64 v125, v125 clamp
    v_exp_f32_e64 v130, v130 clamp
    v_exp_f32_e64 v131, v131 clamp
    v_max_f32 v98, 0, v98
    v_max_f32 v99, 0, v99
    v_max_f32 v104, 0, v104
    v_max_f32 v105, 0, v105
    v_max_f32 v110, 0, v110
    v_max_f32 v111, 0, v111
    v_max_f32 v116, 0, v116
    v_max_f32 v117, 0, v117
    v_max_f32 v122, 0, v122
    v_max_f32 v123, 0, v123
    v_max_f32 v128, 0, v128
    v_max_f32 v129, 0, v129
    v_pk_add_f32 v[100:101], v[100:101], v[98:99]
    v_pk_add_f32 v[106:107], v[106:107], v[104:105]
    v_pk_add_f32 v[112:113], v[112:113], v[110:111]
    v_pk_add_f32 v[118:119], v[118:119], v[116:117]
    v_pk_add_f32 v[124:125], v[124:125], v[122:123]
    v_pk_add_f32 v[130:131], v[130:131], v[128:129]
    v_cvt_pk_bf16_f32 v16, v100, v101
    v_cvt_pk_bf16_f32 v17, v106, v107
    v_cvt_pk_bf16_f32 v18, v112, v113
    v_cvt_pk_bf16_f32 v19, v118, v119
    v_cvt_pk_bf16_f32 v20, v124, v125
    v_cvt_pk_bf16_f32 v21, v130, v131
    v_pk_min_u16 v243, v243, v16
    v_pk_min_u16 v243, v243, v17
    v_pk_min_u16 v243, v243, v18
    v_pk_min_u16 v243, v243, v19
    v_pk_min_u16 v243, v243, v20
    v_pk_min_u16 v243, v243, v21
    v_cvt_pk_bf16_f32 v96, v180, v181
    v_cvt_pk_bf16_f32 v102, v182, v183
    v_cvt_pk_bf16_f32 v108, v184, v185
    v_cvt_pk_bf16_f32 v114, v186, v187
    v_cvt_pk_bf16_f32 v120, v188, v189
    v_cvt_pk_bf16_f32 v126, v190, v191
    v_lshlrev_b32 v98, 16, v96
    v_and_b32 v99, 0xffff0000, v96
    v_lshlrev_b32 v104, 16, v102
    v_and_b32 v105, 0xffff0000, v102
    v_lshlrev_b32 v110, 16, v108
    v_and_b32 v111, 0xffff0000, v108
    v_lshlrev_b32 v116, 16, v114
    v_and_b32 v117, 0xffff0000, v114
    v_lshlrev_b32 v122, 16, v120
    v_and_b32 v123, 0xffff0000, v120
    v_lshlrev_b32 v128, 16, v126
    v_and_b32 v129, 0xffff0000, v126
    v_pk_mul_f32 v[100:101], v[98:99], s[60:61]
    v_pk_mul_f32 v[106:107], v[104:105], s[60:61]
    v_pk_mul_f32 v[112:113], v[110:111], s[60:61]
    v_pk_mul_f32 v[118:119], v[116:117], s[60:61]
    v_pk_mul_f32 v[124:125], v[122:123], s[60:61]
    v_pk_mul_f32 v[130:131], v[128:129], s[60:61]
    v_exp_f32_e64 v100, v100 clamp
    v_exp_f32_e64 v101, v101 clamp
    v_exp_f32_e64 v106, v106 clamp
    v_exp_f32_e64 v107, v107 clamp
    v_exp_f32_e64 v112, v112 clamp
    v_exp_f32_e64 v113, v113 clamp
    v_exp_f32_e64 v118, v118 clamp
    v_exp_f32_e64 v119, v119 clamp
    v_exp_f32_e64 v124, v124 clamp
    v_exp_f32_e64 v125, v125 clamp
    v_exp_f32_e64 v130, v130 clamp
    v_exp_f32_e64 v131, v131 clamp
    v_max_f32 v98, 0, v98
    v_max_f32 v99, 0, v99
    v_max_f32 v104, 0, v104
    v_max_f32 v105, 0, v105
    v_max_f32 v110, 0, v110
    v_max_f32 v111, 0, v111
    v_max_f32 v116, 0, v116
    v_max_f32 v117, 0, v117
    v_max_f32 v122, 0, v122
    v_max_f32 v123, 0, v123
    v_max_f32 v128, 0, v128
    v_max_f32 v129, 0, v129
    v_pk_add_f32 v[100:101], v[100:101], v[98:99]
    v_pk_add_f32 v[106:107], v[106:107], v[104:105]
    v_pk_add_f32 v[112:113], v[112:113], v[110:111]
    v_pk_add_f32 v[118:119], v[118:119], v[116:117]
    v_pk_add_f32 v[124:125], v[124:125], v[122:123]
    v_pk_add_f32 v[130:131], v[130:131], v[128:129]
    v_cvt_pk_bf16_f32 v22, v100, v101
    v_cvt_pk_bf16_f32 v23, v106, v107
    v_cvt_pk_bf16_f32 v24, v112, v113
    v_cvt_pk_bf16_f32 v25, v118, v119
    v_cvt_pk_bf16_f32 v26, v124, v125
    v_cvt_pk_bf16_f32 v27, v130, v131
    v_pk_min_u16 v243, v243, v22
    v_pk_min_u16 v243, v243, v23
    v_pk_min_u16 v243, v243, v24
    v_pk_min_u16 v243, v243, v25
    v_pk_min_u16 v243, v243, v26
    v_pk_min_u16 v243, v243, v27
    v_cvt_pk_bf16_f32 v96, v192, v193
    v_cvt_pk_bf16_f32 v102, v194, v195
    v_cvt_pk_bf16_f32 v108, v196, v197
    v_cvt_pk_bf16_f32 v114, v198, v199
    v_cvt_pk_bf16_f32 v120, v200, v201
    v_cvt_pk_bf16_f32 v126, v202, v203
    v_lshlrev_b32 v98, 16, v96
    v_and_b32 v99, 0xffff0000, v96
    v_lshlrev_b32 v104, 16, v102
    v_and_b32 v105, 0xffff0000, v102
    v_lshlrev_b32 v110, 16, v108
    v_and_b32 v111, 0xffff0000, v108
    v_lshlrev_b32 v116, 16, v114
    v_and_b32 v117, 0xffff0000, v114
    v_lshlrev_b32 v122, 16, v120
    v_and_b32 v123, 0xffff0000, v120
    v_lshlrev_b32 v128, 16, v126
    v_and_b32 v129, 0xffff0000, v126
    v_pk_mul_f32 v[100:101], v[98:99], s[60:61]
    v_pk_mul_f32 v[106:107], v[104:105], s[60:61]
    v_pk_mul_f32 v[112:113], v[110:111], s[60:61]
    v_pk_mul_f32 v[118:119], v[116:117], s[60:61]
    v_pk_mul_f32 v[124:125], v[122:123], s[60:61]
    v_pk_mul_f32 v[130:131], v[128:129], s[60:61]
    v_exp_f32_e64 v100, v100 clamp
    v_exp_f32_e64 v101, v101 clamp
    v_exp_f32_e64 v106, v106 clamp
    v_exp_f32_e64 v107, v107 clamp
    v_exp_f32_e64 v112, v112 clamp
    v_exp_f32_e64 v113, v113 clamp
    v_exp_f32_e64 v118, v118 clamp
    v_exp_f32_e64 v119, v119 clamp
    v_exp_f32_e64 v124, v124 clamp
    v_exp_f32_e64 v125, v125 clamp
    v_exp_f32_e64 v130, v130 clamp
    v_exp_f32_e64 v131, v131 clamp
    v_max_f32 v98, 0, v98
    v_max_f32 v99, 0, v99
    v_max_f32 v104, 0, v104
    v_max_f32 v105, 0, v105
    v_max_f32 v110, 0, v110
    v_max_f32 v111, 0, v111
    v_max_f32 v116, 0, v116
    v_max_f32 v117, 0, v117
    v_max_f32 v122, 0, v122
    v_max_f32 v123, 0, v123
    v_max_f32 v128, 0, v128
    v_max_f32 v129, 0, v129
    v_pk_add_f32 v[100:101], v[100:101], v[98:99]
    v_pk_add_f32 v[106:107], v[106:107], v[104:105]
    v_pk_add_f32 v[112:113], v[112:113], v[110:111]
    v_pk_add_f32 v[118:119], v[118:119], v[116:117]
    v_pk_add_f32 v[124:125], v[124:125], v[122:123]
    v_pk_add_f32 v[130:131], v[130:131], v[128:129]
    v_cvt_pk_bf16_f32 v28, v100, v101
    v_cvt_pk_bf16_f32 v29, v106, v107
    v_cvt_pk_bf16_f32 v30, v112, v113
    v_cvt_pk_bf16_f32 v31, v118, v119
    v_cvt_pk_bf16_f32 v32, v124, v125
    v_cvt_pk_bf16_f32 v33, v130, v131
    v_pk_min_u16 v243, v243, v28
    v_pk_min_u16 v243, v243, v29
    v_pk_min_u16 v243, v243, v30
    v_pk_min_u16 v243, v243, v31
    v_pk_min_u16 v243, v243, v32
    v_pk_min_u16 v243, v243, v33
    v_cvt_pk_bf16_f32 v96, v204, v205
    v_cvt_pk_bf16_f32 v102, v206, v207
    v_cvt_pk_bf16_f32 v108, v208, v209
    v_cvt_pk_bf16_f32 v114, v210, v211
    v_cvt_pk_bf16_f32 v120, v212, v213
    v_cvt_pk_bf16_f32 v126, v214, v215
    v_lshlrev_b32 v98, 16, v96
    v_and_b32 v99, 0xffff0000, v96
    v_lshlrev_b32 v104, 16, v102
    v_and_b32 v105, 0xffff0000, v102
    v_lshlrev_b32 v110, 16, v108
    v_and_b32 v111, 0xffff0000, v108
    v_lshlrev_b32 v116, 16, v114
    v_and_b32 v117, 0xffff0000, v114
    v_lshlrev_b32 v122, 16, v120
    v_and_b32 v123, 0xffff0000, v120
    v_lshlrev_b32 v128, 16, v126
    v_and_b32 v129, 0xffff0000, v126
    v_pk_mul_f32 v[100:101], v[98:99], s[60:61]
    v_pk_mul_f32 v[106:107], v[104:105], s[60:61]
    v_pk_mul_f32 v[112:113], v[110:111], s[60:61]
    v_pk_mul_f32 v[118:119], v[116:117], s[60:61]
    v_pk_mul_f32 v[124:125], v[122:123], s[60:61]
    v_pk_mul_f32 v[130:131], v[128:129], s[60:61]
    v_exp_f32_e64 v100, v100 clamp
    v_exp_f32_e64 v101, v101 clamp
    v_exp_f32_e64 v106, v106 clamp
    v_exp_f32_e64 v107, v107 clamp
    v_exp_f32_e64 v112, v112 clamp
    v_exp_f32_e64 v113, v113 clamp
    v_exp_f32_e64 v118, v118 clamp
    v_exp_f32_e64 v119, v119 clamp
    v_exp_f32_e64 v124, v124 clamp
    v_exp_f32_e64 v125, v125 clamp
    v_exp_f32_e64 v130, v130 clamp
    v_exp_f32_e64 v131, v131 clamp
    v_max_f32 v98, 0, v98
    v_max_f32 v99, 0, v99
    v_max_f32 v104, 0, v104
    v_max_f32 v105, 0, v105
    v_max_f32 v110, 0, v110
    v_max_f32 v111, 0, v111
    v_max_f32 v116, 0, v116
    v_max_f32 v117, 0, v117
    v_max_f32 v122, 0, v122
    v_max_f32 v123, 0, v123
    v_max_f32 v128, 0, v128
    v_max_f32 v129, 0, v129
    v_pk_add_f32 v[100:101], v[100:101], v[98:99]
    v_pk_add_f32 v[106:107], v[106:107], v[104:105]
    v_pk_add_f32 v[112:113], v[112:113], v[110:111]
    v_pk_add_f32 v[118:119], v[118:119], v[116:117]
    v_pk_add_f32 v[124:125], v[124:125], v[122:123]
    v_pk_add_f32 v[130:131], v[130:131], v[128:129]
    v_cvt_pk_bf16_f32 v34, v100, v101
    v_cvt_pk_bf16_f32 v35, v106, v107
    v_cvt_pk_bf16_f32 v36, v112, v113
    v_cvt_pk_bf16_f32 v37, v118, v119
    v_cvt_pk_bf16_f32 v38, v124, v125
    v_cvt_pk_bf16_f32 v39, v130, v131
    v_pk_min_u16 v243, v243, v34
    v_pk_min_u16 v243, v243, v35
    v_pk_min_u16 v243, v243, v36
    v_pk_min_u16 v243, v243, v37
    v_pk_min_u16 v243, v243, v38
    v_pk_min_u16 v243, v243, v39
    v_cvt_pk_bf16_f32 v96, v216, v217
    v_cvt_pk_bf16_f32 v102, v218, v219
    v_cvt_pk_bf16_f32 v108, v220, v221
    v_cvt_pk_bf16_f32 v114, v222, v223
    v_cvt_pk_bf16_f32 v120, v224, v225
    v_cvt_pk_bf16_f32 v126, v226, v227
    v_lshlrev_b32 v98, 16, v96
    v_and_b32 v99, 0xffff0000, v96
    v_lshlrev_b32 v104, 16, v102
    v_and_b32 v105, 0xffff0000, v102
    v_lshlrev_b32 v110, 16, v108
    v_and_b32 v111, 0xffff0000, v108
    v_lshlrev_b32 v116, 16, v114
    v_and_b32 v117, 0xffff0000, v114
    v_lshlrev_b32 v122, 16, v120
    v_and_b32 v123, 0xffff0000, v120
    v_lshlrev_b32 v128, 16, v126
    v_and_b32 v129, 0xffff0000, v126
    v_pk_mul_f32 v[100:101], v[98:99], s[60:61]
    v_pk_mul_f32 v[106:107], v[104:105], s[60:61]
    v_pk_mul_f32 v[112:113], v[110:111], s[60:61]
    v_pk_mul_f32 v[118:119], v[116:117], s[60:61]
    v_pk_mul_f32 v[124:125], v[122:123], s[60:61]
    v_pk_mul_f32 v[130:131], v[128:129], s[60:61]
    v_exp_f32_e64 v100, v100 clamp
    v_exp_f32_e64 v101, v101 clamp
    v_exp_f32_e64 v106, v106 clamp
    v_exp_f32_e64 v107, v107 clamp
    v_exp_f32_e64 v112, v112 clamp
    v_exp_f32_e64 v113, v113 clamp
    v_exp_f32_e64 v118, v118 clamp
    v_exp_f32_e64 v119, v119 clamp
    v_exp_f32_e64 v124, v124 clamp
    v_exp_f32_e64 v125, v125 clamp
    v_exp_f32_e64 v130, v130 clamp
    v_exp_f32_e64 v131, v131 clamp
    v_max_f32 v98, 0, v98
    v_max_f32 v99, 0, v99
    v_max_f32 v104, 0, v104
    v_max_f32 v105, 0, v105
    v_max_f32 v110, 0, v110
    v_max_f32 v111, 0, v111
    v_max_f32 v116, 0, v116
    v_max_f32 v117, 0, v117
    v_max_f32 v122, 0, v122
    v_max_f32 v123, 0, v123
    v_max_f32 v128, 0, v128
    v_max_f32 v129, 0, v129
    v_pk_add_f32 v[100:101], v[100:101], v[98:99]
    v_pk_add_f32 v[106:107], v[106:107], v[104:105]
    v_pk_add_f32 v[112:113], v[112:113], v[110:111]
    v_pk_add_f32 v[118:119], v[118:119], v[116:117]
    v_pk_add_f32 v[124:125], v[124:125], v[122:123]
    v_pk_add_f32 v[130:131], v[130:131], v[128:129]
    v_cvt_pk_bf16_f32 v40, v100, v101
    v_cvt_pk_bf16_f32 v41, v106, v107
    v_cvt_pk_bf16_f32 v42, v112, v113
    v_cvt_pk_bf16_f32 v43, v118, v119
    v_cvt_pk_bf16_f32 v44, v124, v125
    v_cvt_pk_bf16_f32 v45, v130, v131
    v_pk_min_u16 v243, v243, v40
    v_pk_min_u16 v243, v243, v41
    v_pk_min_u16 v243, v243, v42
    v_pk_min_u16 v243, v243, v43
    v_pk_min_u16 v243, v243, v44
    v_pk_min_u16 v243, v243, v45
    v_cvt_pk_bf16_f32 v96, v228, v229
    v_cvt_pk_bf16_f32 v102, v230, v231
    v_cvt_pk_bf16_f32 v108, v232, v233
    v_cvt_pk_bf16_f32 v114, v234, v235
    v_cvt_pk_bf16_f32 v120, v236, v237
    v_cvt_pk_bf16_f32 v126, v238, v239
    v_lshlrev_b32 v98, 16, v96
    v_and_b32 v99, 0xffff0000, v96
    v_lshlrev_b32 v104, 16, v102
    v_and_b32 v105, 0xffff0000, v102
    v_lshlrev_b32 v110, 16, v108
    v_and_b32 v111, 0xffff0000, v108
    v_lshlrev_b32 v116, 16, v114
    v_and_b32 v117, 0xffff0000, v114
    v_lshlrev_b32 v122, 16, v120
    v_and_b32 v123, 0xffff0000, v120
    v_lshlrev_b32 v128, 16, v126
    v_and_b32 v129, 0xffff0000, v126
    v_pk_mul_f32 v[100:101], v[98:99], s[60:61]
    v_pk_mul_f32 v[106:107], v[104:105], s[60:61]
    v_pk_mul_f32 v[112:113], v[110:111], s[60:61]
    v_pk_mul_f32 v[118:119], v[116:117], s[60:61]
    v_pk_mul_f32 v[124:125], v[122:123], s[60:61]
    v_pk_mul_f32 v[130:131], v[128:129], s[60:61]
    v_exp_f32_e64 v100, v100 clamp
    v_exp_f32_e64 v101, v101 clamp
    v_exp_f32_e64 v106, v106 clamp
    v_exp_f32_e64 v107, v107 clamp
    v_exp_f32_e64 v112, v112 clamp
    v_exp_f32_e64 v113, v113 clamp
    v_exp_f32_e64 v118, v118 clamp
    v_exp_f32_e64 v119, v119 clamp
    v_exp_f32_e64 v124, v124 clamp
    v_exp_f32_e64 v125, v125 clamp
    v_exp_f32_e64 v130, v130 clamp
    v_exp_f32_e64 v131, v131 clamp
    v_max_f32 v98, 0, v98
    v_max_f32 v99, 0, v99
    v_max_f32 v104, 0, v104
    v_max_f32 v105, 0, v105
    v_max_f32 v110, 0, v110
    v_max_f32 v111, 0, v111
    v_max_f32 v116, 0, v116
    v_max_f32 v117, 0, v117
    v_max_f32 v122, 0, v122
    v_max_f32 v123, 0, v123
    v_max_f32 v128, 0, v128
    v_max_f32 v129, 0, v129
    v_pk_add_f32 v[100:101], v[100:101], v[98:99]
    v_pk_add_f32 v[106:107], v[106:107], v[104:105]
    v_pk_add_f32 v[112:113], v[112:113], v[110:111]
    v_pk_add_f32 v[118:119], v[118:119], v[116:117]
    v_pk_add_f32 v[124:125], v[124:125], v[122:123]
    v_pk_add_f32 v[130:131], v[130:131], v[128:129]
    v_cvt_pk_bf16_f32 v46, v100, v101
    v_cvt_pk_bf16_f32 v47, v106, v107
    v_cvt_pk_bf16_f32 v48, v112, v113
    v_cvt_pk_bf16_f32 v49, v118, v119
    v_cvt_pk_bf16_f32 v50, v124, v125
    v_cvt_pk_bf16_f32 v51, v130, v131
    v_pk_min_u16 v243, v243, v46
    v_pk_min_u16 v243, v243, v47
    v_pk_min_u16 v243, v243, v48
    v_pk_min_u16 v243, v243, v49
    v_pk_min_u16 v243, v243, v50
    v_pk_min_u16 v243, v243, v51
    v_lshrrev_b32 v96, 16, v243
    v_and_b32 v97, 0xffff, v243
    v_min_u32 v96, v96, v97
    v_cmp_gt_u32 vcc, 0x3a00, v96
    s_cbranch_vccz K1_QFIX

    v_lshlrev_b32 v96, 16, v16
    v_and_b32 v97, 0xffff0000, v16
    v_pk_add_f32 v[96:97], v[96:97], s[62:63]
    v_cvt_pk_bf16_f32 v16, v96, v97
    v_lshlrev_b32 v96, 16, v17
    v_and_b32 v97, 0xffff0000, v17
    v_pk_add_f32 v[96:97], v[96:97], s[62:63]
    v_cvt_pk_bf16_f32 v17, v96, v97
    v_lshlrev_b32 v96, 16, v18
    v_and_b32 v97, 0xffff0000, v18
    v_pk_add_f32 v[96:97], v[96:97], s[62:63]
    v_cvt_pk_bf16_f32 v18, v96, v97
    v_lshlrev_b32 v96, 16, v19
    v_and_b32 v97, 0xffff0000, v19
    v_pk_add_f32 v[96:97], v[96:97], s[62:63]
    v_cvt_pk_bf16_f32 v19, v96, v97
    v_lshlrev_b32 v96, 16, v20
    v_and_b32 v97, 0xffff0000, v20
    v_pk_add_f32 v[96:97], v[96:97], s[62:63]
    v_cvt_pk_bf16_f32 v20, v96, v97
    v_lshlrev_b32 v96, 16, v21
    v_and_b32 v97, 0xffff0000, v21
    v_pk_add_f32 v[96:97], v[96:97], s[62:63]
    v_cvt_pk_bf16_f32 v21, v96, v97
    v_lshlrev_b32 v96, 16, v22
    v_and_b32 v97, 0xffff0000, v22
    v_pk_add_f32 v[96:97], v[96:97], s[62:63]
    v_cvt_pk_bf16_f32 v22, v96, v97
    v_lshlrev_b32 v96, 16, v23
    v_and_b32 v97, 0xffff0000, v23
    v_pk_add_f32 v[96:97], v[96:97], s[62:63]
    v_cvt_pk_bf16_f32 v23, v96, v97
    v_lshlrev_b32 v96, 16, v24
    v_and_b32 v97, 0xffff0000, v24
    v_pk_add_f32 v[96:97], v[96:97], s[62:63]
    v_cvt_pk_bf16_f32 v24, v96, v97
    v_lshlrev_b32 v96, 16, v25
    v_and_b32 v97, 0xffff0000, v25
    v_pk_add_f32 v[96:97], v[96:97], s[62:63]
    v_cvt_pk_bf16_f32 v25, v96, v97
    v_lshlrev_b32 v96, 16, v26
    v_and_b32 v97, 0xffff0000, v26
    v_pk_add_f32 v[96:97], v[96:97], s[62:63]
    v_cvt_pk_bf16_f32 v26, v96, v97
    v_lshlrev_b32 v96, 16, v27
    v_and_b32 v97, 0xffff0000, v27
    v_pk_add_f32 v[96:97], v[96:97], s[62:63]
    v_cvt_pk_bf16_f32 v27, v96, v97
    v_lshlrev_b32 v96, 16, v28
    v_and_b32 v97, 0xffff0000, v28
    v_pk_add_f32 v[96:97], v[96:97], s[62:63]
    v_cvt_pk_bf16_f32 v28, v96, v97
    v_lshlrev_b32 v96, 16, v29
    v_and_b32 v97, 0xffff0000, v29
    v_pk_add_f32 v[96:97], v[96:97], s[62:63]
    v_cvt_pk_bf16_f32 v29, v96, v97
    v_lshlrev_b32 v96, 16, v30
    v_and_b32 v97, 0xffff0000, v30
    v_pk_add_f32 v[96:97], v[96:97], s[62:63]
    v_cvt_pk_bf16_f32 v30, v96, v97
    v_lshlrev_b32 v96, 16, v31
    v_and_b32 v97, 0xffff0000, v31
    v_pk_add_f32 v[96:97], v[96:97], s[62:63]
    v_cvt_pk_bf16_f32 v31, v96, v97
    v_lshlrev_b32 v96, 16, v32
    v_and_b32 v97, 0xffff0000, v32
    v_pk_add_f32 v[96:97], v[96:97], s[62:63]
    v_cvt_pk_bf16_f32 v32, v96, v97
    v_lshlrev_b32 v96, 16, v33
    v_and_b32 v97, 0xffff0000, v33
    v_pk_add_f32 v[96:97], v[96:97], s[62:63]
    v_cvt_pk_bf16_f32 v33, v96, v97
    v_lshlrev_b32 v96, 16, v34
    v_and_b32 v97, 0xffff0000, v34
    v_pk_add_f32 v[96:97], v[96:97], s[62:63]
    v_cvt_pk_bf16_f32 v34, v96, v97
    v_lshlrev_b32 v96, 16, v35
    v_and_b32 v97, 0xffff0000, v35
    v_pk_add_f32 v[96:97], v[96:97], s[62:63]
    v_cvt_pk_bf16_f32 v35, v96, v97
    v_lshlrev_b32 v96, 16, v36
    v_and_b32 v97, 0xffff0000, v36
    v_pk_add_f32 v[96:97], v[96:97], s[62:63]
    v_cvt_pk_bf16_f32 v36, v96, v97
    v_lshlrev_b32 v96, 16, v37
    v_and_b32 v97, 0xffff0000, v37
    v_pk_add_f32 v[96:97], v[96:97], s[62:63]
    v_cvt_pk_bf16_f32 v37, v96, v97
    v_lshlrev_b32 v96, 16, v38
    v_and_b32 v97, 0xffff0000, v38
    v_pk_add_f32 v[96:97], v[96:97], s[62:63]
    v_cvt_pk_bf16_f32 v38, v96, v97
    v_lshlrev_b32 v96, 16, v39
    v_and_b32 v97, 0xffff0000, v39
    v_pk_add_f32 v[96:97], v[96:97], s[62:63]
    v_cvt_pk_bf16_f32 v39, v96, v97
    v_lshlrev_b32 v96, 16, v40
    v_and_b32 v97, 0xffff0000, v40
    v_pk_add_f32 v[96:97], v[96:97], s[62:63]
    v_cvt_pk_bf16_f32 v40, v96, v97
    v_lshlrev_b32 v96, 16, v41
    v_and_b32 v97, 0xffff0000, v41
    v_pk_add_f32 v[96:97], v[96:97], s[62:63]
    v_cvt_pk_bf16_f32 v41, v96, v97
    v_lshlrev_b32 v96, 16, v42
    v_and_b32 v97, 0xffff0000, v42
    v_pk_add_f32 v[96:97], v[96:97], s[62:63]
    v_cvt_pk_bf16_f32 v42, v96, v97
    v_lshlrev_b32 v96, 16, v43
    v_and_b32 v97, 0xffff0000, v43
    v_pk_add_f32 v[96:97], v[96:97], s[62:63]
    v_cvt_pk_bf16_f32 v43, v96, v97
    v_lshlrev_b32 v96, 16, v44
    v_and_b32 v97, 0xffff0000, v44
    v_pk_add_f32 v[96:97], v[96:97], s[62:63]
    v_cvt_pk_bf16_f32 v44, v96, v97
    v_lshlrev_b32 v96, 16, v45
    v_and_b32 v97, 0xffff0000, v45
    v_pk_add_f32 v[96:97], v[96:97], s[62:63]
    v_cvt_pk_bf16_f32 v45, v96, v97
    v_lshlrev_b32 v96, 16, v46
    v_and_b32 v97, 0xffff0000, v46
    v_pk_add_f32 v[96:97], v[96:97], s[62:63]
    v_cvt_pk_bf16_f32 v46, v96, v97
    v_lshlrev_b32 v96, 16, v47
    v_and_b32 v97, 0xffff0000, v47
    v_pk_add_f32 v[96:97], v[96:97], s[62:63]
    v_cvt_pk_bf16_f32 v47, v96, v97
    v_lshlrev_b32 v96, 16, v48
    v_and_b32 v97, 0xffff0000, v48
    v_pk_add_f32 v[96:97], v[96:97], s[62:63]
    v_cvt_pk_bf16_f32 v48, v96, v97
    v_lshlrev_b32 v96, 16, v49
    v_and_b32 v97, 0xffff0000, v49
    v_pk_add_f32 v[96:97], v[96:97], s[62:63]
    v_cvt_pk_bf16_f32 v49, v96, v97
    v_lshlrev_b32 v96, 16, v50
    v_and_b32 v97, 0xffff0000, v50
    v_pk_add_f32 v[96:97], v[96:97], s[62:63]
    v_cvt_pk_bf16_f32 v50, v96, v97
    v_lshlrev_b32 v96, 16, v51
    v_and_b32 v97, 0xffff0000, v51
    v_pk_add_f32 v[96:97], v[96:97], s[62:63]
    v_cvt_pk_bf16_f32 v51, v96, v97
K1_QFIX:
    ds_write_b64 v12, v[16:17] offset:0
    ds_write_b64 v12, v[18:19] offset:32
    ds_write_b64 v12, v[20:21] offset:64
    ds_write_b64 v12, v[22:23] offset:96
    ds_write_b64 v12, v[24:25] offset:128
    ds_write_b64 v12, v[26:27] offset:160
    ds_write_b64 v12, v[28:29] offset:192
    ds_write_b64 v12, v[30:31] offset:224
    ds_write_b64 v12, v[32:33] offset:256
    ds_write_b64 v12, v[34:35] offset:4864
    ds_write_b64 v12, v[36:37] offset:4896
    ds_write_b64 v12, v[38:39] offset:4928
    ds_write_b64 v12, v[40:41] offset:4960
    ds_write_b64 v12, v[42:43] offset:4992
    ds_write_b64 v12, v[44:45] offset:5024
    ds_write_b64 v12, v[46:47] offset:5056
    ds_write_b64 v12, v[48:49] offset:5088
    ds_write_b64 v12, v[50:51] offset:5120
    v_add_u32 v13, 0, v1
    v_mul_u32_u24 v14, 3641, v13
    v_lshrrev_b32 v14, 16, v14
    v_mul_u32_u24 v15, 18, v14
    v_sub_u32 v15, v13, v15
    v_lshlrev_b32 v15, 4, v15
    v_mul_u32_u24 v13, 304, v14
    v_add3_u32 v13, v13, v15, s15
    v_mul_u32_u24 v14, 1152, v14
    v_add_u32 v96, v14, v15
    ds_read_b128 v[168:171], v13

    v_add_u32 v13, 64, v1
    v_mul_u32_u24 v14, 3641, v13
    v_lshrrev_b32 v14, 16, v14
    v_mul_u32_u24 v15, 18, v14
    v_sub_u32 v15, v13, v15
    v_lshlrev_b32 v15, 4, v15
    v_mul_u32_u24 v13, 304, v14
    v_add3_u32 v13, v13, v15, s15
    v_mul_u32_u24 v14, 1152, v14
    v_add_u32 v97, v14, v15
    ds_read_b128 v[172:175], v13

    v_add_u32 v13, 128, v1
    v_mul_u32_u24 v14, 3641, v13
    v_lshrrev_b32 v14, 16, v14
    v_mul_u32_u24 v15, 18, v14
    v_sub_u32 v15, v13, v15
    v_lshlrev_b32 v15, 4, v15
    v_mul_u32_u24 v13, 304, v14
    v_add3_u32 v13, v13, v15, s15
    v_mul_u32_u24 v14, 1152, v14
    v_add_u32 v98, v14, v15
    ds_read_b128 v[176:179], v13

    v_add_u32 v13, 192, v1
    v_mul_u32_u24 v14, 3641, v13
    v_lshrrev_b32 v14, 16, v14
    v_mul_u32_u24 v15, 18, v14
    v_sub_u32 v15, v13, v15
    v_lshlrev_b32 v15, 4, v15
    v_mul_u32_u24 v13, 304, v14
    v_add3_u32 v13, v13, v15, s15
    v_mul_u32_u24 v14, 1152, v14
    v_add_u32 v99, v14, v15
    ds_read_b128 v[180:183], v13

    v_add_u32 v13, 256, v1
    v_mul_u32_u24 v14, 3641, v13
    v_lshrrev_b32 v14, 16, v14
    v_mul_u32_u24 v15, 18, v14
    v_sub_u32 v15, v13, v15
    v_lshlrev_b32 v15, 4, v15
    v_mul_u32_u24 v13, 304, v14
    v_add3_u32 v13, v13, v15, s15
    v_mul_u32_u24 v14, 1152, v14
    v_add_u32 v100, v14, v15
    ds_read_b128 v[184:187], v13

    v_add_u32 v13, 320, v1
    v_mul_u32_u24 v14, 3641, v13
    v_lshrrev_b32 v14, 16, v14
    v_mul_u32_u24 v15, 18, v14
    v_sub_u32 v15, v13, v15
    v_lshlrev_b32 v15, 4, v15
    v_mul_u32_u24 v13, 304, v14
    v_add3_u32 v13, v13, v15, s15
    v_mul_u32_u24 v14, 1152, v14
    v_add_u32 v101, v14, v15
    ds_read_b128 v[188:191], v13

    v_add_u32 v13, 384, v1
    v_mul_u32_u24 v14, 3641, v13
    v_lshrrev_b32 v14, 16, v14
    v_mul_u32_u24 v15, 18, v14
    v_sub_u32 v15, v13, v15
    v_lshlrev_b32 v15, 4, v15
    v_mul_u32_u24 v13, 304, v14
    v_add3_u32 v13, v13, v15, s15
    v_mul_u32_u24 v14, 1152, v14
    v_add_u32 v102, v14, v15
    ds_read_b128 v[192:195], v13

    v_add_u32 v13, 448, v1
    v_mul_u32_u24 v14, 3641, v13
    v_lshrrev_b32 v14, 16, v14
    v_mul_u32_u24 v15, 18, v14
    v_sub_u32 v15, v13, v15
    v_lshlrev_b32 v15, 4, v15
    v_mul_u32_u24 v13, 304, v14
    v_add3_u32 v13, v13, v15, s15
    v_mul_u32_u24 v14, 1152, v14
    v_add_u32 v103, v14, v15
    ds_read_b128 v[196:199], v13

    v_add_u32 v13, 512, v1
    v_mul_u32_u24 v14, 3641, v13
    v_lshrrev_b32 v14, 16, v14
    v_mul_u32_u24 v15, 18, v14
    v_sub_u32 v15, v13, v15
    v_lshlrev_b32 v15, 4, v15
    v_mul_u32_u24 v13, 304, v14
    v_add3_u32 v13, v13, v15, s15
    v_mul_u32_u24 v14, 1152, v14
    v_add_u32 v104, v14, v15
    ds_read_b128 v[200:203], v13

    s_waitcnt lgkmcnt(8)
    buffer_store_dwordx4 v[168:171], v96, s[56:59], s64 offen sc1
    s_waitcnt lgkmcnt(7)
    buffer_store_dwordx4 v[172:175], v97, s[56:59], s64 offen sc1
    s_waitcnt lgkmcnt(6)
    buffer_store_dwordx4 v[176:179], v98, s[56:59], s64 offen sc1
    s_waitcnt lgkmcnt(5)
    buffer_store_dwordx4 v[180:183], v99, s[56:59], s64 offen sc1
    s_waitcnt lgkmcnt(4)
    buffer_store_dwordx4 v[184:187], v100, s[56:59], s64 offen sc1
    s_waitcnt lgkmcnt(3)
    buffer_store_dwordx4 v[188:191], v101, s[56:59], s64 offen sc1
    s_waitcnt lgkmcnt(2)
    buffer_store_dwordx4 v[192:195], v102, s[56:59], s64 offen sc1
    s_waitcnt lgkmcnt(1)
    buffer_store_dwordx4 v[196:199], v103, s[56:59], s64 offen sc1
    s_waitcnt lgkmcnt(0)
    buffer_store_dwordx4 v[200:203], v104, s[56:59], s64 offen sc1
    s_endpgm
K1_GEMM_KV:
    s_add_u32 m0, s8, 0x0
    s_mov_b32 s10, 0x0
    buffer_load_dwordx4 v4, s[52:55], s10 offen lds
    s_add_u32 m0, s8, 0x400
    s_mov_b32 s10, 0x0
    buffer_load_dwordx4 v5, s[52:55], s10 offen lds
    s_add_u32 m0, s8, 0x800
    s_mov_b32 s10, 0x0
    buffer_load_dwordx4 v6, s[52:55], s10 offen lds
    s_add_u32 m0, s8, 0xc00
    s_mov_b32 s10, 0x0
    buffer_load_dwordx4 v7, s[52:55], s10 offen lds
    s_add_u32 m0, s9, 0x4000
    s_mov_b32 exec_hi, 0
    buffer_load_dwordx4 v8, s[52:55], s10 offen lds
    s_mov_b32 exec_hi, -1
    s_add_u32 m0, s8, 0x4800
    s_mov_b32 s10, 0x36000
    buffer_load_dwordx4 v4, s[52:55], s10 offen lds
    s_add_u32 m0, s8, 0x4c00
    s_mov_b32 s10, 0x36000
    buffer_load_dwordx4 v5, s[52:55], s10 offen lds
    s_add_u32 m0, s8, 0x5000
    s_mov_b32 s10, 0x36000
    buffer_load_dwordx4 v6, s[52:55], s10 offen lds
    s_add_u32 m0, s8, 0x5400
    s_mov_b32 s10, 0x36000
    buffer_load_dwordx4 v7, s[52:55], s10 offen lds
    s_add_u32 m0, s9, 0x8800
    s_mov_b32 exec_hi, 0
    buffer_load_dwordx4 v8, s[52:55], s10 offen lds
    s_mov_b32 exec_hi, -1
    s_waitcnt vmcnt(14)
    ds_write_b128 v3, v[16:19] offset:0
    ds_write_b128 v3, v[20:23] offset:1024
    ds_read_b128 v[96:99], v241
    ds_read_b128 v[104:107], v242
    ds_write_b128 v3, v[24:27] offset:0
    ds_write_b128 v3, v[28:31] offset:1024
    ds_read_b128 v[100:103], v241
    ds_read_b128 v[108:111], v242
    s_waitcnt vmcnt(5)
    s_barrier
    ds_read_b64_tr_b16 v[128:129], v9 offset:0
    ds_read_b64_tr_b16 v[130:131], v9 offset:2304
    ds_read_b64_tr_b16 v[132:133], v9 offset:32
    ds_read_b64_tr_b16 v[134:135], v9 offset:2336
    ds_read_b64_tr_b16 v[136:137], v9 offset:64
    ds_read_b64_tr_b16 v[138:139], v9 offset:2368
    ds_read_b64_tr_b16 v[140:141], v9 offset:96
    ds_read_b64_tr_b16 v[142:143], v9 offset:2400
    ds_read_b64_tr_b16 v[144:145], v9 offset:128
    ds_read_b64_tr_b16 v[146:147], v9 offset:2432
    ds_read_b64_tr_b16 v[148:149], v9 offset:160
    ds_read_b64_tr_b16 v[150:151], v9 offset:2464
    ds_read_b64_tr_b16 v[152:153], v9 offset:192
    ds_read_b64_tr_b16 v[154:155], v9 offset:2496
    ds_read_b64_tr_b16 v[156:157], v9 offset:224
    ds_read_b64_tr_b16 v[158:159], v9 offset:2528
    ds_read_b64_tr_b16 v[160:161], v9 offset:256
    ds_read_b64_tr_b16 v[162:163], v9 offset:2560
    s_waitcnt lgkmcnt(15)
    s_waitcnt lgkmcnt(12)
    v_mfma_f32_16x16x32_bf16 v[168:171], v[96:99], v[128:131], 0
    v_mfma_f32_16x16x32_bf16 v[204:207], v[100:103], v[128:131], 0
    ds_read_b64_tr_b16 v[164:165], v9 offset:9216
    ds_read_b64_tr_b16 v[166:167], v9 offset:11520
    s_add_u32 m0, s8, 0x9000
    s_mov_b32 s10, 0x6c000
    buffer_load_dwordx4 v4, s[52:55], s10 offen lds
    v_mfma_f32_16x16x32_bf16 v[172:175], v[96:99], v[132:135], 0
    v_mfma_f32_16x16x32_bf16 v[208:211], v[100:103], v[132:135], 0
    ds_read_b64_tr_b16 v[128:129], v9 offset:9248
    ds_read_b64_tr_b16 v[130:131], v9 offset:11552
    s_add_u32 m0, s8, 0x9400
    s_mov_b32 s10, 0x6c000
    buffer_load_dwordx4 v5, s[52:55], s10 offen lds
    v_mfma_f32_16x16x32_bf16 v[176:179], v[96:99], v[136:139], 0
    v_mfma_f32_16x16x32_bf16 v[212:215], v[100:103], v[136:139], 0
    ds_read_b64_tr_b16 v[132:133], v9 offset:9280
    ds_read_b64_tr_b16 v[134:135], v9 offset:11584
    s_add_u32 m0, s8, 0x9800
    s_mov_b32 s10, 0x6c000
    buffer_load_dwordx4 v6, s[52:55], s10 offen lds
    s_waitcnt lgkmcnt(12)
    v_mfma_f32_16x16x32_bf16 v[180:183], v[96:99], v[140:143], 0
    v_mfma_f32_16x16x32_bf16 v[216:219], v[100:103], v[140:143], 0
    ds_read_b64_tr_b16 v[136:137], v9 offset:9312
    ds_read_b64_tr_b16 v[138:139], v9 offset:11616
    s_add_u32 m0, s8, 0x9c00
    s_mov_b32 s10, 0x6c000
    buffer_load_dwordx4 v7, s[52:55], s10 offen lds
    v_mfma_f32_16x16x32_bf16 v[184:187], v[96:99], v[144:147], 0
    v_mfma_f32_16x16x32_bf16 v[220:223], v[100:103], v[144:147], 0
    ds_read_b64_tr_b16 v[140:141], v9 offset:9344
    ds_read_b64_tr_b16 v[142:143], v9 offset:11648
    s_add_u32 m0, s9, 0xd000
    s_mov_b32 exec_hi, 0
    buffer_load_dwordx4 v8, s[52:55], s10 offen lds
    s_mov_b32 exec_hi, -1
    ds_write_b128 v3, v[32:35] offset:0
    ds_write_b128 v3, v[36:39] offset:1024
    ds_read_b128 v[112:115], v241
    ds_read_b128 v[120:123], v242
    ds_write_b128 v3, v[40:43] offset:0
    ds_write_b128 v3, v[44:47] offset:1024
    ds_read_b128 v[116:119], v241
    ds_read_b128 v[124:127], v242
    v_mfma_f32_16x16x32_bf16 v[188:191], v[96:99], v[148:151], 0
    v_mfma_f32_16x16x32_bf16 v[224:227], v[100:103], v[148:151], 0
    ds_read_b64_tr_b16 v[144:145], v9 offset:9376
    ds_read_b64_tr_b16 v[146:147], v9 offset:11680
    buffer_load_dwordx4 v[48:51], v2, s[48:51], s64 offen offset:256
    s_waitcnt lgkmcnt(15)
    v_mfma_f32_16x16x32_bf16 v[192:195], v[96:99], v[152:155], 0
    v_mfma_f32_16x16x32_bf16 v[228:231], v[100:103], v[152:155], 0
    ds_read_b64_tr_b16 v[148:149], v9 offset:9408
    ds_read_b64_tr_b16 v[150:151], v9 offset:11712
    buffer_load_dwordx4 v[52:55], v2, s[48:51], s65 offen offset:256
    v_mfma_f32_16x16x32_bf16 v[196:199], v[96:99], v[156:159], 0
    v_mfma_f32_16x16x32_bf16 v[232:235], v[100:103], v[156:159], 0
    ds_read_b64_tr_b16 v[152:153], v9 offset:9440
    ds_read_b64_tr_b16 v[154:155], v9 offset:11744
    buffer_load_dwordx4 v[56:59], v2, s[48:51], s66 offen offset:256
    v_mfma_f32_16x16x32_bf16 v[200:203], v[96:99], v[160:163], 0
    v_mfma_f32_16x16x32_bf16 v[236:239], v[100:103], v[160:163], 0
    ds_read_b64_tr_b16 v[156:157], v9 offset:9472
    ds_read_b64_tr_b16 v[158:159], v9 offset:11776
    buffer_load_dwordx4 v[60:63], v2, s[48:51], s67 offen offset:256
    s_waitcnt vmcnt(9)
    s_barrier
    s_waitcnt lgkmcnt(15)
    v_mfma_f32_16x16x32_bf16 v[168:171], v[104:107], v[164:167], v[168:171]
    v_mfma_f32_16x16x32_bf16 v[204:207], v[108:111], v[164:167], v[204:207]
    ds_read_b64_tr_b16 v[160:161], v9 offset:18432
    ds_read_b64_tr_b16 v[162:163], v9 offset:20736
    s_add_u32 m0, s8, 0xd800
    s_mov_b32 s10, 0xa2000
    buffer_load_dwordx4 v4, s[52:55], s10 offen lds
    v_mfma_f32_16x16x32_bf16 v[172:175], v[104:107], v[128:131], v[172:175]
    v_mfma_f32_16x16x32_bf16 v[208:211], v[108:111], v[128:131], v[208:211]
    ds_read_b64_tr_b16 v[164:165], v9 offset:18464
    ds_read_b64_tr_b16 v[166:167], v9 offset:20768
    s_add_u32 m0, s8, 0xdc00
    s_mov_b32 s10, 0xa2000
    buffer_load_dwordx4 v5, s[52:55], s10 offen lds
    v_mfma_f32_16x16x32_bf16 v[176:179], v[104:107], v[132:135], v[176:179]
    v_mfma_f32_16x16x32_bf16 v[212:215], v[108:111], v[132:135], v[212:215]
    ds_read_b64_tr_b16 v[128:129], v9 offset:18496
    ds_read_b64_tr_b16 v[130:131], v9 offset:20800
    s_add_u32 m0, s8, 0xe000
    s_mov_b32 s10, 0xa2000
    buffer_load_dwordx4 v6, s[52:55], s10 offen lds
    s_waitcnt lgkmcnt(12)
    v_mfma_f32_16x16x32_bf16 v[180:183], v[104:107], v[136:139], v[180:183]
    v_mfma_f32_16x16x32_bf16 v[216:219], v[108:111], v[136:139], v[216:219]
    ds_read_b64_tr_b16 v[132:133], v9 offset:18528
    ds_read_b64_tr_b16 v[134:135], v9 offset:20832
    s_add_u32 m0, s8, 0xe400
    s_mov_b32 s10, 0xa2000
    buffer_load_dwordx4 v7, s[52:55], s10 offen lds
    v_mfma_f32_16x16x32_bf16 v[184:187], v[104:107], v[140:143], v[184:187]
    v_mfma_f32_16x16x32_bf16 v[220:223], v[108:111], v[140:143], v[220:223]
    ds_read_b64_tr_b16 v[136:137], v9 offset:18560
    ds_read_b64_tr_b16 v[138:139], v9 offset:20864
    s_add_u32 m0, s9, 0x11800
    s_mov_b32 exec_hi, 0
    buffer_load_dwordx4 v8, s[52:55], s10 offen lds
    s_mov_b32 exec_hi, -1
    v_mfma_f32_16x16x32_bf16 v[188:191], v[104:107], v[144:147], v[188:191]
    v_mfma_f32_16x16x32_bf16 v[224:227], v[108:111], v[144:147], v[224:227]
    ds_read_b64_tr_b16 v[140:141], v9 offset:18592
    ds_read_b64_tr_b16 v[142:143], v9 offset:20896
    buffer_load_dwordx4 v[64:67], v2, s[48:51], s64 offen offset:384
    s_waitcnt lgkmcnt(12)
    v_mfma_f32_16x16x32_bf16 v[192:195], v[104:107], v[148:151], v[192:195]
    v_mfma_f32_16x16x32_bf16 v[228:231], v[108:111], v[148:151], v[228:231]
    ds_read_b64_tr_b16 v[144:145], v9 offset:18624
    ds_read_b64_tr_b16 v[146:147], v9 offset:20928
    buffer_load_dwordx4 v[68:71], v2, s[48:51], s65 offen offset:384
    v_mfma_f32_16x16x32_bf16 v[196:199], v[104:107], v[152:155], v[196:199]
    v_mfma_f32_16x16x32_bf16 v[232:235], v[108:111], v[152:155], v[232:235]
    ds_read_b64_tr_b16 v[148:149], v9 offset:18656
    ds_read_b64_tr_b16 v[150:151], v9 offset:20960
    buffer_load_dwordx4 v[72:75], v2, s[48:51], s66 offen offset:384
    v_mfma_f32_16x16x32_bf16 v[200:203], v[104:107], v[156:159], v[200:203]
    v_mfma_f32_16x16x32_bf16 v[236:239], v[108:111], v[156:159], v[236:239]
    ds_read_b64_tr_b16 v[152:153], v9 offset:18688
    ds_read_b64_tr_b16 v[154:155], v9 offset:20992
    buffer_load_dwordx4 v[76:79], v2, s[48:51], s67 offen offset:384
    s_waitcnt lgkmcnt(12)
    v_mfma_f32_16x16x32_bf16 v[168:171], v[112:115], v[160:163], v[168:171]
    v_mfma_f32_16x16x32_bf16 v[204:207], v[116:119], v[160:163], v[204:207]
    ds_read_b64_tr_b16 v[156:157], v9 offset:27648
    ds_read_b64_tr_b16 v[158:159], v9 offset:29952
    buffer_load_dwordx4 v[80:83], v2, s[48:51], s64 offen offset:512
    v_mfma_f32_16x16x32_bf16 v[172:175], v[112:115], v[164:167], v[172:175]
    v_mfma_f32_16x16x32_bf16 v[208:211], v[116:119], v[164:167], v[208:211]
    ds_read_b64_tr_b16 v[160:161], v9 offset:27680
    ds_read_b64_tr_b16 v[162:163], v9 offset:29984
    buffer_load_dwordx4 v[84:87], v2, s[48:51], s65 offen offset:512
    v_mfma_f32_16x16x32_bf16 v[176:179], v[112:115], v[128:131], v[176:179]
    v_mfma_f32_16x16x32_bf16 v[212:215], v[116:119], v[128:131], v[212:215]
    ds_read_b64_tr_b16 v[164:165], v9 offset:27712
    ds_read_b64_tr_b16 v[166:167], v9 offset:30016
    buffer_load_dwordx4 v[88:91], v2, s[48:51], s66 offen offset:512
    s_waitcnt lgkmcnt(12)
    v_mfma_f32_16x16x32_bf16 v[180:183], v[112:115], v[132:135], v[180:183]
    v_mfma_f32_16x16x32_bf16 v[216:219], v[116:119], v[132:135], v[216:219]
    ds_read_b64_tr_b16 v[128:129], v9 offset:27744
    ds_read_b64_tr_b16 v[130:131], v9 offset:30048
    buffer_load_dwordx4 v[92:95], v2, s[48:51], s67 offen offset:512
    v_mfma_f32_16x16x32_bf16 v[184:187], v[112:115], v[136:139], v[184:187]
    v_mfma_f32_16x16x32_bf16 v[220:223], v[116:119], v[136:139], v[220:223]
    ds_read_b64_tr_b16 v[132:133], v9 offset:27776
    ds_read_b64_tr_b16 v[134:135], v9 offset:30080
    buffer_load_dwordx4 v[16:19], v2, s[48:51], s64 offen offset:640
    s_waitcnt vmcnt(14)
    ds_write_b128 v3, v[48:51] offset:0
    ds_write_b128 v3, v[52:55] offset:1024
    ds_read_b128 v[96:99], v241
    ds_read_b128 v[104:107], v242
    ds_write_b128 v3, v[56:59] offset:0
    ds_write_b128 v3, v[60:63] offset:1024
    ds_read_b128 v[100:103], v241
    ds_read_b128 v[108:111], v242
    v_mfma_f32_16x16x32_bf16 v[188:191], v[112:115], v[140:143], v[188:191]
    v_mfma_f32_16x16x32_bf16 v[224:227], v[116:119], v[140:143], v[224:227]
    ds_read_b64_tr_b16 v[136:137], v9 offset:27808
    ds_read_b64_tr_b16 v[138:139], v9 offset:30112
    buffer_load_dwordx4 v[20:23], v2, s[48:51], s65 offen offset:640
    s_waitcnt lgkmcnt(15)
    v_mfma_f32_16x16x32_bf16 v[192:195], v[112:115], v[144:147], v[192:195]
    v_mfma_f32_16x16x32_bf16 v[228:231], v[116:119], v[144:147], v[228:231]
    ds_read_b64_tr_b16 v[140:141], v9 offset:27840
    ds_read_b64_tr_b16 v[142:143], v9 offset:30144
    buffer_load_dwordx4 v[24:27], v2, s[48:51], s66 offen offset:640
    v_mfma_f32_16x16x32_bf16 v[196:199], v[112:115], v[148:151], v[196:199]
    v_mfma_f32_16x16x32_bf16 v[232:235], v[116:119], v[148:151], v[232:235]
    ds_read_b64_tr_b16 v[144:145], v9 offset:27872
    ds_read_b64_tr_b16 v[146:147], v9 offset:30176
    buffer_load_dwordx4 v[28:31], v2, s[48:51], s67 offen offset:640
    v_mfma_f32_16x16x32_bf16 v[200:203], v[112:115], v[152:155], v[200:203]
    v_mfma_f32_16x16x32_bf16 v[236:239], v[116:119], v[152:155], v[236:239]
    ds_read_b64_tr_b16 v[148:149], v9 offset:27904
    ds_read_b64_tr_b16 v[150:151], v9 offset:30208
    buffer_load_dwordx4 v[32:35], v2, s[48:51], s64 offen offset:768
    s_barrier
    s_waitcnt lgkmcnt(15)
    v_mfma_f32_16x16x32_bf16 v[168:171], v[120:123], v[156:159], v[168:171]
    v_mfma_f32_16x16x32_bf16 v[204:207], v[124:127], v[156:159], v[204:207]
    ds_read_b64_tr_b16 v[152:153], v240 offset:0
    ds_read_b64_tr_b16 v[154:155], v240 offset:2304
    buffer_load_dwordx4 v[36:39], v2, s[48:51], s65 offen offset:768
    v_mfma_f32_16x16x32_bf16 v[172:175], v[120:123], v[160:163], v[172:175]
    v_mfma_f32_16x16x32_bf16 v[208:211], v[124:127], v[160:163], v[208:211]
    ds_read_b64_tr_b16 v[156:157], v240 offset:32
    ds_read_b64_tr_b16 v[158:159], v240 offset:2336
    buffer_load_dwordx4 v[40:43], v2, s[48:51], s66 offen offset:768
    v_mfma_f32_16x16x32_bf16 v[176:179], v[120:123], v[164:167], v[176:179]
    v_mfma_f32_16x16x32_bf16 v[212:215], v[124:127], v[164:167], v[212:215]
    ds_read_b64_tr_b16 v[160:161], v240 offset:64
    ds_read_b64_tr_b16 v[162:163], v240 offset:2368
    buffer_load_dwordx4 v[44:47], v2, s[48:51], s67 offen offset:768
    s_waitcnt lgkmcnt(12)
    v_mfma_f32_16x16x32_bf16 v[180:183], v[120:123], v[128:131], v[180:183]
    v_mfma_f32_16x16x32_bf16 v[216:219], v[124:127], v[128:131], v[216:219]
    ds_read_b64_tr_b16 v[164:165], v240 offset:96
    ds_read_b64_tr_b16 v[166:167], v240 offset:2400
    buffer_load_dwordx4 v[48:51], v2, s[48:51], s64 offen offset:896
    v_mfma_f32_16x16x32_bf16 v[184:187], v[120:123], v[132:135], v[184:187]
    v_mfma_f32_16x16x32_bf16 v[220:223], v[124:127], v[132:135], v[220:223]
    ds_read_b64_tr_b16 v[128:129], v240 offset:128
    ds_read_b64_tr_b16 v[130:131], v240 offset:2432
    buffer_load_dwordx4 v[52:55], v2, s[48:51], s65 offen offset:896
    v_mfma_f32_16x16x32_bf16 v[188:191], v[120:123], v[136:139], v[188:191]
    v_mfma_f32_16x16x32_bf16 v[224:227], v[124:127], v[136:139], v[224:227]
    ds_read_b64_tr_b16 v[132:133], v240 offset:160
    ds_read_b64_tr_b16 v[134:135], v240 offset:2464
    buffer_load_dwordx4 v[56:59], v2, s[48:51], s66 offen offset:896
    s_waitcnt lgkmcnt(12)
    v_mfma_f32_16x16x32_bf16 v[192:195], v[120:123], v[140:143], v[192:195]
    v_mfma_f32_16x16x32_bf16 v[228:231], v[124:127], v[140:143], v[228:231]
    ds_read_b64_tr_b16 v[136:137], v240 offset:192
    ds_read_b64_tr_b16 v[138:139], v240 offset:2496
    buffer_load_dwordx4 v[60:63], v2, s[48:51], s67 offen offset:896
    v_mfma_f32_16x16x32_bf16 v[196:199], v[120:123], v[144:147], v[196:199]
    v_mfma_f32_16x16x32_bf16 v[232:235], v[124:127], v[144:147], v[232:235]
    ds_read_b64_tr_b16 v[140:141], v240 offset:224
    ds_read_b64_tr_b16 v[142:143], v240 offset:2528
    s_add_u32 m0, s8, 0x0
    s_mov_b32 s10, 0xd8000
    buffer_load_dwordx4 v4, s[52:55], s10 offen lds
    v_mfma_f32_16x16x32_bf16 v[200:203], v[120:123], v[148:151], v[200:203]
    v_mfma_f32_16x16x32_bf16 v[236:239], v[124:127], v[148:151], v[236:239]
    ds_read_b64_tr_b16 v[144:145], v240 offset:256
    ds_read_b64_tr_b16 v[146:147], v240 offset:2560
    s_add_u32 m0, s8, 0x400
    s_mov_b32 s10, 0xd8000
    buffer_load_dwordx4 v5, s[52:55], s10 offen lds
    s_waitcnt lgkmcnt(12)
    v_mfma_f32_16x16x32_bf16 v[168:171], v[96:99], v[152:155], v[168:171]
    v_mfma_f32_16x16x32_bf16 v[204:207], v[100:103], v[152:155], v[204:207]
    ds_read_b64_tr_b16 v[148:149], v240 offset:9216
    ds_read_b64_tr_b16 v[150:151], v240 offset:11520
    s_add_u32 m0, s8, 0x800
    s_mov_b32 s10, 0xd8000
    buffer_load_dwordx4 v6, s[52:55], s10 offen lds
    v_mfma_f32_16x16x32_bf16 v[172:175], v[96:99], v[156:159], v[172:175]
    v_mfma_f32_16x16x32_bf16 v[208:211], v[100:103], v[156:159], v[208:211]
    ds_read_b64_tr_b16 v[152:153], v240 offset:9248
    ds_read_b64_tr_b16 v[154:155], v240 offset:11552
    s_add_u32 m0, s8, 0xc00
    s_mov_b32 s10, 0xd8000
    buffer_load_dwordx4 v7, s[52:55], s10 offen lds
    v_mfma_f32_16x16x32_bf16 v[176:179], v[96:99], v[160:163], v[176:179]
    v_mfma_f32_16x16x32_bf16 v[212:215], v[100:103], v[160:163], v[212:215]
    ds_read_b64_tr_b16 v[156:157], v240 offset:9280
    ds_read_b64_tr_b16 v[158:159], v240 offset:11584
    s_add_u32 m0, s9, 0x4000
    s_mov_b32 exec_hi, 0
    buffer_load_dwordx4 v8, s[52:55], s10 offen lds
    s_mov_b32 exec_hi, -1
    s_waitcnt lgkmcnt(12)
    v_mfma_f32_16x16x32_bf16 v[180:183], v[96:99], v[164:167], v[180:183]
    v_mfma_f32_16x16x32_bf16 v[216:219], v[100:103], v[164:167], v[216:219]
    ds_read_b64_tr_b16 v[160:161], v240 offset:9312
    ds_read_b64_tr_b16 v[162:163], v240 offset:11616
    v_mfma_f32_16x16x32_bf16 v[184:187], v[96:99], v[128:131], v[184:187]
    v_mfma_f32_16x16x32_bf16 v[220:223], v[100:103], v[128:131], v[220:223]
    ds_read_b64_tr_b16 v[164:165], v240 offset:9344
    ds_read_b64_tr_b16 v[166:167], v240 offset:11648
    s_waitcnt vmcnt(21)
    ds_write_b128 v3, v[64:67] offset:0
    ds_write_b128 v3, v[68:71] offset:1024
    ds_read_b128 v[112:115], v241
    ds_read_b128 v[120:123], v242
    ds_write_b128 v3, v[72:75] offset:0
    ds_write_b128 v3, v[76:79] offset:1024
    ds_read_b128 v[116:119], v241
    ds_read_b128 v[124:127], v242
    v_mfma_f32_16x16x32_bf16 v[188:191], v[96:99], v[132:135], v[188:191]
    v_mfma_f32_16x16x32_bf16 v[224:227], v[100:103], v[132:135], v[224:227]
    ds_read_b64_tr_b16 v[128:129], v240 offset:9376
    ds_read_b64_tr_b16 v[130:131], v240 offset:11680
    buffer_load_dwordx4 v[64:67], v2, s[48:51], s64 offen offset:1024
    s_waitcnt lgkmcnt(15)
    v_mfma_f32_16x16x32_bf16 v[192:195], v[96:99], v[136:139], v[192:195]
    v_mfma_f32_16x16x32_bf16 v[228:231], v[100:103], v[136:139], v[228:231]
    ds_read_b64_tr_b16 v[132:133], v240 offset:9408
    ds_read_b64_tr_b16 v[134:135], v240 offset:11712
    buffer_load_dwordx4 v[68:71], v2, s[48:51], s65 offen offset:1024
    v_mfma_f32_16x16x32_bf16 v[196:199], v[96:99], v[140:143], v[196:199]
    v_mfma_f32_16x16x32_bf16 v[232:235], v[100:103], v[140:143], v[232:235]
    ds_read_b64_tr_b16 v[136:137], v240 offset:9440
    ds_read_b64_tr_b16 v[138:139], v240 offset:11744
    buffer_load_dwordx4 v[72:75], v2, s[48:51], s66 offen offset:1024
    v_mfma_f32_16x16x32_bf16 v[200:203], v[96:99], v[144:147], v[200:203]
    v_mfma_f32_16x16x32_bf16 v[236:239], v[100:103], v[144:147], v[236:239]
    ds_read_b64_tr_b16 v[140:141], v240 offset:9472
    ds_read_b64_tr_b16 v[142:143], v240 offset:11776
    buffer_load_dwordx4 v[76:79], v2, s[48:51], s67 offen offset:1024
    s_barrier
    s_waitcnt lgkmcnt(15)
    v_mfma_f32_16x16x32_bf16 v[168:171], v[104:107], v[148:151], v[168:171]
    v_mfma_f32_16x16x32_bf16 v[204:207], v[108:111], v[148:151], v[204:207]
    ds_read_b64_tr_b16 v[144:145], v240 offset:18432
    ds_read_b64_tr_b16 v[146:147], v240 offset:20736
    s_add_u32 m0, s8, 0x4800
    s_mov_b32 s10, 0x10e000
    buffer_load_dwordx4 v4, s[52:55], s10 offen lds
    v_mfma_f32_16x16x32_bf16 v[172:175], v[104:107], v[152:155], v[172:175]
    v_mfma_f32_16x16x32_bf16 v[208:211], v[108:111], v[152:155], v[208:211]
    ds_read_b64_tr_b16 v[148:149], v240 offset:18464
    ds_read_b64_tr_b16 v[150:151], v240 offset:20768
    s_add_u32 m0, s8, 0x4c00
    s_mov_b32 s10, 0x10e000
    buffer_load_dwordx4 v5, s[52:55], s10 offen lds
    v_mfma_f32_16x16x32_bf16 v[176:179], v[104:107], v[156:159], v[176:179]
    v_mfma_f32_16x16x32_bf16 v[212:215], v[108:111], v[156:159], v[212:215]
    ds_read_b64_tr_b16 v[152:153], v240 offset:18496
    ds_read_b64_tr_b16 v[154:155], v240 offset:20800
    s_add_u32 m0, s8, 0x5000
    s_mov_b32 s10, 0x10e000
    buffer_load_dwordx4 v6, s[52:55], s10 offen lds
    s_waitcnt lgkmcnt(12)
    v_mfma_f32_16x16x32_bf16 v[180:183], v[104:107], v[160:163], v[180:183]
    v_mfma_f32_16x16x32_bf16 v[216:219], v[108:111], v[160:163], v[216:219]
    ds_read_b64_tr_b16 v[156:157], v240 offset:18528
    ds_read_b64_tr_b16 v[158:159], v240 offset:20832
    s_add_u32 m0, s8, 0x5400
    s_mov_b32 s10, 0x10e000
    buffer_load_dwordx4 v7, s[52:55], s10 offen lds
    v_mfma_f32_16x16x32_bf16 v[184:187], v[104:107], v[164:167], v[184:187]
    v_mfma_f32_16x16x32_bf16 v[220:223], v[108:111], v[164:167], v[220:223]
    ds_read_b64_tr_b16 v[160:161], v240 offset:18560
    ds_read_b64_tr_b16 v[162:163], v240 offset:20864
    s_add_u32 m0, s9, 0x8800
    s_mov_b32 exec_hi, 0
    buffer_load_dwordx4 v8, s[52:55], s10 offen lds
    s_mov_b32 exec_hi, -1
    v_mfma_f32_16x16x32_bf16 v[188:191], v[104:107], v[128:131], v[188:191]
    v_mfma_f32_16x16x32_bf16 v[224:227], v[108:111], v[128:131], v[224:227]
    ds_read_b64_tr_b16 v[164:165], v240 offset:18592
    ds_read_b64_tr_b16 v[166:167], v240 offset:20896
    s_waitcnt lgkmcnt(12)
    v_mfma_f32_16x16x32_bf16 v[192:195], v[104:107], v[132:135], v[192:195]
    v_mfma_f32_16x16x32_bf16 v[228:231], v[108:111], v[132:135], v[228:231]
    ds_read_b64_tr_b16 v[128:129], v240 offset:18624
    ds_read_b64_tr_b16 v[130:131], v240 offset:20928
    v_mfma_f32_16x16x32_bf16 v[196:199], v[104:107], v[136:139], v[196:199]
    v_mfma_f32_16x16x32_bf16 v[232:235], v[108:111], v[136:139], v[232:235]
    ds_read_b64_tr_b16 v[132:133], v240 offset:18656
    ds_read_b64_tr_b16 v[134:135], v240 offset:20960
    v_mfma_f32_16x16x32_bf16 v[200:203], v[104:107], v[140:143], v[200:203]
    v_mfma_f32_16x16x32_bf16 v[236:239], v[108:111], v[140:143], v[236:239]
    ds_read_b64_tr_b16 v[136:137], v240 offset:18688
    ds_read_b64_tr_b16 v[138:139], v240 offset:20992
    s_waitcnt lgkmcnt(12)
    v_mfma_f32_16x16x32_bf16 v[168:171], v[112:115], v[144:147], v[168:171]
    v_mfma_f32_16x16x32_bf16 v[204:207], v[116:119], v[144:147], v[204:207]
    ds_read_b64_tr_b16 v[140:141], v240 offset:27648
    ds_read_b64_tr_b16 v[142:143], v240 offset:29952
    v_mfma_f32_16x16x32_bf16 v[172:175], v[112:115], v[148:151], v[172:175]
    v_mfma_f32_16x16x32_bf16 v[208:211], v[116:119], v[148:151], v[208:211]
    ds_read_b64_tr_b16 v[144:145], v240 offset:27680
    ds_read_b64_tr_b16 v[146:147], v240 offset:29984
    v_mfma_f32_16x16x32_bf16 v[176:179], v[112:115], v[152:155], v[176:179]
    v_mfma_f32_16x16x32_bf16 v[212:215], v[116:119], v[152:155], v[212:215]
    ds_read_b64_tr_b16 v[148:149], v240 offset:27712
    ds_read_b64_tr_b16 v[150:151], v240 offset:30016
    s_waitcnt lgkmcnt(12)
    v_mfma_f32_16x16x32_bf16 v[180:183], v[112:115], v[156:159], v[180:183]
    v_mfma_f32_16x16x32_bf16 v[216:219], v[116:119], v[156:159], v[216:219]
    ds_read_b64_tr_b16 v[152:153], v240 offset:27744
    ds_read_b64_tr_b16 v[154:155], v240 offset:30048
    v_mfma_f32_16x16x32_bf16 v[184:187], v[112:115], v[160:163], v[184:187]
    v_mfma_f32_16x16x32_bf16 v[220:223], v[116:119], v[160:163], v[220:223]
    ds_read_b64_tr_b16 v[156:157], v240 offset:27776
    ds_read_b64_tr_b16 v[158:159], v240 offset:30080
    s_waitcnt vmcnt(26)
    ds_write_b128 v3, v[80:83] offset:0
    ds_write_b128 v3, v[84:87] offset:1024
    ds_read_b128 v[96:99], v241
    ds_read_b128 v[104:107], v242
    ds_write_b128 v3, v[88:91] offset:0
    ds_write_b128 v3, v[92:95] offset:1024
    ds_read_b128 v[100:103], v241
    ds_read_b128 v[108:111], v242
    v_mfma_f32_16x16x32_bf16 v[188:191], v[112:115], v[164:167], v[188:191]
    v_mfma_f32_16x16x32_bf16 v[224:227], v[116:119], v[164:167], v[224:227]
    ds_read_b64_tr_b16 v[160:161], v240 offset:27808
    ds_read_b64_tr_b16 v[162:163], v240 offset:30112
    s_waitcnt lgkmcnt(15)
    v_mfma_f32_16x16x32_bf16 v[192:195], v[112:115], v[128:131], v[192:195]
    v_mfma_f32_16x16x32_bf16 v[228:231], v[116:119], v[128:131], v[228:231]
    ds_read_b64_tr_b16 v[164:165], v240 offset:27840
    ds_read_b64_tr_b16 v[166:167], v240 offset:30144
    v_mfma_f32_16x16x32_bf16 v[196:199], v[112:115], v[132:135], v[196:199]
    v_mfma_f32_16x16x32_bf16 v[232:235], v[116:119], v[132:135], v[232:235]
    ds_read_b64_tr_b16 v[128:129], v240 offset:27872
    ds_read_b64_tr_b16 v[130:131], v240 offset:30176
    v_mfma_f32_16x16x32_bf16 v[200:203], v[112:115], v[136:139], v[200:203]
    v_mfma_f32_16x16x32_bf16 v[236:239], v[116:119], v[136:139], v[236:239]
    ds_read_b64_tr_b16 v[132:133], v240 offset:27904
    ds_read_b64_tr_b16 v[134:135], v240 offset:30208
    s_waitcnt vmcnt(9)
    s_barrier
    s_waitcnt lgkmcnt(15)
    v_mfma_f32_16x16x32_bf16 v[168:171], v[120:123], v[140:143], v[168:171]
    v_mfma_f32_16x16x32_bf16 v[204:207], v[124:127], v[140:143], v[204:207]
    ds_read_b64_tr_b16 v[136:137], v9 offset:0
    ds_read_b64_tr_b16 v[138:139], v9 offset:2304
    s_add_u32 m0, s8, 0x9000
    s_mov_b32 s10, 0x144000
    buffer_load_dwordx4 v4, s[52:55], s10 offen lds
    v_mfma_f32_16x16x32_bf16 v[172:175], v[120:123], v[144:147], v[172:175]
    v_mfma_f32_16x16x32_bf16 v[208:211], v[124:127], v[144:147], v[208:211]
    ds_read_b64_tr_b16 v[140:141], v9 offset:32
    ds_read_b64_tr_b16 v[142:143], v9 offset:2336
    s_add_u32 m0, s8, 0x9400
    s_mov_b32 s10, 0x144000
    buffer_load_dwordx4 v5, s[52:55], s10 offen lds
    v_mfma_f32_16x16x32_bf16 v[176:179], v[120:123], v[148:151], v[176:179]
    v_mfma_f32_16x16x32_bf16 v[212:215], v[124:127], v[148:151], v[212:215]
    ds_read_b64_tr_b16 v[144:145], v9 offset:64
    ds_read_b64_tr_b16 v[146:147], v9 offset:2368
    s_add_u32 m0, s8, 0x9800
    s_mov_b32 s10, 0x144000
    buffer_load_dwordx4 v6, s[52:55], s10 offen lds
    s_waitcnt lgkmcnt(12)
    v_mfma_f32_16x16x32_bf16 v[180:183], v[120:123], v[152:155], v[180:183]
    v_mfma_f32_16x16x32_bf16 v[216:219], v[124:127], v[152:155], v[216:219]
    ds_read_b64_tr_b16 v[148:149], v9 offset:96
    ds_read_b64_tr_b16 v[150:151], v9 offset:2400
    s_add_u32 m0, s8, 0x9c00
    s_mov_b32 s10, 0x144000
    buffer_load_dwordx4 v7, s[52:55], s10 offen lds
    v_mfma_f32_16x16x32_bf16 v[184:187], v[120:123], v[156:159], v[184:187]
    v_mfma_f32_16x16x32_bf16 v[220:223], v[124:127], v[156:159], v[220:223]
    ds_read_b64_tr_b16 v[152:153], v9 offset:128
    ds_read_b64_tr_b16 v[154:155], v9 offset:2432
    s_add_u32 m0, s9, 0xd000
    s_mov_b32 exec_hi, 0
    buffer_load_dwordx4 v8, s[52:55], s10 offen lds
    s_mov_b32 exec_hi, -1
    v_mfma_f32_16x16x32_bf16 v[188:191], v[120:123], v[160:163], v[188:191]
    v_mfma_f32_16x16x32_bf16 v[224:227], v[124:127], v[160:163], v[224:227]
    ds_read_b64_tr_b16 v[156:157], v9 offset:160
    ds_read_b64_tr_b16 v[158:159], v9 offset:2464
    s_waitcnt lgkmcnt(12)
    v_mfma_f32_16x16x32_bf16 v[192:195], v[120:123], v[164:167], v[192:195]
    v_mfma_f32_16x16x32_bf16 v[228:231], v[124:127], v[164:167], v[228:231]
    ds_read_b64_tr_b16 v[160:161], v9 offset:192
    ds_read_b64_tr_b16 v[162:163], v9 offset:2496
    v_mfma_f32_16x16x32_bf16 v[196:199], v[120:123], v[128:131], v[196:199]
    v_mfma_f32_16x16x32_bf16 v[232:235], v[124:127], v[128:131], v[232:235]
    ds_read_b64_tr_b16 v[164:165], v9 offset:224
    ds_read_b64_tr_b16 v[166:167], v9 offset:2528
    v_mfma_f32_16x16x32_bf16 v[200:203], v[120:123], v[132:135], v[200:203]
    v_mfma_f32_16x16x32_bf16 v[236:239], v[124:127], v[132:135], v[236:239]
    ds_read_b64_tr_b16 v[128:129], v9 offset:256
    ds_read_b64_tr_b16 v[130:131], v9 offset:2560
    s_waitcnt lgkmcnt(12)
    v_mfma_f32_16x16x32_bf16 v[168:171], v[96:99], v[136:139], v[168:171]
    v_mfma_f32_16x16x32_bf16 v[204:207], v[100:103], v[136:139], v[204:207]
    ds_read_b64_tr_b16 v[132:133], v9 offset:9216
    ds_read_b64_tr_b16 v[134:135], v9 offset:11520
    v_mfma_f32_16x16x32_bf16 v[172:175], v[96:99], v[140:143], v[172:175]
    v_mfma_f32_16x16x32_bf16 v[208:211], v[100:103], v[140:143], v[208:211]
    ds_read_b64_tr_b16 v[136:137], v9 offset:9248
    ds_read_b64_tr_b16 v[138:139], v9 offset:11552
    v_mfma_f32_16x16x32_bf16 v[176:179], v[96:99], v[144:147], v[176:179]
    v_mfma_f32_16x16x32_bf16 v[212:215], v[100:103], v[144:147], v[212:215]
    ds_read_b64_tr_b16 v[140:141], v9 offset:9280
    ds_read_b64_tr_b16 v[142:143], v9 offset:11584
    s_waitcnt lgkmcnt(12)
    v_mfma_f32_16x16x32_bf16 v[180:183], v[96:99], v[148:151], v[180:183]
    v_mfma_f32_16x16x32_bf16 v[216:219], v[100:103], v[148:151], v[216:219]
    ds_read_b64_tr_b16 v[144:145], v9 offset:9312
    ds_read_b64_tr_b16 v[146:147], v9 offset:11616
    v_mfma_f32_16x16x32_bf16 v[184:187], v[96:99], v[152:155], v[184:187]
    v_mfma_f32_16x16x32_bf16 v[220:223], v[100:103], v[152:155], v[220:223]
    ds_read_b64_tr_b16 v[148:149], v9 offset:9344
    ds_read_b64_tr_b16 v[150:151], v9 offset:11648
    ds_write_b128 v3, v[16:19] offset:0
    ds_write_b128 v3, v[20:23] offset:1024
    ds_read_b128 v[112:115], v241
    ds_read_b128 v[120:123], v242
    ds_write_b128 v3, v[24:27] offset:0
    ds_write_b128 v3, v[28:31] offset:1024
    ds_read_b128 v[116:119], v241
    ds_read_b128 v[124:127], v242
    v_mfma_f32_16x16x32_bf16 v[188:191], v[96:99], v[156:159], v[188:191]
    v_mfma_f32_16x16x32_bf16 v[224:227], v[100:103], v[156:159], v[224:227]
    ds_read_b64_tr_b16 v[152:153], v9 offset:9376
    ds_read_b64_tr_b16 v[154:155], v9 offset:11680
    s_waitcnt lgkmcnt(15)
    v_mfma_f32_16x16x32_bf16 v[192:195], v[96:99], v[160:163], v[192:195]
    v_mfma_f32_16x16x32_bf16 v[228:231], v[100:103], v[160:163], v[228:231]
    ds_read_b64_tr_b16 v[156:157], v9 offset:9408
    ds_read_b64_tr_b16 v[158:159], v9 offset:11712
    v_mfma_f32_16x16x32_bf16 v[196:199], v[96:99], v[164:167], v[196:199]
    v_mfma_f32_16x16x32_bf16 v[232:235], v[100:103], v[164:167], v[232:235]
    ds_read_b64_tr_b16 v[160:161], v9 offset:9440
    ds_read_b64_tr_b16 v[162:163], v9 offset:11744
    v_mfma_f32_16x16x32_bf16 v[200:203], v[96:99], v[128:131], v[200:203]
    v_mfma_f32_16x16x32_bf16 v[236:239], v[100:103], v[128:131], v[236:239]
    ds_read_b64_tr_b16 v[164:165], v9 offset:9472
    ds_read_b64_tr_b16 v[166:167], v9 offset:11776
    s_waitcnt vmcnt(5)
    s_barrier
    s_waitcnt lgkmcnt(15)
    v_mfma_f32_16x16x32_bf16 v[168:171], v[104:107], v[132:135], v[168:171]
    v_mfma_f32_16x16x32_bf16 v[204:207], v[108:111], v[132:135], v[204:207]
    ds_read_b64_tr_b16 v[128:129], v9 offset:18432
    ds_read_b64_tr_b16 v[130:131], v9 offset:20736
    s_add_u32 m0, s8, 0xd800
    s_mov_b32 s10, 0x17a000
    buffer_load_dwordx4 v4, s[52:55], s10 offen lds
    v_mfma_f32_16x16x32_bf16 v[172:175], v[104:107], v[136:139], v[172:175]
    v_mfma_f32_16x16x32_bf16 v[208:211], v[108:111], v[136:139], v[208:211]
    ds_read_b64_tr_b16 v[132:133], v9 offset:18464
    ds_read_b64_tr_b16 v[134:135], v9 offset:20768
    s_add_u32 m0, s8, 0xdc00
    s_mov_b32 s10, 0x17a000
    buffer_load_dwordx4 v5, s[52:55], s10 offen lds
    v_mfma_f32_16x16x32_bf16 v[176:179], v[104:107], v[140:143], v[176:179]
    v_mfma_f32_16x16x32_bf16 v[212:215], v[108:111], v[140:143], v[212:215]
    ds_read_b64_tr_b16 v[136:137], v9 offset:18496
    ds_read_b64_tr_b16 v[138:139], v9 offset:20800
    s_add_u32 m0, s8, 0xe000
    s_mov_b32 s10, 0x17a000
    buffer_load_dwordx4 v6, s[52:55], s10 offen lds
    s_waitcnt lgkmcnt(12)
    v_mfma_f32_16x16x32_bf16 v[180:183], v[104:107], v[144:147], v[180:183]
    v_mfma_f32_16x16x32_bf16 v[216:219], v[108:111], v[144:147], v[216:219]
    ds_read_b64_tr_b16 v[140:141], v9 offset:18528
    ds_read_b64_tr_b16 v[142:143], v9 offset:20832
    s_add_u32 m0, s8, 0xe400
    s_mov_b32 s10, 0x17a000
    buffer_load_dwordx4 v7, s[52:55], s10 offen lds
    v_mfma_f32_16x16x32_bf16 v[184:187], v[104:107], v[148:151], v[184:187]
    v_mfma_f32_16x16x32_bf16 v[220:223], v[108:111], v[148:151], v[220:223]
    ds_read_b64_tr_b16 v[144:145], v9 offset:18560
    ds_read_b64_tr_b16 v[146:147], v9 offset:20864
    s_add_u32 m0, s9, 0x11800
    s_mov_b32 exec_hi, 0
    buffer_load_dwordx4 v8, s[52:55], s10 offen lds
    s_mov_b32 exec_hi, -1
    v_mfma_f32_16x16x32_bf16 v[188:191], v[104:107], v[152:155], v[188:191]
    v_mfma_f32_16x16x32_bf16 v[224:227], v[108:111], v[152:155], v[224:227]
    ds_read_b64_tr_b16 v[148:149], v9 offset:18592
    ds_read_b64_tr_b16 v[150:151], v9 offset:20896
    s_waitcnt lgkmcnt(12)
    v_mfma_f32_16x16x32_bf16 v[192:195], v[104:107], v[156:159], v[192:195]
    v_mfma_f32_16x16x32_bf16 v[228:231], v[108:111], v[156:159], v[228:231]
    ds_read_b64_tr_b16 v[152:153], v9 offset:18624
    ds_read_b64_tr_b16 v[154:155], v9 offset:20928
    v_mfma_f32_16x16x32_bf16 v[196:199], v[104:107], v[160:163], v[196:199]
    v_mfma_f32_16x16x32_bf16 v[232:235], v[108:111], v[160:163], v[232:235]
    ds_read_b64_tr_b16 v[156:157], v9 offset:18656
    ds_read_b64_tr_b16 v[158:159], v9 offset:20960
    v_mfma_f32_16x16x32_bf16 v[200:203], v[104:107], v[164:167], v[200:203]
    v_mfma_f32_16x16x32_bf16 v[236:239], v[108:111], v[164:167], v[236:239]
    ds_read_b64_tr_b16 v[160:161], v9 offset:18688
    ds_read_b64_tr_b16 v[162:163], v9 offset:20992
    s_waitcnt lgkmcnt(12)
    v_mfma_f32_16x16x32_bf16 v[168:171], v[112:115], v[128:131], v[168:171]
    v_mfma_f32_16x16x32_bf16 v[204:207], v[116:119], v[128:131], v[204:207]
    ds_read_b64_tr_b16 v[164:165], v9 offset:27648
    ds_read_b64_tr_b16 v[166:167], v9 offset:29952
    v_mfma_f32_16x16x32_bf16 v[172:175], v[112:115], v[132:135], v[172:175]
    v_mfma_f32_16x16x32_bf16 v[208:211], v[116:119], v[132:135], v[208:211]
    ds_read_b64_tr_b16 v[128:129], v9 offset:27680
    ds_read_b64_tr_b16 v[130:131], v9 offset:29984
    v_mfma_f32_16x16x32_bf16 v[176:179], v[112:115], v[136:139], v[176:179]
    v_mfma_f32_16x16x32_bf16 v[212:215], v[116:119], v[136:139], v[212:215]
    ds_read_b64_tr_b16 v[132:133], v9 offset:27712
    ds_read_b64_tr_b16 v[134:135], v9 offset:30016
    s_waitcnt lgkmcnt(12)
    v_mfma_f32_16x16x32_bf16 v[180:183], v[112:115], v[140:143], v[180:183]
    v_mfma_f32_16x16x32_bf16 v[216:219], v[116:119], v[140:143], v[216:219]
    ds_read_b64_tr_b16 v[136:137], v9 offset:27744
    ds_read_b64_tr_b16 v[138:139], v9 offset:30048
    v_mfma_f32_16x16x32_bf16 v[184:187], v[112:115], v[144:147], v[184:187]
    v_mfma_f32_16x16x32_bf16 v[220:223], v[116:119], v[144:147], v[220:223]
    ds_read_b64_tr_b16 v[140:141], v9 offset:27776
    ds_read_b64_tr_b16 v[142:143], v9 offset:30080
    ds_write_b128 v3, v[32:35] offset:0
    ds_write_b128 v3, v[36:39] offset:1024
    ds_read_b128 v[96:99], v241
    ds_read_b128 v[104:107], v242
    ds_write_b128 v3, v[40:43] offset:0
    ds_write_b128 v3, v[44:47] offset:1024
    ds_read_b128 v[100:103], v241
    ds_read_b128 v[108:111], v242
    v_mfma_f32_16x16x32_bf16 v[188:191], v[112:115], v[148:151], v[188:191]
    v_mfma_f32_16x16x32_bf16 v[224:227], v[116:119], v[148:151], v[224:227]
    ds_read_b64_tr_b16 v[144:145], v9 offset:27808
    ds_read_b64_tr_b16 v[146:147], v9 offset:30112
    s_waitcnt lgkmcnt(15)
    v_mfma_f32_16x16x32_bf16 v[192:195], v[112:115], v[152:155], v[192:195]
    v_mfma_f32_16x16x32_bf16 v[228:231], v[116:119], v[152:155], v[228:231]
    ds_read_b64_tr_b16 v[148:149], v9 offset:27840
    ds_read_b64_tr_b16 v[150:151], v9 offset:30144
    v_mfma_f32_16x16x32_bf16 v[196:199], v[112:115], v[156:159], v[196:199]
    v_mfma_f32_16x16x32_bf16 v[232:235], v[116:119], v[156:159], v[232:235]
    ds_read_b64_tr_b16 v[152:153], v9 offset:27872
    ds_read_b64_tr_b16 v[154:155], v9 offset:30176
    v_mfma_f32_16x16x32_bf16 v[200:203], v[112:115], v[160:163], v[200:203]
    v_mfma_f32_16x16x32_bf16 v[236:239], v[116:119], v[160:163], v[236:239]
    ds_read_b64_tr_b16 v[156:157], v9 offset:27904
    ds_read_b64_tr_b16 v[158:159], v9 offset:30208
    s_waitcnt vmcnt(5)
    s_barrier
    s_waitcnt lgkmcnt(15)
    v_mfma_f32_16x16x32_bf16 v[168:171], v[120:123], v[164:167], v[168:171]
    v_mfma_f32_16x16x32_bf16 v[204:207], v[124:127], v[164:167], v[204:207]
    ds_read_b64_tr_b16 v[160:161], v240 offset:0
    ds_read_b64_tr_b16 v[162:163], v240 offset:2304
    s_add_u32 m0, s8, 0x0
    s_mov_b32 s10, 0x1b0000
    buffer_load_dwordx4 v4, s[52:55], s10 offen lds
    v_mfma_f32_16x16x32_bf16 v[172:175], v[120:123], v[128:131], v[172:175]
    v_mfma_f32_16x16x32_bf16 v[208:211], v[124:127], v[128:131], v[208:211]
    ds_read_b64_tr_b16 v[164:165], v240 offset:32
    ds_read_b64_tr_b16 v[166:167], v240 offset:2336
    s_add_u32 m0, s8, 0x400
    s_mov_b32 s10, 0x1b0000
    buffer_load_dwordx4 v5, s[52:55], s10 offen lds
    v_mfma_f32_16x16x32_bf16 v[176:179], v[120:123], v[132:135], v[176:179]
    v_mfma_f32_16x16x32_bf16 v[212:215], v[124:127], v[132:135], v[212:215]
    ds_read_b64_tr_b16 v[128:129], v240 offset:64
    ds_read_b64_tr_b16 v[130:131], v240 offset:2368
    s_add_u32 m0, s8, 0x800
    s_mov_b32 s10, 0x1b0000
    buffer_load_dwordx4 v6, s[52:55], s10 offen lds
    s_waitcnt lgkmcnt(12)
    v_mfma_f32_16x16x32_bf16 v[180:183], v[120:123], v[136:139], v[180:183]
    v_mfma_f32_16x16x32_bf16 v[216:219], v[124:127], v[136:139], v[216:219]
    ds_read_b64_tr_b16 v[132:133], v240 offset:96
    ds_read_b64_tr_b16 v[134:135], v240 offset:2400
    s_add_u32 m0, s8, 0xc00
    s_mov_b32 s10, 0x1b0000
    buffer_load_dwordx4 v7, s[52:55], s10 offen lds
    v_mfma_f32_16x16x32_bf16 v[184:187], v[120:123], v[140:143], v[184:187]
    v_mfma_f32_16x16x32_bf16 v[220:223], v[124:127], v[140:143], v[220:223]
    ds_read_b64_tr_b16 v[136:137], v240 offset:128
    ds_read_b64_tr_b16 v[138:139], v240 offset:2432
    s_add_u32 m0, s9, 0x4000
    s_mov_b32 exec_hi, 0
    buffer_load_dwordx4 v8, s[52:55], s10 offen lds
    s_mov_b32 exec_hi, -1
    v_mfma_f32_16x16x32_bf16 v[188:191], v[120:123], v[144:147], v[188:191]
    v_mfma_f32_16x16x32_bf16 v[224:227], v[124:127], v[144:147], v[224:227]
    ds_read_b64_tr_b16 v[140:141], v240 offset:160
    ds_read_b64_tr_b16 v[142:143], v240 offset:2464
    s_waitcnt lgkmcnt(12)
    v_mfma_f32_16x16x32_bf16 v[192:195], v[120:123], v[148:151], v[192:195]
    v_mfma_f32_16x16x32_bf16 v[228:231], v[124:127], v[148:151], v[228:231]
    ds_read_b64_tr_b16 v[144:145], v240 offset:192
    ds_read_b64_tr_b16 v[146:147], v240 offset:2496
    v_mfma_f32_16x16x32_bf16 v[196:199], v[120:123], v[152:155], v[196:199]
    v_mfma_f32_16x16x32_bf16 v[232:235], v[124:127], v[152:155], v[232:235]
    ds_read_b64_tr_b16 v[148:149], v240 offset:224
    ds_read_b64_tr_b16 v[150:151], v240 offset:2528
    v_mfma_f32_16x16x32_bf16 v[200:203], v[120:123], v[156:159], v[200:203]
    v_mfma_f32_16x16x32_bf16 v[236:239], v[124:127], v[156:159], v[236:239]
    ds_read_b64_tr_b16 v[152:153], v240 offset:256
    ds_read_b64_tr_b16 v[154:155], v240 offset:2560
    s_waitcnt lgkmcnt(12)
    v_mfma_f32_16x16x32_bf16 v[168:171], v[96:99], v[160:163], v[168:171]
    v_mfma_f32_16x16x32_bf16 v[204:207], v[100:103], v[160:163], v[204:207]
    ds_read_b64_tr_b16 v[156:157], v240 offset:9216
    ds_read_b64_tr_b16 v[158:159], v240 offset:11520
    v_mfma_f32_16x16x32_bf16 v[172:175], v[96:99], v[164:167], v[172:175]
    v_mfma_f32_16x16x32_bf16 v[208:211], v[100:103], v[164:167], v[208:211]
    ds_read_b64_tr_b16 v[160:161], v240 offset:9248
    ds_read_b64_tr_b16 v[162:163], v240 offset:11552
    v_mfma_f32_16x16x32_bf16 v[176:179], v[96:99], v[128:131], v[176:179]
    v_mfma_f32_16x16x32_bf16 v[212:215], v[100:103], v[128:131], v[212:215]
    ds_read_b64_tr_b16 v[164:165], v240 offset:9280
    ds_read_b64_tr_b16 v[166:167], v240 offset:11584
    s_waitcnt lgkmcnt(12)
    v_mfma_f32_16x16x32_bf16 v[180:183], v[96:99], v[132:135], v[180:183]
    v_mfma_f32_16x16x32_bf16 v[216:219], v[100:103], v[132:135], v[216:219]
    ds_read_b64_tr_b16 v[128:129], v240 offset:9312
    ds_read_b64_tr_b16 v[130:131], v240 offset:11616
    v_mfma_f32_16x16x32_bf16 v[184:187], v[96:99], v[136:139], v[184:187]
    v_mfma_f32_16x16x32_bf16 v[220:223], v[100:103], v[136:139], v[220:223]
    ds_read_b64_tr_b16 v[132:133], v240 offset:9344
    ds_read_b64_tr_b16 v[134:135], v240 offset:11648
    ds_write_b128 v3, v[48:51] offset:0
    ds_write_b128 v3, v[52:55] offset:1024
    ds_read_b128 v[112:115], v241
    ds_read_b128 v[120:123], v242
    ds_write_b128 v3, v[56:59] offset:0
    ds_write_b128 v3, v[60:63] offset:1024
    ds_read_b128 v[116:119], v241
    ds_read_b128 v[124:127], v242
    v_mfma_f32_16x16x32_bf16 v[188:191], v[96:99], v[140:143], v[188:191]
    v_mfma_f32_16x16x32_bf16 v[224:227], v[100:103], v[140:143], v[224:227]
    ds_read_b64_tr_b16 v[136:137], v240 offset:9376
    ds_read_b64_tr_b16 v[138:139], v240 offset:11680
    s_waitcnt lgkmcnt(15)
    v_mfma_f32_16x16x32_bf16 v[192:195], v[96:99], v[144:147], v[192:195]
    v_mfma_f32_16x16x32_bf16 v[228:231], v[100:103], v[144:147], v[228:231]
    ds_read_b64_tr_b16 v[140:141], v240 offset:9408
    ds_read_b64_tr_b16 v[142:143], v240 offset:11712
    v_mfma_f32_16x16x32_bf16 v[196:199], v[96:99], v[148:151], v[196:199]
    v_mfma_f32_16x16x32_bf16 v[232:235], v[100:103], v[148:151], v[232:235]
    ds_read_b64_tr_b16 v[144:145], v240 offset:9440
    ds_read_b64_tr_b16 v[146:147], v240 offset:11744
    v_mfma_f32_16x16x32_bf16 v[200:203], v[96:99], v[152:155], v[200:203]
    v_mfma_f32_16x16x32_bf16 v[236:239], v[100:103], v[152:155], v[236:239]
    ds_read_b64_tr_b16 v[148:149], v240 offset:9472
    ds_read_b64_tr_b16 v[150:151], v240 offset:11776
    s_waitcnt vmcnt(5)
    s_barrier
    s_waitcnt lgkmcnt(15)
    v_mfma_f32_16x16x32_bf16 v[168:171], v[104:107], v[156:159], v[168:171]
    v_mfma_f32_16x16x32_bf16 v[204:207], v[108:111], v[156:159], v[204:207]
    ds_read_b64_tr_b16 v[152:153], v240 offset:18432
    ds_read_b64_tr_b16 v[154:155], v240 offset:20736
    v_mfma_f32_16x16x32_bf16 v[172:175], v[104:107], v[160:163], v[172:175]
    v_mfma_f32_16x16x32_bf16 v[208:211], v[108:111], v[160:163], v[208:211]
    ds_read_b64_tr_b16 v[156:157], v240 offset:18464
    ds_read_b64_tr_b16 v[158:159], v240 offset:20768
    v_mfma_f32_16x16x32_bf16 v[176:179], v[104:107], v[164:167], v[176:179]
    v_mfma_f32_16x16x32_bf16 v[212:215], v[108:111], v[164:167], v[212:215]
    ds_read_b64_tr_b16 v[160:161], v240 offset:18496
    ds_read_b64_tr_b16 v[162:163], v240 offset:20800
    s_waitcnt lgkmcnt(12)
    v_mfma_f32_16x16x32_bf16 v[180:183], v[104:107], v[128:131], v[180:183]
    v_mfma_f32_16x16x32_bf16 v[216:219], v[108:111], v[128:131], v[216:219]
    ds_read_b64_tr_b16 v[164:165], v240 offset:18528
    ds_read_b64_tr_b16 v[166:167], v240 offset:20832
    v_mfma_f32_16x16x32_bf16 v[184:187], v[104:107], v[132:135], v[184:187]
    v_mfma_f32_16x16x32_bf16 v[220:223], v[108:111], v[132:135], v[220:223]
    ds_read_b64_tr_b16 v[128:129], v240 offset:18560
    ds_read_b64_tr_b16 v[130:131], v240 offset:20864
    v_mfma_f32_16x16x32_bf16 v[188:191], v[104:107], v[136:139], v[188:191]
    v_mfma_f32_16x16x32_bf16 v[224:227], v[108:111], v[136:139], v[224:227]
    ds_read_b64_tr_b16 v[132:133], v240 offset:18592
    ds_read_b64_tr_b16 v[134:135], v240 offset:20896
    s_waitcnt lgkmcnt(12)
    v_mfma_f32_16x16x32_bf16 v[192:195], v[104:107], v[140:143], v[192:195]
    v_mfma_f32_16x16x32_bf16 v[228:231], v[108:111], v[140:143], v[228:231]
    ds_read_b64_tr_b16 v[136:137], v240 offset:18624
    ds_read_b64_tr_b16 v[138:139], v240 offset:20928
    v_mfma_f32_16x16x32_bf16 v[196:199], v[104:107], v[144:147], v[196:199]
    v_mfma_f32_16x16x32_bf16 v[232:235], v[108:111], v[144:147], v[232:235]
    ds_read_b64_tr_b16 v[140:141], v240 offset:18656
    ds_read_b64_tr_b16 v[142:143], v240 offset:20960
    v_mfma_f32_16x16x32_bf16 v[200:203], v[104:107], v[148:151], v[200:203]
    v_mfma_f32_16x16x32_bf16 v[236:239], v[108:111], v[148:151], v[236:239]
    ds_read_b64_tr_b16 v[144:145], v240 offset:18688
    ds_read_b64_tr_b16 v[146:147], v240 offset:20992
    s_waitcnt lgkmcnt(12)
    v_mfma_f32_16x16x32_bf16 v[168:171], v[112:115], v[152:155], v[168:171]
    v_mfma_f32_16x16x32_bf16 v[204:207], v[116:119], v[152:155], v[204:207]
    ds_read_b64_tr_b16 v[148:149], v240 offset:27648
    ds_read_b64_tr_b16 v[150:151], v240 offset:29952
    v_mfma_f32_16x16x32_bf16 v[172:175], v[112:115], v[156:159], v[172:175]
    v_mfma_f32_16x16x32_bf16 v[208:211], v[116:119], v[156:159], v[208:211]
    ds_read_b64_tr_b16 v[152:153], v240 offset:27680
    ds_read_b64_tr_b16 v[154:155], v240 offset:29984
    v_mfma_f32_16x16x32_bf16 v[176:179], v[112:115], v[160:163], v[176:179]
    v_mfma_f32_16x16x32_bf16 v[212:215], v[116:119], v[160:163], v[212:215]
    ds_read_b64_tr_b16 v[156:157], v240 offset:27712
    ds_read_b64_tr_b16 v[158:159], v240 offset:30016
    s_waitcnt lgkmcnt(12)
    v_mfma_f32_16x16x32_bf16 v[180:183], v[112:115], v[164:167], v[180:183]
    v_mfma_f32_16x16x32_bf16 v[216:219], v[116:119], v[164:167], v[216:219]
    ds_read_b64_tr_b16 v[160:161], v240 offset:27744
    ds_read_b64_tr_b16 v[162:163], v240 offset:30048
    v_mfma_f32_16x16x32_bf16 v[184:187], v[112:115], v[128:131], v[184:187]
    v_mfma_f32_16x16x32_bf16 v[220:223], v[116:119], v[128:131], v[220:223]
    ds_read_b64_tr_b16 v[164:165], v240 offset:27776
    ds_read_b64_tr_b16 v[166:167], v240 offset:30080
    ds_write_b128 v3, v[64:67] offset:0
    ds_write_b128 v3, v[68:71] offset:1024
    ds_read_b128 v[96:99], v241
    ds_read_b128 v[104:107], v242
    ds_write_b128 v3, v[72:75] offset:0
    ds_write_b128 v3, v[76:79] offset:1024
    ds_read_b128 v[100:103], v241
    ds_read_b128 v[108:111], v242
    v_mfma_f32_16x16x32_bf16 v[188:191], v[112:115], v[132:135], v[188:191]
    v_mfma_f32_16x16x32_bf16 v[224:227], v[116:119], v[132:135], v[224:227]
    ds_read_b64_tr_b16 v[128:129], v240 offset:27808
    ds_read_b64_tr_b16 v[130:131], v240 offset:30112
    s_waitcnt lgkmcnt(15)
    v_mfma_f32_16x16x32_bf16 v[192:195], v[112:115], v[136:139], v[192:195]
    v_mfma_f32_16x16x32_bf16 v[228:231], v[116:119], v[136:139], v[228:231]
    ds_read_b64_tr_b16 v[132:133], v240 offset:27840
    ds_read_b64_tr_b16 v[134:135], v240 offset:30144
    v_mfma_f32_16x16x32_bf16 v[196:199], v[112:115], v[140:143], v[196:199]
    v_mfma_f32_16x16x32_bf16 v[232:235], v[116:119], v[140:143], v[232:235]
    ds_read_b64_tr_b16 v[136:137], v240 offset:27872
    ds_read_b64_tr_b16 v[138:139], v240 offset:30176
    v_mfma_f32_16x16x32_bf16 v[200:203], v[112:115], v[144:147], v[200:203]
    v_mfma_f32_16x16x32_bf16 v[236:239], v[116:119], v[144:147], v[236:239]
    ds_read_b64_tr_b16 v[140:141], v240 offset:27904
    ds_read_b64_tr_b16 v[142:143], v240 offset:30208
    s_waitcnt vmcnt(0)
    s_barrier
    s_waitcnt lgkmcnt(15)
    v_mfma_f32_16x16x32_bf16 v[168:171], v[120:123], v[148:151], v[168:171]
    v_mfma_f32_16x16x32_bf16 v[204:207], v[124:127], v[148:151], v[204:207]
    ds_read_b64_tr_b16 v[144:145], v9 offset:0
    ds_read_b64_tr_b16 v[146:147], v9 offset:2304
    v_mfma_f32_16x16x32_bf16 v[172:175], v[120:123], v[152:155], v[172:175]
    v_mfma_f32_16x16x32_bf16 v[208:211], v[124:127], v[152:155], v[208:211]
    ds_read_b64_tr_b16 v[148:149], v9 offset:32
    ds_read_b64_tr_b16 v[150:151], v9 offset:2336
    v_mfma_f32_16x16x32_bf16 v[176:179], v[120:123], v[156:159], v[176:179]
    v_mfma_f32_16x16x32_bf16 v[212:215], v[124:127], v[156:159], v[212:215]
    ds_read_b64_tr_b16 v[152:153], v9 offset:64
    ds_read_b64_tr_b16 v[154:155], v9 offset:2368
    s_waitcnt lgkmcnt(12)
    v_mfma_f32_16x16x32_bf16 v[180:183], v[120:123], v[160:163], v[180:183]
    v_mfma_f32_16x16x32_bf16 v[216:219], v[124:127], v[160:163], v[216:219]
    ds_read_b64_tr_b16 v[156:157], v9 offset:96
    ds_read_b64_tr_b16 v[158:159], v9 offset:2400
    v_mfma_f32_16x16x32_bf16 v[184:187], v[120:123], v[164:167], v[184:187]
    v_mfma_f32_16x16x32_bf16 v[220:223], v[124:127], v[164:167], v[220:223]
    ds_read_b64_tr_b16 v[160:161], v9 offset:128
    ds_read_b64_tr_b16 v[162:163], v9 offset:2432
    v_mfma_f32_16x16x32_bf16 v[188:191], v[120:123], v[128:131], v[188:191]
    v_mfma_f32_16x16x32_bf16 v[224:227], v[124:127], v[128:131], v[224:227]
    ds_read_b64_tr_b16 v[164:165], v9 offset:160
    ds_read_b64_tr_b16 v[166:167], v9 offset:2464
    s_waitcnt lgkmcnt(12)
    v_mfma_f32_16x16x32_bf16 v[192:195], v[120:123], v[132:135], v[192:195]
    v_mfma_f32_16x16x32_bf16 v[228:231], v[124:127], v[132:135], v[228:231]
    ds_read_b64_tr_b16 v[128:129], v9 offset:192
    ds_read_b64_tr_b16 v[130:131], v9 offset:2496
    v_mfma_f32_16x16x32_bf16 v[196:199], v[120:123], v[136:139], v[196:199]
    v_mfma_f32_16x16x32_bf16 v[232:235], v[124:127], v[136:139], v[232:235]
    ds_read_b64_tr_b16 v[132:133], v9 offset:224
    ds_read_b64_tr_b16 v[134:135], v9 offset:2528
    v_mfma_f32_16x16x32_bf16 v[200:203], v[120:123], v[140:143], v[200:203]
    v_mfma_f32_16x16x32_bf16 v[236:239], v[124:127], v[140:143], v[236:239]
    ds_read_b64_tr_b16 v[136:137], v9 offset:256
    ds_read_b64_tr_b16 v[138:139], v9 offset:2560
    s_waitcnt lgkmcnt(12)
    v_mfma_f32_16x16x32_bf16 v[168:171], v[96:99], v[144:147], v[168:171]
    v_mfma_f32_16x16x32_bf16 v[204:207], v[100:103], v[144:147], v[204:207]
    ds_read_b64_tr_b16 v[140:141], v9 offset:9216
    ds_read_b64_tr_b16 v[142:143], v9 offset:11520
    v_mfma_f32_16x16x32_bf16 v[172:175], v[96:99], v[148:151], v[172:175]
    v_mfma_f32_16x16x32_bf16 v[208:211], v[100:103], v[148:151], v[208:211]
    ds_read_b64_tr_b16 v[144:145], v9 offset:9248
    ds_read_b64_tr_b16 v[146:147], v9 offset:11552
    v_mfma_f32_16x16x32_bf16 v[176:179], v[96:99], v[152:155], v[176:179]
    v_mfma_f32_16x16x32_bf16 v[212:215], v[100:103], v[152:155], v[212:215]
    ds_read_b64_tr_b16 v[148:149], v9 offset:9280
    ds_read_b64_tr_b16 v[150:151], v9 offset:11584
    s_waitcnt lgkmcnt(12)
    v_mfma_f32_16x16x32_bf16 v[180:183], v[96:99], v[156:159], v[180:183]
    v_mfma_f32_16x16x32_bf16 v[216:219], v[100:103], v[156:159], v[216:219]
    ds_read_b64_tr_b16 v[152:153], v9 offset:9312
    ds_read_b64_tr_b16 v[154:155], v9 offset:11616
    v_mfma_f32_16x16x32_bf16 v[184:187], v[96:99], v[160:163], v[184:187]
    v_mfma_f32_16x16x32_bf16 v[220:223], v[100:103], v[160:163], v[220:223]
    ds_read_b64_tr_b16 v[156:157], v9 offset:9344
    ds_read_b64_tr_b16 v[158:159], v9 offset:11648
    v_mfma_f32_16x16x32_bf16 v[188:191], v[96:99], v[164:167], v[188:191]
    v_mfma_f32_16x16x32_bf16 v[224:227], v[100:103], v[164:167], v[224:227]
    ds_read_b64_tr_b16 v[160:161], v9 offset:9376
    ds_read_b64_tr_b16 v[162:163], v9 offset:11680
    s_waitcnt lgkmcnt(12)
    v_mfma_f32_16x16x32_bf16 v[192:195], v[96:99], v[128:131], v[192:195]
    v_mfma_f32_16x16x32_bf16 v[228:231], v[100:103], v[128:131], v[228:231]
    ds_read_b64_tr_b16 v[164:165], v9 offset:9408
    ds_read_b64_tr_b16 v[166:167], v9 offset:11712
    v_mfma_f32_16x16x32_bf16 v[196:199], v[96:99], v[132:135], v[196:199]
    v_mfma_f32_16x16x32_bf16 v[232:235], v[100:103], v[132:135], v[232:235]
    ds_read_b64_tr_b16 v[128:129], v9 offset:9440
    ds_read_b64_tr_b16 v[130:131], v9 offset:11744
    v_mfma_f32_16x16x32_bf16 v[200:203], v[96:99], v[136:139], v[200:203]
    v_mfma_f32_16x16x32_bf16 v[236:239], v[100:103], v[136:139], v[236:239]
    ds_read_b64_tr_b16 v[132:133], v9 offset:9472
    ds_read_b64_tr_b16 v[134:135], v9 offset:11776
    s_waitcnt lgkmcnt(12)
    v_mfma_f32_16x16x32_bf16 v[168:171], v[104:107], v[140:143], v[168:171]
    v_mfma_f32_16x16x32_bf16 v[204:207], v[108:111], v[140:143], v[204:207]
    v_mfma_f32_16x16x32_bf16 v[172:175], v[104:107], v[144:147], v[172:175]
    v_mfma_f32_16x16x32_bf16 v[208:211], v[108:111], v[144:147], v[208:211]
    v_mfma_f32_16x16x32_bf16 v[176:179], v[104:107], v[148:151], v[176:179]
    v_mfma_f32_16x16x32_bf16 v[212:215], v[108:111], v[148:151], v[212:215]
    s_waitcnt lgkmcnt(6)
    v_mfma_f32_16x16x32_bf16 v[180:183], v[104:107], v[152:155], v[180:183]
    v_mfma_f32_16x16x32_bf16 v[216:219], v[108:111], v[152:155], v[216:219]
    v_mfma_f32_16x16x32_bf16 v[184:187], v[104:107], v[156:159], v[184:187]
    v_mfma_f32_16x16x32_bf16 v[220:223], v[108:111], v[156:159], v[220:223]
    v_mfma_f32_16x16x32_bf16 v[188:191], v[104:107], v[160:163], v[188:191]
    v_mfma_f32_16x16x32_bf16 v[224:227], v[108:111], v[160:163], v[224:227]
    s_waitcnt lgkmcnt(0)
    v_mfma_f32_16x16x32_bf16 v[192:195], v[104:107], v[164:167], v[192:195]
    v_mfma_f32_16x16x32_bf16 v[228:231], v[108:111], v[164:167], v[228:231]
    v_mfma_f32_16x16x32_bf16 v[196:199], v[104:107], v[128:131], v[196:199]
    v_mfma_f32_16x16x32_bf16 v[232:235], v[108:111], v[128:131], v[232:235]
    v_mfma_f32_16x16x32_bf16 v[200:203], v[104:107], v[132:135], v[200:203]
    v_mfma_f32_16x16x32_bf16 v[236:239], v[108:111], v[132:135], v[236:239]
    s_nop 9
    s_lshl_b32 s98, s6, 1
    s_and_b32 s99, s11, 1
    s_add_u32 s98, s98, s99
    s_lshr_b32 s99, s11, 1
    s_lshl_b32 s99, s99, 5
    s_add_u32 s99, s99, s98
    s_lshl_b32 s99, s99, 7
    s_add_u32 s99, s99, 0xb60000
    v_mov_b32 v12, 0
    s_mov_b64 exec, 1
    buffer_store_dword v12, v12, s[56:59], s99 offen sc1
    s_mov_b64 exec, -1

    v_mov_b32 v243, -1
    v_cvt_pk_bf16_f32 v96, v168, v169
    v_cvt_pk_bf16_f32 v102, v170, v171
    v_cvt_pk_bf16_f32 v108, v204, v205
    v_cvt_pk_bf16_f32 v114, v206, v207
    v_cvt_pk_bf16_f32 v120, v172, v173
    v_cvt_pk_bf16_f32 v126, v174, v175
    v_cvt_pk_bf16_f32 v132, v208, v209
    v_cvt_pk_bf16_f32 v138, v210, v211
    v_lshlrev_b32 v98, 16, v96
    v_and_b32 v99, 0xffff0000, v96
    v_lshlrev_b32 v104, 16, v102
    v_and_b32 v105, 0xffff0000, v102
    v_lshlrev_b32 v110, 16, v108
    v_and_b32 v111, 0xffff0000, v108
    v_lshlrev_b32 v116, 16, v114
    v_and_b32 v117, 0xffff0000, v114
    v_lshlrev_b32 v122, 16, v120
    v_and_b32 v123, 0xffff0000, v120
    v_lshlrev_b32 v128, 16, v126
    v_and_b32 v129, 0xffff0000, v126
    v_lshlrev_b32 v134, 16, v132
    v_and_b32 v135, 0xffff0000, v132
    v_lshlrev_b32 v140, 16, v138
    v_and_b32 v141, 0xffff0000, v138
    v_pk_mul_f32 v[100:101], v[98:99], s[60:61]
    v_pk_mul_f32 v[106:107], v[104:105], s[60:61]
    v_pk_mul_f32 v[112:113], v[110:111], s[60:61]
    v_pk_mul_f32 v[118:119], v[116:117], s[60:61]
    v_pk_mul_f32 v[124:125], v[122:123], s[60:61]
    v_pk_mul_f32 v[130:131], v[128:129], s[60:61]
    v_pk_mul_f32 v[136:137], v[134:135], s[60:61]
    v_pk_mul_f32 v[142:143], v[140:141], s[60:61]
    v_exp_f32_e64 v100, v100 clamp
    v_exp_f32_e64 v101, v101 clamp
    v_exp_f32_e64 v106, v106 clamp
    v_exp_f32_e64 v107, v107 clamp
    v_exp_f32_e64 v112, v112 clamp
    v_exp_f32_e64 v113, v113 clamp
    v_exp_f32_e64 v118, v118 clamp
    v_exp_f32_e64 v119, v119 clamp
    v_exp_f32_e64 v124, v124 clamp
    v_exp_f32_e64 v125, v125 clamp
    v_exp_f32_e64 v130, v130 clamp
    v_exp_f32_e64 v131, v131 clamp
    v_exp_f32_e64 v136, v136 clamp
    v_exp_f32_e64 v137, v137 clamp
    v_exp_f32_e64 v142, v142 clamp
    v_exp_f32_e64 v143, v143 clamp
    v_max_f32 v98, 0, v98
    v_max_f32 v99, 0, v99
    v_max_f32 v104, 0, v104
    v_max_f32 v105, 0, v105
    v_max_f32 v110, 0, v110
    v_max_f32 v111, 0, v111
    v_max_f32 v116, 0, v116
    v_max_f32 v117, 0, v117
    v_max_f32 v122, 0, v122
    v_max_f32 v123, 0, v123
    v_max_f32 v128, 0, v128
    v_max_f32 v129, 0, v129
    v_max_f32 v134, 0, v134
    v_max_f32 v135, 0, v135
    v_max_f32 v140, 0, v140
    v_max_f32 v141, 0, v141
    v_pk_add_f32 v[100:101], v[100:101], v[98:99]
    v_pk_add_f32 v[106:107], v[106:107], v[104:105]
    v_pk_add_f32 v[112:113], v[112:113], v[110:111]
    v_pk_add_f32 v[118:119], v[118:119], v[116:117]
    v_pk_add_f32 v[124:125], v[124:125], v[122:123]
    v_pk_add_f32 v[130:131], v[130:131], v[128:129]
    v_pk_add_f32 v[136:137], v[136:137], v[134:135]
    v_pk_add_f32 v[142:143], v[142:143], v[140:141]
    v_cvt_pk_bf16_f32 v16, v100, v101
    v_cvt_pk_bf16_f32 v17, v106, v107
    v_cvt_pk_bf16_f32 v18, v112, v113
    v_cvt_pk_bf16_f32 v19, v118, v119
    v_cvt_pk_bf16_f32 v20, v124, v125
    v_cvt_pk_bf16_f32 v21, v130, v131
    v_cvt_pk_bf16_f32 v22, v136, v137
    v_cvt_pk_bf16_f32 v23, v142, v143
    v_pk_min_u16 v243, v243, v16
    v_pk_min_u16 v243, v243, v17
    v_pk_min_u16 v243, v243, v18
    v_pk_min_u16 v243, v243, v19
    v_pk_min_u16 v243, v243, v20
    v_pk_min_u16 v243, v243, v21
    v_pk_min_u16 v243, v243, v22
    v_pk_min_u16 v243, v243, v23
    v_cvt_pk_bf16_f32 v96, v176, v177
    v_cvt_pk_bf16_f32 v102, v178, v179
    v_cvt_pk_bf16_f32 v108, v212, v213
    v_cvt_pk_bf16_f32 v114, v214, v215
    v_cvt_pk_bf16_f32 v120, v180, v181
    v_cvt_pk_bf16_f32 v126, v182, v183
    v_cvt_pk_bf16_f32 v132, v216, v217
    v_cvt_pk_bf16_f32 v138, v218, v219
    v_lshlrev_b32 v98, 16, v96
    v_and_b32 v99, 0xffff0000, v96
    v_lshlrev_b32 v104, 16, v102
    v_and_b32 v105, 0xffff0000, v102
    v_lshlrev_b32 v110, 16, v108
    v_and_b32 v111, 0xffff0000, v108
    v_lshlrev_b32 v116, 16, v114
    v_and_b32 v117, 0xffff0000, v114
    v_lshlrev_b32 v122, 16, v120
    v_and_b32 v123, 0xffff0000, v120
    v_lshlrev_b32 v128, 16, v126
    v_and_b32 v129, 0xffff0000, v126
    v_lshlrev_b32 v134, 16, v132
    v_and_b32 v135, 0xffff0000, v132
    v_lshlrev_b32 v140, 16, v138
    v_and_b32 v141, 0xffff0000, v138
    v_pk_mul_f32 v[100:101], v[98:99], s[60:61]
    v_pk_mul_f32 v[106:107], v[104:105], s[60:61]
    v_pk_mul_f32 v[112:113], v[110:111], s[60:61]
    v_pk_mul_f32 v[118:119], v[116:117], s[60:61]
    v_pk_mul_f32 v[124:125], v[122:123], s[60:61]
    v_pk_mul_f32 v[130:131], v[128:129], s[60:61]
    v_pk_mul_f32 v[136:137], v[134:135], s[60:61]
    v_pk_mul_f32 v[142:143], v[140:141], s[60:61]
    v_exp_f32_e64 v100, v100 clamp
    v_exp_f32_e64 v101, v101 clamp
    v_exp_f32_e64 v106, v106 clamp
    v_exp_f32_e64 v107, v107 clamp
    v_exp_f32_e64 v112, v112 clamp
    v_exp_f32_e64 v113, v113 clamp
    v_exp_f32_e64 v118, v118 clamp
    v_exp_f32_e64 v119, v119 clamp
    v_exp_f32_e64 v124, v124 clamp
    v_exp_f32_e64 v125, v125 clamp
    v_exp_f32_e64 v130, v130 clamp
    v_exp_f32_e64 v131, v131 clamp
    v_exp_f32_e64 v136, v136 clamp
    v_exp_f32_e64 v137, v137 clamp
    v_exp_f32_e64 v142, v142 clamp
    v_exp_f32_e64 v143, v143 clamp
    v_max_f32 v98, 0, v98
    v_max_f32 v99, 0, v99
    v_max_f32 v104, 0, v104
    v_max_f32 v105, 0, v105
    v_max_f32 v110, 0, v110
    v_max_f32 v111, 0, v111
    v_max_f32 v116, 0, v116
    v_max_f32 v117, 0, v117
    v_max_f32 v122, 0, v122
    v_max_f32 v123, 0, v123
    v_max_f32 v128, 0, v128
    v_max_f32 v129, 0, v129
    v_max_f32 v134, 0, v134
    v_max_f32 v135, 0, v135
    v_max_f32 v140, 0, v140
    v_max_f32 v141, 0, v141
    v_pk_add_f32 v[100:101], v[100:101], v[98:99]
    v_pk_add_f32 v[106:107], v[106:107], v[104:105]
    v_pk_add_f32 v[112:113], v[112:113], v[110:111]
    v_pk_add_f32 v[118:119], v[118:119], v[116:117]
    v_pk_add_f32 v[124:125], v[124:125], v[122:123]
    v_pk_add_f32 v[130:131], v[130:131], v[128:129]
    v_pk_add_f32 v[136:137], v[136:137], v[134:135]
    v_pk_add_f32 v[142:143], v[142:143], v[140:141]
    v_cvt_pk_bf16_f32 v24, v100, v101
    v_cvt_pk_bf16_f32 v25, v106, v107
    v_cvt_pk_bf16_f32 v26, v112, v113
    v_cvt_pk_bf16_f32 v27, v118, v119
    v_cvt_pk_bf16_f32 v28, v124, v125
    v_cvt_pk_bf16_f32 v29, v130, v131
    v_cvt_pk_bf16_f32 v30, v136, v137
    v_cvt_pk_bf16_f32 v31, v142, v143
    v_pk_min_u16 v243, v243, v24
    v_pk_min_u16 v243, v243, v25
    v_pk_min_u16 v243, v243, v26
    v_pk_min_u16 v243, v243, v27
    v_pk_min_u16 v243, v243, v28
    v_pk_min_u16 v243, v243, v29
    v_pk_min_u16 v243, v243, v30
    v_pk_min_u16 v243, v243, v31
    v_cvt_pk_bf16_f32 v56, v184, v185
    v_cvt_pk_bf16_f32 v57, v186, v187
    v_cvt_pk_bf16_f32 v58, v220, v221
    v_cvt_pk_bf16_f32 v59, v222, v223
    v_lshlrev_b32 v98, 16, v56
    v_and_b32 v99, 0xffff0000, v56
    v_lshlrev_b32 v104, 16, v57
    v_and_b32 v105, 0xffff0000, v57
    v_lshlrev_b32 v110, 16, v58
    v_and_b32 v111, 0xffff0000, v58
    v_lshlrev_b32 v116, 16, v59
    v_and_b32 v117, 0xffff0000, v59
    v_pk_mul_f32 v[100:101], v[98:99], s[60:61]
    v_pk_mul_f32 v[106:107], v[104:105], s[60:61]
    v_pk_mul_f32 v[112:113], v[110:111], s[60:61]
    v_pk_mul_f32 v[118:119], v[116:117], s[60:61]
    v_exp_f32_e64 v100, v100 clamp
    v_exp_f32_e64 v101, v101 clamp
    v_exp_f32_e64 v106, v106 clamp
    v_exp_f32_e64 v107, v107 clamp
    v_exp_f32_e64 v112, v112 clamp
    v_exp_f32_e64 v113, v113 clamp
    v_exp_f32_e64 v118, v118 clamp
    v_exp_f32_e64 v119, v119 clamp
    v_max_f32 v98, 0, v98
    v_max_f32 v99, 0, v99
    v_max_f32 v104, 0, v104
    v_max_f32 v105, 0, v105
    v_max_f32 v110, 0, v110
    v_max_f32 v111, 0, v111
    v_max_f32 v116, 0, v116
    v_max_f32 v117, 0, v117
    v_pk_add_f32 v[100:101], v[100:101], v[98:99]
    v_pk_add_f32 v[106:107], v[106:107], v[104:105]
    v_pk_add_f32 v[112:113], v[112:113], v[110:111]
    v_pk_add_f32 v[118:119], v[118:119], v[116:117]
    v_cvt_pk_bf16_f32 v32, v100, v101
    v_cvt_pk_bf16_f32 v33, v106, v107
    v_cvt_pk_bf16_f32 v34, v112, v113
    v_cvt_pk_bf16_f32 v35, v118, v119
    v_pk_min_u16 v243, v243, v32
    v_pk_min_u16 v243, v243, v33
    v_pk_min_u16 v243, v243, v34
    v_pk_min_u16 v243, v243, v35
    v_lshrrev_b32 v96, 16, v243
    v_and_b32 v97, 0xffff, v243
    v_min_u32 v96, v96, v97
    v_cmp_gt_u32 vcc, 0x3a00, v96
    s_cbranch_vccz K1_KFIX

    v_lshlrev_b32 v96, 16, v16
    v_and_b32 v97, 0xffff0000, v16
    v_pk_add_f32 v[96:97], v[96:97], s[62:63]
    v_cvt_pk_bf16_f32 v16, v96, v97
    v_lshlrev_b32 v96, 16, v17
    v_and_b32 v97, 0xffff0000, v17
    v_pk_add_f32 v[96:97], v[96:97], s[62:63]
    v_cvt_pk_bf16_f32 v17, v96, v97
    v_lshlrev_b32 v96, 16, v18
    v_and_b32 v97, 0xffff0000, v18
    v_pk_add_f32 v[96:97], v[96:97], s[62:63]
    v_cvt_pk_bf16_f32 v18, v96, v97
    v_lshlrev_b32 v96, 16, v19
    v_and_b32 v97, 0xffff0000, v19
    v_pk_add_f32 v[96:97], v[96:97], s[62:63]
    v_cvt_pk_bf16_f32 v19, v96, v97
    v_lshlrev_b32 v96, 16, v20
    v_and_b32 v97, 0xffff0000, v20
    v_pk_add_f32 v[96:97], v[96:97], s[62:63]
    v_cvt_pk_bf16_f32 v20, v96, v97
    v_lshlrev_b32 v96, 16, v21
    v_and_b32 v97, 0xffff0000, v21
    v_pk_add_f32 v[96:97], v[96:97], s[62:63]
    v_cvt_pk_bf16_f32 v21, v96, v97
    v_lshlrev_b32 v96, 16, v22
    v_and_b32 v97, 0xffff0000, v22
    v_pk_add_f32 v[96:97], v[96:97], s[62:63]
    v_cvt_pk_bf16_f32 v22, v96, v97
    v_lshlrev_b32 v96, 16, v23
    v_and_b32 v97, 0xffff0000, v23
    v_pk_add_f32 v[96:97], v[96:97], s[62:63]
    v_cvt_pk_bf16_f32 v23, v96, v97
    v_lshlrev_b32 v96, 16, v24
    v_and_b32 v97, 0xffff0000, v24
    v_pk_add_f32 v[96:97], v[96:97], s[62:63]
    v_cvt_pk_bf16_f32 v24, v96, v97
    v_lshlrev_b32 v96, 16, v25
    v_and_b32 v97, 0xffff0000, v25
    v_pk_add_f32 v[96:97], v[96:97], s[62:63]
    v_cvt_pk_bf16_f32 v25, v96, v97
    v_lshlrev_b32 v96, 16, v26
    v_and_b32 v97, 0xffff0000, v26
    v_pk_add_f32 v[96:97], v[96:97], s[62:63]
    v_cvt_pk_bf16_f32 v26, v96, v97
    v_lshlrev_b32 v96, 16, v27
    v_and_b32 v97, 0xffff0000, v27
    v_pk_add_f32 v[96:97], v[96:97], s[62:63]
    v_cvt_pk_bf16_f32 v27, v96, v97
    v_lshlrev_b32 v96, 16, v28
    v_and_b32 v97, 0xffff0000, v28
    v_pk_add_f32 v[96:97], v[96:97], s[62:63]
    v_cvt_pk_bf16_f32 v28, v96, v97
    v_lshlrev_b32 v96, 16, v29
    v_and_b32 v97, 0xffff0000, v29
    v_pk_add_f32 v[96:97], v[96:97], s[62:63]
    v_cvt_pk_bf16_f32 v29, v96, v97
    v_lshlrev_b32 v96, 16, v30
    v_and_b32 v97, 0xffff0000, v30
    v_pk_add_f32 v[96:97], v[96:97], s[62:63]
    v_cvt_pk_bf16_f32 v30, v96, v97
    v_lshlrev_b32 v96, 16, v31
    v_and_b32 v97, 0xffff0000, v31
    v_pk_add_f32 v[96:97], v[96:97], s[62:63]
    v_cvt_pk_bf16_f32 v31, v96, v97
    v_lshlrev_b32 v96, 16, v32
    v_and_b32 v97, 0xffff0000, v32
    v_pk_add_f32 v[96:97], v[96:97], s[62:63]
    v_cvt_pk_bf16_f32 v32, v96, v97
    v_lshlrev_b32 v96, 16, v33
    v_and_b32 v97, 0xffff0000, v33
    v_pk_add_f32 v[96:97], v[96:97], s[62:63]
    v_cvt_pk_bf16_f32 v33, v96, v97
    v_lshlrev_b32 v96, 16, v34
    v_and_b32 v97, 0xffff0000, v34
    v_pk_add_f32 v[96:97], v[96:97], s[62:63]
    v_cvt_pk_bf16_f32 v34, v96, v97
    v_lshlrev_b32 v96, 16, v35
    v_and_b32 v97, 0xffff0000, v35
    v_pk_add_f32 v[96:97], v[96:97], s[62:63]
    v_cvt_pk_bf16_f32 v35, v96, v97
K1_KFIX:
    v_cmp_gt_u32 vcc, 8, v10
    v_cvt_pk_bf16_f32 v36, v188, v189
    v_cvt_pk_bf16_f32 v37, v190, v191
    v_cvt_pk_bf16_f32 v38, v224, v225
    v_cvt_pk_bf16_f32 v39, v226, v227
    v_cvt_pk_bf16_f32 v40, v192, v193
    v_cvt_pk_bf16_f32 v41, v194, v195
    v_cvt_pk_bf16_f32 v42, v228, v229
    v_cvt_pk_bf16_f32 v43, v230, v231
    v_cvt_pk_bf16_f32 v44, v196, v197
    v_cvt_pk_bf16_f32 v45, v198, v199
    v_cvt_pk_bf16_f32 v46, v232, v233
    v_cvt_pk_bf16_f32 v47, v234, v235
    v_cvt_pk_bf16_f32 v48, v200, v201
    v_cvt_pk_bf16_f32 v49, v202, v203
    v_cvt_pk_bf16_f32 v50, v236, v237
    v_cvt_pk_bf16_f32 v51, v238, v239
    v_cndmask_b32 v32, v56, v32, vcc
    v_cndmask_b32 v33, v57, v33, vcc
    v_cndmask_b32 v34, v58, v34, vcc
    v_cndmask_b32 v35, v59, v35, vcc
    s_nop 1
    v_mfma_f32_16x16x32_bf16 v[168:171], v[16:19], v[32:35], 0
    v_mfma_f32_16x16x32_bf16 v[172:175], v[16:19], v[36:39], 0
    v_mfma_f32_16x16x32_bf16 v[176:179], v[20:23], v[32:35], 0
    v_mfma_f32_16x16x32_bf16 v[180:183], v[20:23], v[36:39], 0
    v_mfma_f32_16x16x32_bf16 v[184:187], v[20:23], v[40:43], 0
    v_mfma_f32_16x16x32_bf16 v[188:191], v[24:27], v[36:39], 0
    v_mfma_f32_16x16x32_bf16 v[192:195], v[24:27], v[40:43], 0
    v_mfma_f32_16x16x32_bf16 v[196:199], v[24:27], v[44:47], 0
    v_mfma_f32_16x16x32_bf16 v[200:203], v[28:31], v[40:43], 0
    v_mfma_f32_16x16x32_bf16 v[204:207], v[28:31], v[44:47], 0
    v_mfma_f32_16x16x32_bf16 v[208:211], v[28:31], v[48:51], 0
    v_mfma_f32_16x16x32_bf16 v[212:215], v[32:35], v[44:47], 0
    v_mfma_f32_16x16x32_bf16 v[216:219], v[32:35], v[48:51], 0
    s_mov_b32 s64, 0x3f803f80
    v_dot2_f32_bf16 v96, v16, s64, 0
    v_dot2_f32_bf16 v97, v20, s64, 0
    v_dot2_f32_bf16 v98, v24, s64, 0
    v_dot2_f32_bf16 v99, v28, s64, 0
    v_dot2_f32_bf16 v100, v32, s64, 0
    v_dot2_f32_bf16 v96, v17, s64, v96
    v_dot2_f32_bf16 v97, v21, s64, v97
    v_dot2_f32_bf16 v98, v25, s64, v98
    v_dot2_f32_bf16 v99, v29, s64, v99
    v_dot2_f32_bf16 v100, v33, s64, v100
    v_dot2_f32_bf16 v96, v18, s64, v96
    v_dot2_f32_bf16 v97, v22, s64, v97
    v_dot2_f32_bf16 v98, v26, s64, v98
    v_dot2_f32_bf16 v99, v30, s64, v99
    v_dot2_f32_bf16 v100, v34, s64, v100
    v_dot2_f32_bf16 v96, v19, s64, v96
    v_dot2_f32_bf16 v97, v23, s64, v97
    v_dot2_f32_bf16 v98, v27, s64, v98
    v_dot2_f32_bf16 v99, v31, s64, v99
    v_dot2_f32_bf16 v100, v35, s64, v100
    s_barrier
    s_lshl_b32 s15, s3, 10
    v_lshlrev_b32 v12, 4, v1
    v_add_u32 v13, s15, v12

    ds_write_b128 v13, v[168:171] offset:0
    ds_write_b128 v13, v[172:175] offset:4096
    ds_write_b128 v13, v[176:179] offset:8192
    ds_write_b128 v13, v[180:183] offset:12288
    ds_write_b128 v13, v[184:187] offset:16384
    ds_write_b128 v13, v[188:191] offset:20480
    ds_write_b128 v13, v[192:195] offset:24576
    ds_write_b128 v13, v[196:199] offset:28672
    ds_write_b128 v13, v[200:203] offset:32768
    ds_write_b128 v13, v[204:207] offset:36864
    ds_write_b128 v13, v[208:211] offset:40960
    ds_write_b128 v13, v[212:215] offset:45056
    ds_write_b128 v13, v[216:219] offset:49152
    s_lshl_b32 s15, s3, 2
    v_add_u32 v14, s15, v11
    v_mul_u32_u24 v14, 320, v14
    v_lshl_add_u32 v14, v10, 2, v14

    ds_write_b32 v14, v96 offset:53248
    ds_write_b32 v14, v97 offset:53312
    ds_write_b32 v14, v98 offset:53376
    ds_write_b32 v14, v99 offset:53440
    ds_write_b32 v14, v100 offset:53504
    s_waitcnt lgkmcnt(0)
    s_barrier
    s_lshl_b32 s68, s6, 3
    s_add_u32 s68, s68, s11
    s_mul_i32 s68, s68, 13824
    s_add_u32 s68, s68, 0x950000
    s_lshl_b32 s15, s3, 12
    v_add_u32 v13, s15, v12
    s_lshl_b32 s15, s3, 10
    v_add_u32 v14, s15, v12
    ds_read_b128 v[16:19], v13 offset:0
    ds_read_b128 v[20:23], v13 offset:1024
    ds_read_b128 v[24:27], v13 offset:2048
    ds_read_b128 v[28:31], v13 offset:3072
    ds_read_b128 v[32:35], v13 offset:16384
    ds_read_b128 v[36:39], v13 offset:17408
    ds_read_b128 v[40:43], v13 offset:18432
    ds_read_b128 v[44:47], v13 offset:19456
    ds_read_b128 v[48:51], v13 offset:32768
    ds_read_b128 v[52:55], v13 offset:33792
    ds_read_b128 v[56:59], v13 offset:34816
    ds_read_b128 v[60:63], v13 offset:35840
    s_waitcnt lgkmcnt(8)
    v_pk_add_f32 v[16:17], v[16:17], v[20:21]
    v_pk_add_f32 v[18:19], v[18:19], v[22:23]
    v_pk_add_f32 v[24:25], v[24:25], v[28:29]
    v_pk_add_f32 v[26:27], v[26:27], v[30:31]
    v_pk_add_f32 v[16:17], v[16:17], v[24:25]
    v_pk_add_f32 v[18:19], v[18:19], v[26:27]
    s_add_u32 s69, s68, 0
    buffer_store_dwordx4 v[16:19], v14, s[56:59], s69 offen sc1
    s_waitcnt lgkmcnt(4)
    v_pk_add_f32 v[32:33], v[32:33], v[36:37]
    v_pk_add_f32 v[34:35], v[34:35], v[38:39]
    v_pk_add_f32 v[40:41], v[40:41], v[44:45]
    v_pk_add_f32 v[42:43], v[42:43], v[46:47]
    v_pk_add_f32 v[32:33], v[32:33], v[40:41]
    v_pk_add_f32 v[34:35], v[34:35], v[42:43]
    s_add_u32 s69, s68, 4096
    buffer_store_dwordx4 v[32:35], v14, s[56:59], s69 offen sc1
    s_waitcnt lgkmcnt(0)
    v_pk_add_f32 v[48:49], v[48:49], v[52:53]
    v_pk_add_f32 v[50:51], v[50:51], v[54:55]
    v_pk_add_f32 v[56:57], v[56:57], v[60:61]
    v_pk_add_f32 v[58:59], v[58:59], v[62:63]
    v_pk_add_f32 v[48:49], v[48:49], v[56:57]
    v_pk_add_f32 v[50:51], v[50:51], v[58:59]
    s_add_u32 s69, s68, 8192
    buffer_store_dwordx4 v[48:51], v14, s[56:59], s69 offen sc1
    s_cmp_lg_u32 s3, 0
    s_cbranch_scc1 K1_KVZ_1
    ds_read_b128 v[64:67], v13 offset:49152
    ds_read_b128 v[68:71], v13 offset:50176
    ds_read_b128 v[72:75], v13 offset:51200
    ds_read_b128 v[76:79], v13 offset:52224
    s_waitcnt lgkmcnt(0)
    v_pk_add_f32 v[64:65], v[64:65], v[68:69]
    v_pk_add_f32 v[66:67], v[66:67], v[70:71]
    v_pk_add_f32 v[72:73], v[72:73], v[76:77]
    v_pk_add_f32 v[74:75], v[74:75], v[78:79]
    v_pk_add_f32 v[64:65], v[64:65], v[72:73]
    v_pk_add_f32 v[66:67], v[66:67], v[74:75]
    s_add_u32 s69, s68, 12288
    buffer_store_dwordx4 v[64:67], v14, s[56:59], s69 offen sc1
    s_branch K1_KVFIN
K1_KVZ_1:
    s_cmp_lt_u32 s3, 2
    s_cbranch_scc1 K1_KVEND_2
    v_subrev_u32 v14, 128, v0
    v_cmp_gt_u32 vcc, 80, v14
    s_and_saveexec_b64 s[74:75], vcc
    s_cbranch_execz K1_KVEND_2
    v_lshlrev_b32 v15, 2, v14

    ds_read_b32 v96, v15 offset:53248
    ds_read_b32 v97, v15 offset:53568
    ds_read_b32 v98, v15 offset:53888
    ds_read_b32 v99, v15 offset:54208
    ds_read_b32 v100, v15 offset:54528
    ds_read_b32 v101, v15 offset:54848
    ds_read_b32 v102, v15 offset:55168
    ds_read_b32 v103, v15 offset:55488
    ds_read_b32 v104, v15 offset:55808
    ds_read_b32 v105, v15 offset:56128
    ds_read_b32 v106, v15 offset:56448
    ds_read_b32 v107, v15 offset:56768
    ds_read_b32 v108, v15 offset:57088
    ds_read_b32 v109, v15 offset:57408
    ds_read_b32 v110, v15 offset:57728
    ds_read_b32 v111, v15 offset:58048
    s_add_u32 s69, s68, 13312
    s_waitcnt lgkmcnt(0)
    v_add_f32 v96, v96, v104
    v_add_f32 v97, v97, v105
    v_add_f32 v98, v98, v106
    v_add_f32 v99, v99, v107
    v_add_f32 v100, v100, v108
    v_add_f32 v101, v101, v109
    v_add_f32 v102, v102, v110
    v_add_f32 v103, v103, v111
    v_add_f32 v96, v96, v100
    v_add_f32 v97, v97, v101
    v_add_f32 v98, v98, v102
    v_add_f32 v99, v99, v103
    v_add_f32 v96, v96, v98
    v_add_f32 v97, v97, v99
    v_add_f32 v96, v96, v97
    buffer_store_dword v96, v15, s[56:59], s69 offen sc1
K1_KVEND_2:
K1_KVFIN:
    s_mov_b32 s48, s44
    s_and_b32 s49, s45, 0xffff
    s_mov_b32 s50, 0x100
    s_mov_b32 s51, 0x20000
    s_mov_b64 exec, -1
    s_waitcnt vmcnt(0)
    s_barrier
    v_mov_b32 v3, 0
    s_cmp_lg_u32 s3, 0
    s_cbranch_scc1 K1_KVW
    v_mov_b32 v2, 1
    s_lshr_b32 s12, s11, 1
    s_lshl_b32 s12, s12, 4
    s_add_u32 s12, s12, 160
    s_mov_b64 exec, 1
    buffer_atomic_add v2, v3, s[48:51], s12 offen sc0 sc1
    s_waitcnt vmcnt(0)
    v_readfirstlane_b32 s12, v2
    s_mov_b64 exec, -1
    s_cmp_lg_u32 s12, 31
    s_cbranch_scc1 K1_KVP
    v_mov_b32 v2, 1
    v_lshlrev_b32 v4, 7, v1
    s_lshr_b32 s12, s11, 1
    s_lshl_b32 s12, s12, 12
    s_add_u32 s12, s12, 0xb60000
    s_mov_b32 exec_hi, 0
    buffer_store_dword v2, v4, s[56:59], s12 offen sc1
    s_mov_b32 exec_hi, -1
    s_branch K1_KVW

K1_KVP:
    s_cmp_ge_u32 s98, 22
    s_cbranch_scc1 K1_KVEXIT
    s_mov_b32 s72, 0
    s_mov_b64 exec, 1

K1_KVPL:
    buffer_load_dword v2, v3, s[56:59], s99 offen sc1
    s_add_u32 s72, s72, 1
    s_waitcnt vmcnt(0)
    v_readfirstlane_b32 s12, v2
    s_cmp_eq_u32 s12, 1
    s_cbranch_scc1 K1_KVW
    s_cmp_gt_u32 s72, 0x8000
    s_cbranch_scc1 K1_KVW
    s_sleep 2
    s_branch K1_KVPL

K1_KVW:
    s_mov_b64 exec, -1
    s_cmp_ge_u32 s98, 22
    s_cbranch_scc1 K1_KVEXIT
    s_barrier
    v_lshlrev_b32 v3, 4, v1
    s_lshr_b32 s12, s11, 1
    s_mul_i32 s12, s12, 22
    s_add_u32 s15, s12, s98

    s_mul_i32 s64, s15, 94
    s_lshr_b32 s64, s64, 11
    s_mul_i32 s65, s64, 22
    s_sub_u32 s65, s15, s65
    s_mov_b32 s66, 0x110fffff
    s_mov_b32 s67, 0x55443322
    s_mov_b32 s68, 0x10043210
    s_mov_b32 s69, 0x32212110
    s_cmp_ge_u32 s65, 16
    s_cselect_b32 s66, 0x887766, s66
    s_cselect_b32 s68, 0x434332, s68
    s_and_b32 s70, s65, 15
    s_lshl_b32 s70, s70, 2
    s_lshr_b64 s[66:67], s[66:67], s70
    s_lshr_b64 s[68:69], s[68:69], s70
    s_and_b32 s66, s66, 15
    s_and_b32 s68, s68, 15
    s_lshl_b32 s70, s68, 5
    v_lshl_add_u32 v16, v11, 3, s70
    s_cmp_eq_u32 s66, 15
    s_cbranch_scc1 K1_RZ
    s_lshl_b32 s70, s66, 4
    v_add_u32 v17, s70, v10
    v_mul_u32_u24 v18, 57, v17
    v_lshrrev_b32 v18, 10, v18
    v_lshrrev_b32 v19, 2, v18
    v_mul_u32_u24 v20, 72, v19
    v_sub_u32 v21, v17, v20
    v_add_u32 v21, 72, v21
    v_sub_u32 v22, v16, v20
    v_lshrrev_b32 v23, 4, v22
    v_lshrrev_b32 v24, 4, v21
    v_lshl_add_u32 v23, v23, 1, v24
    v_subrev_u32 v23, 4, v23
    v_and_b32 v24, 15, v21
    v_and_b32 v25, 12, v22
    v_lshl_add_u32 v24, v25, 2, v24
    v_lshlrev_b32 v24, 4, v24
    v_lshl_add_u32 v24, v23, 10, v24
    v_add_u32 v25, 256, v24
    s_mov_b64 s[74:75], -1
    s_branch K1_RC

K1_RZ:
    v_lshrrev_b32 v18, 2, v10
    v_lshlrev_b32 v18, 1, v18
    v_and_b32 v19, 1, v10
    v_add_u32 v18, v18, v19
    v_and_b32 v19, 2, v10
    v_cmp_eq_u32 s[74:75], 0, v19
    v_lshrrev_b32 v19, 2, v18
    v_mul_u32_u24 v20, 72, v19
    v_sub_u32 v22, v16, v20
    v_lshlrev_b32 v24, 2, v22
    v_add_u32 v24, 13312, v24
    v_add_u32 v25, 16, v24

K1_RC:
    v_mul_u32_u24 v26, 18, v18
    v_sub_u32 v26, v26, v16
    v_add_u32 v27, 17, v26
    v_cmp_gt_u32 vcc, 25, v27
    s_and_b64 s[74:75], s[74:75], vcc
    s_lshl_b32 s70, s64, 1
    v_add_u32 v19, s70, v19
    v_mul_u32_u24 v19, 13824, v19
    v_add_u32 v24, v24, v19
    v_add_u32 v25, v25, v19
    v_mov_b32 v27, 0x40000000
    v_cndmask_b32 v24, v27, v24, s[74:75]
    v_cndmask_b32 v25, v27, v25, s[74:75]
    s_mul_i32 s70, s3, 442368
    s_add_u32 s70, s70, 0x950000

    buffer_load_dwordx4 v[32:35], v24, s[56:59], s70 offen sc1
    buffer_load_dwordx4 v[36:39], v25, s[56:59], s70 offen sc1
    s_add_u32 s70, s70, 110592
    buffer_load_dwordx4 v[40:43], v24, s[56:59], s70 offen sc1
    buffer_load_dwordx4 v[44:47], v25, s[56:59], s70 offen sc1
    s_add_u32 s70, s70, 110592
    buffer_load_dwordx4 v[48:51], v24, s[56:59], s70 offen sc1
    buffer_load_dwordx4 v[52:55], v25, s[56:59], s70 offen sc1
    s_add_u32 s70, s70, 110592
    buffer_load_dwordx4 v[56:59], v24, s[56:59], s70 offen sc1
    buffer_load_dwordx4 v[60:63], v25, s[56:59], s70 offen sc1
    s_lshl_b32 s70, s15, 10
    s_add_u32 s70, s70, 0xb00000
    s_lshl_b32 s71, s3, 11
    s_add_u32 s71, s71, 1024
    v_add_u32 v2, s71, v3
    s_waitcnt vmcnt(0)

    v_pk_add_f32 v[32:33], v[32:33], v[48:49]
    v_pk_add_f32 v[34:35], v[34:35], v[50:51]
    v_pk_add_f32 v[36:37], v[36:37], v[52:53]
    v_pk_add_f32 v[38:39], v[38:39], v[54:55]
    v_pk_add_f32 v[40:41], v[40:41], v[56:57]
    v_pk_add_f32 v[42:43], v[42:43], v[58:59]
    v_pk_add_f32 v[44:45], v[44:45], v[60:61]
    v_pk_add_f32 v[46:47], v[46:47], v[62:63]
    v_pk_add_f32 v[32:33], v[32:33], v[40:41]
    v_pk_add_f32 v[34:35], v[34:35], v[42:43]
    v_pk_add_f32 v[36:37], v[36:37], v[44:45]
    v_pk_add_f32 v[38:39], v[38:39], v[46:47]
    ds_write_b128 v2, v[32:35]
    ds_write_b128 v2, v[36:39] offset:1024
    s_waitcnt lgkmcnt(0)
    s_barrier
    s_cmp_lg_u32 s3, 0
    s_cbranch_scc1 K1_KVEXIT
    ds_read_b128 v[40:43], v2 offset:2048
    ds_read_b128 v[44:47], v2 offset:3072
    ds_read_b128 v[48:51], v2 offset:4096
    ds_read_b128 v[52:55], v2 offset:5120
    ds_read_b128 v[56:59], v2 offset:6144
    ds_read_b128 v[60:63], v2 offset:7168
    s_waitcnt lgkmcnt(0)
    v_pk_add_f32 v[32:33], v[32:33], v[48:49]
    v_pk_add_f32 v[34:35], v[34:35], v[50:51]
    v_pk_add_f32 v[36:37], v[36:37], v[52:53]
    v_pk_add_f32 v[38:39], v[38:39], v[54:55]
    v_pk_add_f32 v[40:41], v[40:41], v[56:57]
    v_pk_add_f32 v[42:43], v[42:43], v[58:59]
    v_pk_add_f32 v[44:45], v[44:45], v[60:61]
    v_pk_add_f32 v[46:47], v[46:47], v[62:63]
    v_pk_add_f32 v[32:33], v[32:33], v[40:41]
    v_pk_add_f32 v[34:35], v[34:35], v[42:43]
    v_pk_add_f32 v[36:37], v[36:37], v[44:45]
    v_pk_add_f32 v[38:39], v[38:39], v[46:47]
    v_sub_u32 v27, 0, v26
    v_cmp_gt_u32 vcc, 18, v27
    s_and_b64 vcc, vcc, s[74:75]
    s_nop 0
    v_cndmask_b32 v32, 0, v32, vcc
    v_sub_u32 v27, 1, v26
    v_cmp_gt_u32 vcc, 18, v27
    s_and_b64 vcc, vcc, s[74:75]
    s_nop 0
    v_cndmask_b32 v33, 0, v33, vcc
    v_sub_u32 v27, 2, v26
    v_cmp_gt_u32 vcc, 18, v27
    s_and_b64 vcc, vcc, s[74:75]
    s_nop 0
    v_cndmask_b32 v34, 0, v34, vcc
    v_sub_u32 v27, 3, v26
    v_cmp_gt_u32 vcc, 18, v27
    s_and_b64 vcc, vcc, s[74:75]
    s_nop 0
    v_cndmask_b32 v35, 0, v35, vcc
    v_sub_u32 v27, 4, v26
    v_cmp_gt_u32 vcc, 18, v27
    s_and_b64 vcc, vcc, s[74:75]
    s_nop 0
    v_cndmask_b32 v36, 0, v36, vcc
    v_sub_u32 v27, 5, v26
    v_cmp_gt_u32 vcc, 18, v27
    s_and_b64 vcc, vcc, s[74:75]
    s_nop 0
    v_cndmask_b32 v37, 0, v37, vcc
    v_sub_u32 v27, 6, v26
    v_cmp_gt_u32 vcc, 18, v27
    s_and_b64 vcc, vcc, s[74:75]
    s_nop 0
    v_cndmask_b32 v38, 0, v38, vcc
    v_sub_u32 v27, 7, v26
    v_cmp_gt_u32 vcc, 18, v27
    s_and_b64 vcc, vcc, s[74:75]
    s_nop 0
    v_cndmask_b32 v39, 0, v39, vcc
    v_cvt_pk_bf16_f32 v28, v32, v33
    v_cvt_pk_bf16_f32 v29, v34, v35
    v_cvt_pk_bf16_f32 v30, v36, v37
    v_cvt_pk_bf16_f32 v31, v38, v39
    buffer_store_dwordx4 v[28:31], v3, s[56:59], s70 offen
K1_KVEXIT:
    s_endpgm
K1_PREP:
    s_setprio 0
    s_and_b32 s64, s2, 7
    s_lshr_b32 s65, s2, 3
    s_lshl_b32 s65, s65, 2
    s_add_u32 s65, s65, s3
    s_lshl_b32 s67, s65, 6
    v_add_u32 v28, s67, v1
    v_mul_u32_u24 v29, 34953, v28
    v_lshrrev_b32 v29, 19, v29
    v_mul_u32_u24 v30, 15, v29
    v_sub_u32 v30, v28, v30
    v_mul_u32_u24 v31, 52, v30
    v_lshrrev_b32 v31, 8, v31
    v_mul_u32_u24 v32, 5, v31
    v_sub_u32 v32, v30, v32
    v_mul_u32_u24 v29, 3456, v29
    v_mul_u32_u24 v31, 1152, v31
    v_add_u32 v29, v29, v31
    v_lshl_add_u32 v29, v32, 7, v29
    s_lshr_b32 s66, s64, 2
    s_lshl_b32 s66, s66, 9
    s_and_b32 s67, s64, 3
    s_mul_i32 s67, s67, 589824
    s_lshl_b32 s65, s65, 12
    s_add_u32 s67, s67, s65
    v_lshlrev_b32 v28, 7, v1
    s_waitcnt lgkmcnt(0)

    s_mov_b32 s48, s16
    s_and_b32 s49, s17, 0xffff
    s_mov_b32 s50, 0x240000
    s_mov_b32 s51, 0x20000
    s_mov_b32 s52, s18
    s_and_b32 s53, s19, 0xffff
    s_mov_b32 s54, 0x1e6000
    s_mov_b32 s55, 0x20000
    s_mov_b32 s4, s2
    s_mul_i32 s5, s4, 7282
    s_lshr_b32 s5, s5, 16
    s_mul_i32 s6, s5, 9
    s_sub_u32 s6, s4, s6
    s_lshr_b32 s7, s3, 1
    s_lshl_b32 s78, s6, 5
    s_add_u32 s78, s78, s5
    s_lshl_b32 s8, s78, 1
    s_add_u32 s8, s8, s7
    s_and_b32 s9, s3, 1
    s_mul_i32 s10, s3, 14416
    s_add_u32 s10, s10, 9216
    v_and_b32 v10, 15, v1
    v_lshrrev_b32 v11, 4, v1

    s_lshl_b32 s11, s8, 8
    s_lshl_b32 s12, s9, 7
    s_add_u32 s11, s11, s12
    v_lshl_add_u32 v2, v1, 1, s11
    s_lshl_b32 s12, s78, 2
    s_waitcnt lgkmcnt(0)
    s_load_dword s13, s[36:37], s12
    s_load_dword s97, s[38:39], s12
    global_load_ushort v12, v2, s[24:25]
    global_load_ushort v13, v2, s[26:27]
    global_load_ushort v14, v2, s[28:29]
    global_load_ushort v15, v2, s[30:31]
    global_load_ushort v16, v2, s[32:33]
    global_load_ushort v17, v2, s[34:35]

    s_lshl_b32 s11, s5, 6
    s_lshl_b32 s12, s3, 4
    s_add_u32 s11, s11, s12
    v_lshrrev_b32 v3, 3, v1
    v_add_u32 v3, s11, v3
    v_mul_u32_u24 v3, 1152, v3
    v_and_b32 v4, 7, v1
    v_lshl_add_u32 v3, v4, 4, v3
    s_lshl_b32 s11, s6, 7
    v_add_u32 v3, s11, v3
    v_add_u32 v4, 9216, v3
    global_load_dwordx4 v[20:23], v3, s[16:17]
    global_load_dwordx4 v[24:27], v4, s[16:17]

    buffer_load_dword v78, v29, s[52:55], s66 offen
    s_mov_b32 exec_hi, 0
    buffer_load_dword v79, v28, s[48:51], s67 offen
    s_mov_b32 exec_hi, -1

    s_mov_b32 s56, s46
    s_and_b32 s57, s47, 0xffff
    s_mov_b32 s58, 0xb70000
    s_mov_b32 s59, 0x20000
    s_mov_b32 s60, 0x0000bf80
    s_mov_b32 s61, 0xbf800000
    s_waitcnt vmcnt(2) lgkmcnt(0)
    s_lshl_b32 s11, s3, 11
    s_add_u32 s11, s11, 66880
    v_lshl_add_u32 v7, v1, 4, s11
    ds_write_b128 v7, v[20:23]
    ds_write_b128 v7, v[24:27] offset:1024
    v_lshrrev_b32 v8, 2, v10
    v_lshl_add_u32 v8, v11, 4, v8
    v_lshlrev_b32 v8, 7, v8
    v_and_b32 v9, 3, v1
    v_lshl_add_u32 v8, v9, 3, v8
    s_lshl_b32 s11, s3, 5
    s_add_u32 s11, s11, 66880
    v_add_u32 v8, s11, v8
    s_waitcnt lgkmcnt(0)
    s_barrier
    ds_read_b64_tr_b16 v[20:21], v8
    ds_read_b64_tr_b16 v[22:23], v8 offset:512
    ds_read_b64_tr_b16 v[24:25], v8 offset:1024
    ds_read_b64_tr_b16 v[26:27], v8 offset:1536
    v_mul_u32_u24 v9, 144, v10
    v_lshl_add_u32 v9, v11, 5, v9
    v_add_u32 v9, s10, v9
    v_lshrrev_b32 v7, 3, v1
    v_mul_u32_u24 v8, 144, v7
    v_and_b32 v6, 7, v1
    v_lshl_add_u32 v8, v6, 4, v8
    v_add_u32 v8, s10, v8
    s_lshl_b32 s11, s6, 6
    s_lshl_b32 s12, s3, 4
    s_add_u32 s11, s11, s12
    v_add_u32 v7, s11, v7
    v_mul_u32_u24 v7, 4352, v7
    v_lshl_add_u32 v6, v6, 4, v7
    s_lshl_b32 s15, s5, 7
    s_add_u32 s15, s15, 0x240000
    s_add_u32 s98, s15, 34816
    s_waitcnt lgkmcnt(0)
    ds_write_b128 v9, v[20:23]
    ds_write_b128 v9, v[24:27] offset:16
    ds_read_b128 v[248:251], v8
    ds_read_b128 v[252:255], v8 offset:1152

    s_waitcnt lgkmcnt(0)
    buffer_store_dwordx4 v[248:251], v6, s[56:59], s15 offen sc1
    buffer_store_dwordx4 v[252:255], v6, s[56:59], s98 offen sc1
    s_lshl_b32 s11, s78, 7
    s_add_u32 s11, s11, 0xb40000
    s_lshl_b32 s12, s4, 7
    s_add_u32 s12, s12, 0xb50000
    s_cmp_eq_u32 s3, 0
    s_cselect_b32 s11, s11, s12
    v_mov_b32 v2, 0
    s_mov_b64 exec, 1
    buffer_store_dword v2, v2, s[56:59], s11 offen sc1
    s_mov_b64 exec, -1

    s_setprio 0
    s_lshl_b32 s12, s7, 4
    s_lshr_b32 s13, s13, s12
    s_lshl_b32 s13, s13, 16
    v_mov_b32 v18, s13
    v_mul_f32 v18, 0x3fb8aa3b, v18
    v_exp_f32 v18, v18
    v_lshlrev_b32 v12, 16, v12
    v_lshlrev_b32 v13, 16, v13
    v_cvt_pk_bf16_f32 v18, v18, v18
    v_lshlrev_b32 v14, 16, v14
    v_lshlrev_b32 v15, 16, v15
    v_lshlrev_b32 v18, 16, v18
    v_lshlrev_b32 v16, 16, v16
    v_lshlrev_b32 v17, 16, v17
    v_mul_f32 v12, v18, v12
    v_mul_f32 v13, v18, v13
    v_mul_f32 v14, v18, v14
    v_mul_f32 v15, v18, v15
    v_mul_f32 v28, 0x3fb8aa3b, v12
    v_mul_f32 v29, 0x3e22f983, v13
    v_mov_b32 v30, v28
    v_sub_f32 v31, 0, v29

    v_pk_mul_f32 v[34:35], v[16:17], v[14:15] op_sel:[1,1] op_sel_hi:[1,0]
    v_pk_fma_f32 v[32:33], v[16:17], v[14:15], v[34:35] op_sel:[0,0,0] op_sel_hi:[0,1,1] neg_lo:[0,0,1]
    v_sub_f32 v33, 0, v33
    v_max_f32_e64 v34, abs(v32), abs(v33)
    s_nop 1
    v_max_f32_dpp v34, v34, v34 quad_perm:[1,0,3,2] row_mask:0xf bank_mask:0xf
    s_nop 1
    v_max_f32_dpp v34, v34, v34 quad_perm:[2,3,0,1] row_mask:0xf bank_mask:0xf
    s_nop 1
    v_max_f32_dpp v34, v34, v34 row_half_mirror row_mask:0xf bank_mask:0xf
    s_nop 1
    v_max_f32_dpp v34, v34, v34 row_mirror row_mask:0xf bank_mask:0xf
    s_nop 0
    v_readlane_b32 s64, v34, 0
    v_readlane_b32 s65, v34, 16
    v_readlane_b32 s66, v34, 32
    v_readlane_b32 s67, v34, 48
    s_nop 3
    s_max_u32 s64, s64, s65
    s_max_u32 s66, s66, s67
    s_max_u32 s64, s64, s66
    s_lshr_b32 s64, s64, 23
    s_sub_u32 s64, 263, s64
    s_min_u32 s64, s64, 227
    s_max_u32 s64, s64, 27
    s_lshl_b32 s66, s64, 23
    s_mov_b32 s67, s66
    s_sub_u32 s99, 254, s64
    s_lshl_b32 s99, s99, 23
    v_pk_mul_f32 v[32:33], v[32:33], s[66:67]

    v_lshl_add_u32 v7, v1, 2, s10
    v_mul_f32 v80, 0x41000000, v28
    v_mul_f32 v81, 0x41000000, v29
    v_mul_f32 v84, 0x41800000, v28
    v_mul_f32 v85, 0x41800000, v29
    v_mul_f32 v88, 0x42000000, v28
    v_mul_f32 v89, 0x42000000, v29
    v_mul_f32 v92, 0x42800000, v28
    v_mul_f32 v93, 0x42800000, v29
    v_mul_f32 v96, 0x43000000, v28
    v_mul_f32 v97, 0x43000000, v29
    v_fract_f32 v81, v81
    v_exp_f32 v80, v80
    v_fract_f32 v85, v85
    v_exp_f32 v84, v84
    v_fract_f32 v89, v89
    v_exp_f32 v88, v88
    v_fract_f32 v93, v93
    v_exp_f32 v92, v92
    v_fract_f32 v97, v97
    v_exp_f32 v96, v96
    v_cos_f32 v82, v81
    v_sin_f32 v83, v81
    v_cos_f32 v86, v85
    v_sin_f32 v87, v85
    v_cos_f32 v90, v89
    v_sin_f32 v91, v89
    v_cos_f32 v94, v93
    v_sin_f32 v95, v93
    v_cos_f32 v98, v97
    v_sin_f32 v99, v97
    s_nop 0
    v_pk_mul_f32 v[42:43], v[80:81], v[82:83] op_sel:[0,0] op_sel_hi:[0,1]
    v_pk_mul_f32 v[44:45], v[84:85], v[86:87] op_sel:[0,0] op_sel_hi:[0,1]
    v_pk_mul_f32 v[48:49], v[88:89], v[90:91] op_sel:[0,0] op_sel_hi:[0,1]
    v_pk_mul_f32 v[56:57], v[92:93], v[94:95] op_sel:[0,0] op_sel_hi:[0,1]
    v_pk_mul_f32 v[72:73], v[96:97], v[98:99] op_sel:[0,0] op_sel_hi:[0,1]
    s_mov_b32 s48, s44
    s_and_b32 s49, s45, 0xffff
    s_mov_b32 s50, 0x100
    s_mov_b32 s51, 0x20000
    s_waitcnt vmcnt(0)
    s_barrier
    s_cmp_lg_u32 s3, 1
    s_cbranch_scc1 K1_NOPUB_3
    v_mov_b32 v2, 1
    v_mov_b32 v3, 0
    s_lshl_b32 s11, s6, 4
    s_mov_b64 exec, 1
    buffer_atomic_add v2, v3, s[48:51], s11 offen sc0 sc1
    s_waitcnt vmcnt(0)
    v_readfirstlane_b32 s11, v2
    s_mov_b64 exec, -1
    s_cmp_lg_u32 s11, 31
    s_cbranch_scc1 K1_NOPUB_3
    v_mov_b32 v2, 1
    v_lshlrev_b32 v3, 7, v1
    s_lshl_b32 s11, s6, 12
    s_add_u32 s11, s11, 0xb40000
    s_mov_b32 exec_hi, 0
    buffer_store_dword v2, v3, s[56:59], s11 offen sc1
    s_mov_b32 exec_hi, -1

K1_NOPUB_3:
    s_setprio 0
    s_cmp_eq_u32 s3, 3
    s_cselect_b32 s14, 1, 0
    s_cmp_lt_u32 s4, 256
    s_cselect_b32 s14, s14, 0
    s_cmp_eq_u32 s14, 0
    s_cbranch_scc1 K1_NOG_4
    s_lshl_b32 s11, s4, 3
    v_lshrrev_b32 v4, 3, v1
    v_add_u32 v4, s11, v4
    v_mul_u32_u24 v5, 1152, v4
    v_and_b32 v6, 7, v1
    v_lshlrev_b32 v6, 4, v6
    v_add_u32 v5, v5, v6

    global_load_dwordx4 v[176:179], v5, s[16:17] offset:0
    global_load_dwordx4 v[212:215], v6, s[40:41] offset:0
    global_load_dwordx4 v[180:183], v5, s[16:17] offset:128
    global_load_dwordx4 v[216:219], v6, s[40:41] offset:128
    global_load_dwordx4 v[184:187], v5, s[16:17] offset:256
    global_load_dwordx4 v[220:223], v6, s[40:41] offset:256
    global_load_dwordx4 v[188:191], v5, s[16:17] offset:384
    global_load_dwordx4 v[224:227], v6, s[40:41] offset:384
    global_load_dwordx4 v[192:195], v5, s[16:17] offset:512
    global_load_dwordx4 v[228:231], v6, s[40:41] offset:512
    global_load_dwordx4 v[196:199], v5, s[16:17] offset:640
    global_load_dwordx4 v[232:235], v6, s[40:41] offset:640
    global_load_dwordx4 v[200:203], v5, s[16:17] offset:768
    global_load_dwordx4 v[236:239], v6, s[40:41] offset:768
    global_load_dwordx4 v[204:207], v5, s[16:17] offset:896
    global_load_dwordx4 v[240:243], v6, s[40:41] offset:896
    global_load_dwordx4 v[208:211], v5, s[16:17] offset:1024
    global_load_dwordx4 v[244:247], v6, s[40:41] offset:1024
K1_NOG_4:
    v_mov_b32 v80, 0x3c00
    ds_write_b32 v7, v80
    v_pk_mul_f32 v[112:113], v[44:45], v[42:43] op_sel:[1,1] op_sel_hi:[1,0]
    v_pk_fma_f32 v[46:47], v[44:45], v[42:43], v[112:113] op_sel:[0,0,0] op_sel_hi:[0,1,1] neg_lo:[0,0,1]
    v_pk_mul_f32 v[114:115], v[48:49], v[42:43] op_sel:[1,1] op_sel_hi:[1,0]
    v_pk_fma_f32 v[50:51], v[48:49], v[42:43], v[114:115] op_sel:[0,0,0] op_sel_hi:[0,1,1] neg_lo:[0,0,1]
    v_pk_mul_f32 v[116:117], v[48:49], v[44:45] op_sel:[1,1] op_sel_hi:[1,0]
    v_pk_fma_f32 v[52:53], v[48:49], v[44:45], v[116:117] op_sel:[0,0,0] op_sel_hi:[0,1,1] neg_lo:[0,0,1]
    v_pk_mul_f32 v[118:119], v[56:57], v[42:43] op_sel:[1,1] op_sel_hi:[1,0]
    v_pk_fma_f32 v[58:59], v[56:57], v[42:43], v[118:119] op_sel:[0,0,0] op_sel_hi:[0,1,1] neg_lo:[0,0,1]
    v_pk_mul_f32 v[120:121], v[56:57], v[44:45] op_sel:[1,1] op_sel_hi:[1,0]
    v_pk_fma_f32 v[60:61], v[56:57], v[44:45], v[120:121] op_sel:[0,0,0] op_sel_hi:[0,1,1] neg_lo:[0,0,1]
    v_pk_mul_f32 v[122:123], v[56:57], v[48:49] op_sel:[1,1] op_sel_hi:[1,0]
    v_pk_fma_f32 v[64:65], v[56:57], v[48:49], v[122:123] op_sel:[0,0,0] op_sel_hi:[0,1,1] neg_lo:[0,0,1]
    v_pk_mul_f32 v[112:113], v[48:49], v[46:47] op_sel:[1,1] op_sel_hi:[1,0]
    v_pk_fma_f32 v[54:55], v[48:49], v[46:47], v[112:113] op_sel:[0,0,0] op_sel_hi:[0,1,1] neg_lo:[0,0,1]
    v_pk_mul_f32 v[114:115], v[56:57], v[46:47] op_sel:[1,1] op_sel_hi:[1,0]
    v_pk_fma_f32 v[62:63], v[56:57], v[46:47], v[114:115] op_sel:[0,0,0] op_sel_hi:[0,1,1] neg_lo:[0,0,1]
    v_pk_mul_f32 v[116:117], v[56:57], v[50:51] op_sel:[1,1] op_sel_hi:[1,0]
    v_pk_fma_f32 v[66:67], v[56:57], v[50:51], v[116:117] op_sel:[0,0,0] op_sel_hi:[0,1,1] neg_lo:[0,0,1]
    v_pk_mul_f32 v[118:119], v[56:57], v[52:53] op_sel:[1,1] op_sel_hi:[1,0]
    v_pk_fma_f32 v[68:69], v[56:57], v[52:53], v[118:119] op_sel:[0,0,0] op_sel_hi:[0,1,1] neg_lo:[0,0,1]
    v_pk_mul_f32 v[120:121], v[56:57], v[54:55] op_sel:[1,1] op_sel_hi:[1,0]
    v_pk_fma_f32 v[70:71], v[56:57], v[54:55], v[120:121] op_sel:[0,0,0] op_sel_hi:[0,1,1] neg_lo:[0,0,1]
    v_cvt_pk_f16_f32 v80, v42, v43
    v_cvt_pk_f16_f32 v81, v44, v45
    v_cvt_pk_f16_f32 v82, v46, v47
    v_cvt_pk_f16_f32 v83, v48, v49
    v_cvt_pk_f16_f32 v84, v50, v51
    v_cvt_pk_f16_f32 v85, v52, v53
    v_cvt_pk_f16_f32 v86, v54, v55
    v_cvt_pk_f16_f32 v87, v56, v57
    ds_write_b32 v7, v80 offset:272
    ds_write_b32 v7, v81 offset:544
    ds_write_b32 v7, v82 offset:816
    ds_write_b32 v7, v83 offset:1088
    ds_write_b32 v7, v84 offset:1360
    ds_write_b32 v7, v85 offset:1632
    ds_write_b32 v7, v86 offset:1904
    ds_write_b32 v7, v87 offset:2176
    v_cvt_pk_f16_f32 v80, v58, v59
    v_cvt_pk_f16_f32 v81, v60, v61
    v_cvt_pk_f16_f32 v82, v62, v63
    v_cvt_pk_f16_f32 v83, v64, v65
    v_cvt_pk_f16_f32 v84, v66, v67
    v_cvt_pk_f16_f32 v85, v68, v69
    v_cvt_pk_f16_f32 v86, v70, v71
    v_cvt_pk_f16_f32 v87, v72, v73
    ds_write_b32 v7, v80 offset:2448
    ds_write_b32 v7, v81 offset:2720
    ds_write_b32 v7, v82 offset:2992
    ds_write_b32 v7, v83 offset:3264
    ds_write_b32 v7, v84 offset:3536
    ds_write_b32 v7, v85 offset:3808
    ds_write_b32 v7, v86 offset:4080
    ds_write_b32 v7, v87 offset:4352
    v_pk_mul_f32 v[112:113], v[72:73], v[42:43] op_sel:[1,1] op_sel_hi:[1,0]
    v_pk_fma_f32 v[128:129], v[72:73], v[42:43], v[112:113] op_sel:[0,0,0] op_sel_hi:[0,1,1] neg_lo:[0,0,1]
    v_pk_mul_f32 v[114:115], v[72:73], v[44:45] op_sel:[1,1] op_sel_hi:[1,0]
    v_pk_fma_f32 v[130:131], v[72:73], v[44:45], v[114:115] op_sel:[0,0,0] op_sel_hi:[0,1,1] neg_lo:[0,0,1]
    v_pk_mul_f32 v[116:117], v[72:73], v[46:47] op_sel:[1,1] op_sel_hi:[1,0]
    v_pk_fma_f32 v[132:133], v[72:73], v[46:47], v[116:117] op_sel:[0,0,0] op_sel_hi:[0,1,1] neg_lo:[0,0,1]
    v_pk_mul_f32 v[118:119], v[72:73], v[48:49] op_sel:[1,1] op_sel_hi:[1,0]
    v_pk_fma_f32 v[134:135], v[72:73], v[48:49], v[118:119] op_sel:[0,0,0] op_sel_hi:[0,1,1] neg_lo:[0,0,1]
    v_pk_mul_f32 v[120:121], v[72:73], v[50:51] op_sel:[1,1] op_sel_hi:[1,0]
    v_pk_fma_f32 v[136:137], v[72:73], v[50:51], v[120:121] op_sel:[0,0,0] op_sel_hi:[0,1,1] neg_lo:[0,0,1]
    v_pk_mul_f32 v[122:123], v[72:73], v[52:53] op_sel:[1,1] op_sel_hi:[1,0]
    v_pk_fma_f32 v[138:139], v[72:73], v[52:53], v[122:123] op_sel:[0,0,0] op_sel_hi:[0,1,1] neg_lo:[0,0,1]
    v_pk_mul_f32 v[124:125], v[72:73], v[54:55] op_sel:[1,1] op_sel_hi:[1,0]
    v_pk_fma_f32 v[140:141], v[72:73], v[54:55], v[124:125] op_sel:[0,0,0] op_sel_hi:[0,1,1] neg_lo:[0,0,1]
    v_pk_mul_f32 v[126:127], v[72:73], v[56:57] op_sel:[1,1] op_sel_hi:[1,0]
    v_pk_fma_f32 v[142:143], v[72:73], v[56:57], v[126:127] op_sel:[0,0,0] op_sel_hi:[0,1,1] neg_lo:[0,0,1]
    v_cvt_pk_f16_f32 v80, v128, v129
    v_cvt_pk_f16_f32 v81, v130, v131
    v_cvt_pk_f16_f32 v82, v132, v133
    v_cvt_pk_f16_f32 v83, v134, v135
    v_cvt_pk_f16_f32 v84, v136, v137
    v_cvt_pk_f16_f32 v85, v138, v139
    v_cvt_pk_f16_f32 v86, v140, v141
    v_cvt_pk_f16_f32 v87, v142, v143
    ds_write_b32 v7, v80 offset:4624
    ds_write_b32 v7, v81 offset:4896
    ds_write_b32 v7, v82 offset:5168
    ds_write_b32 v7, v83 offset:5440
    ds_write_b32 v7, v84 offset:5712
    ds_write_b32 v7, v85 offset:5984
    ds_write_b32 v7, v86 offset:6256
    ds_write_b32 v7, v87 offset:6528
    v_pk_mul_f32 v[112:113], v[72:73], v[58:59] op_sel:[1,1] op_sel_hi:[1,0]
    v_pk_fma_f32 v[128:129], v[72:73], v[58:59], v[112:113] op_sel:[0,0,0] op_sel_hi:[0,1,1] neg_lo:[0,0,1]
    v_pk_mul_f32 v[114:115], v[72:73], v[60:61] op_sel:[1,1] op_sel_hi:[1,0]
    v_pk_fma_f32 v[130:131], v[72:73], v[60:61], v[114:115] op_sel:[0,0,0] op_sel_hi:[0,1,1] neg_lo:[0,0,1]
    v_pk_mul_f32 v[116:117], v[72:73], v[62:63] op_sel:[1,1] op_sel_hi:[1,0]
    v_pk_fma_f32 v[132:133], v[72:73], v[62:63], v[116:117] op_sel:[0,0,0] op_sel_hi:[0,1,1] neg_lo:[0,0,1]
    v_pk_mul_f32 v[118:119], v[72:73], v[64:65] op_sel:[1,1] op_sel_hi:[1,0]
    v_pk_fma_f32 v[134:135], v[72:73], v[64:65], v[118:119] op_sel:[0,0,0] op_sel_hi:[0,1,1] neg_lo:[0,0,1]
    v_pk_mul_f32 v[120:121], v[72:73], v[66:67] op_sel:[1,1] op_sel_hi:[1,0]
    v_pk_fma_f32 v[136:137], v[72:73], v[66:67], v[120:121] op_sel:[0,0,0] op_sel_hi:[0,1,1] neg_lo:[0,0,1]
    v_pk_mul_f32 v[122:123], v[72:73], v[68:69] op_sel:[1,1] op_sel_hi:[1,0]
    v_pk_fma_f32 v[138:139], v[72:73], v[68:69], v[122:123] op_sel:[0,0,0] op_sel_hi:[0,1,1] neg_lo:[0,0,1]
    v_pk_mul_f32 v[124:125], v[72:73], v[70:71] op_sel:[1,1] op_sel_hi:[1,0]
    v_pk_fma_f32 v[140:141], v[72:73], v[70:71], v[124:125] op_sel:[0,0,0] op_sel_hi:[0,1,1] neg_lo:[0,0,1]
    v_cvt_pk_f16_f32 v80, v128, v129
    v_cvt_pk_f16_f32 v81, v130, v131
    v_cvt_pk_f16_f32 v82, v132, v133
    v_cvt_pk_f16_f32 v83, v134, v135
    v_cvt_pk_f16_f32 v84, v136, v137
    v_cvt_pk_f16_f32 v85, v138, v139
    v_cvt_pk_f16_f32 v86, v140, v141
    ds_write_b32 v7, v80 offset:6800
    ds_write_b32 v7, v81 offset:7072
    ds_write_b32 v7, v82 offset:7344
    ds_write_b32 v7, v83 offset:7616
    ds_write_b32 v7, v84 offset:7888
    ds_write_b32 v7, v85 offset:8160
    ds_write_b32 v7, v86 offset:8432
    v_and_b32 v8, 31, v1
    v_mul_u32_u24 v8, 272, v8
    v_lshrrev_b32 v9, 5, v1
    v_lshl_add_u32 v8, v9, 4, v8
    v_add_u32 v8, s10, v8

    ds_read_b128 v[112:115], v8 offset:0
    ds_read_b128 v[116:119], v8 offset:32
    ds_read_b128 v[120:123], v8 offset:64
    ds_read_b128 v[124:127], v8 offset:96
    ds_read_b128 v[128:131], v8 offset:128
    ds_read_b128 v[132:135], v8 offset:160
    ds_read_b128 v[136:139], v8 offset:192
    ds_read_b128 v[140:143], v8 offset:224
    v_mul_f32 v80, 0x3f800000, v30
    v_mul_f32 v81, 0x3f800000, v31
    v_mul_f32 v84, 0x40000000, v30
    v_mul_f32 v85, 0x40000000, v31
    v_mul_f32 v88, 0x40800000, v30
    v_mul_f32 v89, 0x40800000, v31
    v_mul_f32 v92, 0x43800000, v30
    v_mul_f32 v93, 0x43800000, v31
    v_mul_f32 v96, 0x44000000, v30
    v_mul_f32 v97, 0x44000000, v31
    v_mul_f32 v100, 0x44800000, v30
    v_mul_f32 v101, 0x44800000, v31
    v_mul_f32 v104, 0x45000000, v30
    v_mul_f32 v105, 0x45000000, v31
    v_fract_f32 v81, v81
    v_exp_f32 v80, v80
    v_fract_f32 v85, v85
    v_exp_f32 v84, v84
    v_fract_f32 v89, v89
    v_exp_f32 v88, v88
    v_fract_f32 v93, v93
    v_exp_f32 v92, v92
    v_fract_f32 v97, v97
    v_exp_f32 v96, v96
    v_fract_f32 v101, v101
    v_exp_f32 v100, v100
    v_fract_f32 v105, v105
    v_exp_f32 v104, v104
    v_cos_f32 v82, v81
    v_sin_f32 v83, v81
    v_cos_f32 v86, v85
    v_sin_f32 v87, v85
    v_cos_f32 v90, v89
    v_sin_f32 v91, v89
    v_cos_f32 v94, v93
    v_sin_f32 v95, v93
    v_cos_f32 v98, v97
    v_sin_f32 v99, v97
    v_cos_f32 v102, v101
    v_sin_f32 v103, v101
    v_cos_f32 v106, v105
    v_sin_f32 v107, v105
    s_nop 0
    v_pk_mul_f32 v[12:13], v[80:81], v[82:83] op_sel:[0,0] op_sel_hi:[0,1]
    v_pk_mul_f32 v[14:15], v[84:85], v[86:87] op_sel:[0,0] op_sel_hi:[0,1]
    v_pk_mul_f32 v[16:17], v[88:89], v[90:91] op_sel:[0,0] op_sel_hi:[0,1]
    v_pk_mul_f32 v[18:19], v[92:93], v[94:95] op_sel:[0,0] op_sel_hi:[0,1]
    v_pk_mul_f32 v[20:21], v[96:97], v[98:99] op_sel:[0,0] op_sel_hi:[0,1]
    v_pk_mul_f32 v[22:23], v[100:101], v[102:103] op_sel:[0,0] op_sel_hi:[0,1]
    v_pk_mul_f32 v[24:25], v[104:105], v[106:107] op_sel:[0,0] op_sel_hi:[0,1]
    v_pk_mul_f32 v[2:3], v[32:33], v[18:19] op_sel:[1,1] op_sel_hi:[1,0]
    v_pk_fma_f32 v[38:39], v[32:33], v[18:19], v[2:3] op_sel:[0,0,0] op_sel_hi:[0,1,1] neg_lo:[0,0,1]
    v_pk_mul_f32 v[4:5], v[32:33], v[20:21] op_sel:[1,1] op_sel_hi:[1,0]
    v_pk_fma_f32 v[40:41], v[32:33], v[20:21], v[4:5] op_sel:[0,0,0] op_sel_hi:[0,1,1] neg_lo:[0,0,1]
    v_pk_mul_f32 v[26:27], v[32:33], v[22:23] op_sel:[1,1] op_sel_hi:[1,0]
    v_pk_fma_f32 v[44:45], v[32:33], v[22:23], v[26:27] op_sel:[0,0,0] op_sel_hi:[0,1,1] neg_lo:[0,0,1]
    v_pk_mul_f32 v[34:35], v[32:33], v[24:25] op_sel:[1,1] op_sel_hi:[1,0]
    v_pk_fma_f32 v[52:53], v[32:33], v[24:25], v[34:35] op_sel:[0,0,0] op_sel_hi:[0,1,1] neg_lo:[0,0,1]
    v_pk_mul_f32 v[2:3], v[32:33], v[16:17] op_sel:[1,1] op_sel_hi:[1,0]
    v_pk_fma_f32 v[54:55], v[32:33], v[16:17], v[2:3] op_sel:[0,0,0] op_sel_hi:[0,1,1] neg_lo:[0,0,1]
    v_pk_mul_f32 v[4:5], v[32:33], v[14:15] op_sel:[1,1] op_sel_hi:[1,0]
    v_pk_fma_f32 v[62:63], v[32:33], v[14:15], v[4:5] op_sel:[0,0,0] op_sel_hi:[0,1,1] neg_lo:[0,0,1]
    v_pk_mul_f32 v[26:27], v[32:33], v[12:13] op_sel:[1,1] op_sel_hi:[1,0]
    v_pk_fma_f32 v[70:71], v[32:33], v[12:13], v[26:27] op_sel:[0,0,0] op_sel_hi:[0,1,1] neg_lo:[0,0,1]
    v_pk_mul_f32 v[34:35], v[40:41], v[18:19] op_sel:[1,1] op_sel_hi:[1,0]
    v_pk_fma_f32 v[42:43], v[40:41], v[18:19], v[34:35] op_sel:[0,0,0] op_sel_hi:[0,1,1] neg_lo:[0,0,1]
    v_pk_mul_f32 v[2:3], v[38:39], v[22:23] op_sel:[1,1] op_sel_hi:[1,0]
    v_pk_fma_f32 v[46:47], v[38:39], v[22:23], v[2:3] op_sel:[0,0,0] op_sel_hi:[0,1,1] neg_lo:[0,0,1]
    v_pk_mul_f32 v[4:5], v[40:41], v[22:23] op_sel:[1,1] op_sel_hi:[1,0]
    v_pk_fma_f32 v[48:49], v[40:41], v[22:23], v[4:5] op_sel:[0,0,0] op_sel_hi:[0,1,1] neg_lo:[0,0,1]
    v_pk_mul_f32 v[26:27], v[38:39], v[16:17] op_sel:[1,1] op_sel_hi:[1,0]
    v_pk_fma_f32 v[56:57], v[38:39], v[16:17], v[26:27] op_sel:[0,0,0] op_sel_hi:[0,1,1] neg_lo:[0,0,1]
    v_pk_mul_f32 v[34:35], v[40:41], v[16:17] op_sel:[1,1] op_sel_hi:[1,0]
    v_pk_fma_f32 v[58:59], v[40:41], v[16:17], v[34:35] op_sel:[0,0,0] op_sel_hi:[0,1,1] neg_lo:[0,0,1]
    v_pk_mul_f32 v[2:3], v[38:39], v[14:15] op_sel:[1,1] op_sel_hi:[1,0]
    v_pk_fma_f32 v[64:65], v[38:39], v[14:15], v[2:3] op_sel:[0,0,0] op_sel_hi:[0,1,1] neg_lo:[0,0,1]
    v_pk_mul_f32 v[4:5], v[54:55], v[14:15] op_sel:[1,1] op_sel_hi:[1,0]
    v_pk_fma_f32 v[66:67], v[54:55], v[14:15], v[4:5] op_sel:[0,0,0] op_sel_hi:[0,1,1] neg_lo:[0,0,1]
    v_pk_mul_f32 v[26:27], v[62:63], v[12:13] op_sel:[1,1] op_sel_hi:[1,0]
    v_pk_fma_f32 v[72:73], v[62:63], v[12:13], v[26:27] op_sel:[0,0,0] op_sel_hi:[0,1,1] neg_lo:[0,0,1]
    v_pk_mul_f32 v[34:35], v[54:55], v[12:13] op_sel:[1,1] op_sel_hi:[1,0]
    v_pk_fma_f32 v[74:75], v[54:55], v[12:13], v[34:35] op_sel:[0,0,0] op_sel_hi:[0,1,1] neg_lo:[0,0,1]
    v_pk_mul_f32 v[2:3], v[42:43], v[22:23] op_sel:[1,1] op_sel_hi:[1,0]
    v_pk_fma_f32 v[50:51], v[42:43], v[22:23], v[2:3] op_sel:[0,0,0] op_sel_hi:[0,1,1] neg_lo:[0,0,1]
    v_pk_mul_f32 v[4:5], v[42:43], v[16:17] op_sel:[1,1] op_sel_hi:[1,0]
    v_pk_fma_f32 v[60:61], v[42:43], v[16:17], v[4:5] op_sel:[0,0,0] op_sel_hi:[0,1,1] neg_lo:[0,0,1]
    v_pk_mul_f32 v[26:27], v[56:57], v[14:15] op_sel:[1,1] op_sel_hi:[1,0]
    v_pk_fma_f32 v[68:69], v[56:57], v[14:15], v[26:27] op_sel:[0,0,0] op_sel_hi:[0,1,1] neg_lo:[0,0,1]
    v_pk_mul_f32 v[34:35], v[66:67], v[12:13] op_sel:[1,1] op_sel_hi:[1,0]
    v_pk_fma_f32 v[76:77], v[66:67], v[12:13], v[34:35] op_sel:[0,0,0] op_sel_hi:[0,1,1] neg_lo:[0,0,1]
    v_cvt_pk_f16_f32 v80, v32, v33
    v_cvt_pk_f16_f32 v81, v38, v39
    v_cvt_pk_f16_f32 v82, v40, v41
    v_cvt_pk_f16_f32 v83, v42, v43
    v_cvt_pk_f16_f32 v84, v44, v45
    v_cvt_pk_f16_f32 v85, v46, v47
    v_cvt_pk_f16_f32 v86, v48, v49
    v_cvt_pk_f16_f32 v87, v50, v51
    v_cvt_pk_f16_f32 v88, v52, v53
    v_cvt_pk_f16_f32 v89, v54, v55
    v_cvt_pk_f16_f32 v90, v56, v57
    v_cvt_pk_f16_f32 v91, v58, v59
    v_cvt_pk_f16_f32 v92, v60, v61
    v_cvt_pk_f16_f32 v93, v62, v63
    v_cvt_pk_f16_f32 v94, v64, v65
    v_cvt_pk_f16_f32 v95, v66, v67
    v_cvt_pk_f16_f32 v96, v68, v69
    v_cvt_pk_f16_f32 v97, v70, v71
    v_cvt_pk_f16_f32 v98, v72, v73
    v_cvt_pk_f16_f32 v99, v74, v75
    v_cvt_pk_f16_f32 v100, v76, v77
    ds_write_b32 v7, v80 offset:8704
    ds_write_b32 v7, v81 offset:8976
    ds_write_b32 v7, v82 offset:9248
    ds_write_b32 v7, v83 offset:9520
    ds_write_b32 v7, v84 offset:9792
    ds_write_b32 v7, v85 offset:10064
    ds_write_b32 v7, v86 offset:10336
    ds_write_b32 v7, v87 offset:10608
    ds_write_b32 v7, v88 offset:10880
    ds_write_b32 v7, v89 offset:11152
    ds_write_b32 v7, v90 offset:11424
    ds_write_b32 v7, v91 offset:11696
    ds_write_b32 v7, v92 offset:11968
    ds_write_b32 v7, v93 offset:12240
    ds_write_b32 v7, v94 offset:12512
    ds_write_b32 v7, v95 offset:12784
    ds_write_b32 v7, v96 offset:13056
    ds_write_b32 v7, v97 offset:13328
    ds_write_b32 v7, v98 offset:13600
    ds_write_b32 v7, v99 offset:13872
    ds_write_b32 v7, v100 offset:14144
    ds_read_b128 v[144:147], v8 offset:8704
    ds_read_b128 v[148:151], v8 offset:8736
    ds_read_b128 v[152:155], v8 offset:8768
    ds_read_b128 v[156:159], v8 offset:8800
    ds_read_b128 v[160:163], v8 offset:8832
    ds_read_b128 v[164:167], v8 offset:8864
    ds_read_b128 v[168:171], v8 offset:8896
    ds_read_b128 v[172:175], v8 offset:8928
    s_waitcnt lgkmcnt(7)
    v_mfma_f32_32x32x16_f16 v[80:95], v[144:147], v[112:115], 0
    s_waitcnt lgkmcnt(6)
    v_mfma_f32_32x32x16_f16 v[80:95], v[148:151], v[116:119], v[80:95]
    s_waitcnt lgkmcnt(5)
    v_mfma_f32_32x32x16_f16 v[80:95], v[152:155], v[120:123], v[80:95]
    s_waitcnt lgkmcnt(4)
    v_mfma_f32_32x32x16_f16 v[80:95], v[156:159], v[124:127], v[80:95]
    s_waitcnt lgkmcnt(3)
    v_mfma_f32_32x32x16_f16 v[80:95], v[160:163], v[128:131], v[80:95]
    s_waitcnt lgkmcnt(2)
    v_mfma_f32_32x32x16_f16 v[80:95], v[164:167], v[132:135], v[80:95]
    s_waitcnt lgkmcnt(1)
    v_mfma_f32_32x32x16_f16 v[80:95], v[168:171], v[136:139], v[80:95]
    s_waitcnt lgkmcnt(0)
    v_mfma_f32_32x32x16_f16 v[80:95], v[172:175], v[140:143], v[80:95]
    s_nop 15
    s_mov_b32 s52, s20
    s_and_b32 s53, s21, 0xffff
    s_mov_b32 s54, 0xa2000
    s_mov_b32 s55, 0x20000
    s_lshr_b32 s65, s2, 3
    s_lshl_b32 s65, s65, 2
    s_add_u32 s65, s65, s3
    s_mul_i32 s65, s65, 4608
    v_lshlrev_b32 v101, 7, v1
    s_mov_b32 exec_hi, 0xf
    buffer_load_dword v78, v101, s[52:55], s65 offen
    s_mov_b64 exec, -1

    s_mov_b32 s66, s99
    s_mov_b32 s67, s99
    v_pk_mul_f32 v[80:81], v[80:81], s[66:67]
    v_pk_mul_f32 v[82:83], v[82:83], s[66:67]
    v_pk_mul_f32 v[84:85], v[84:85], s[66:67]
    v_pk_mul_f32 v[86:87], v[86:87], s[66:67]
    v_pk_mul_f32 v[88:89], v[88:89], s[66:67]
    v_pk_mul_f32 v[90:91], v[90:91], s[66:67]
    v_lshlrev_b32 v9, 4, v1
    s_cmp_eq_u32 s9, 0
    s_cbranch_scc1 K1_EVEN_5
    v_add_u32 v9, s10, v9
    ds_write_b128 v9, v[80:83] offset:0
    ds_write_b128 v9, v[84:87] offset:1024
    ds_write_b128 v9, v[88:91] offset:2048
    s_cmp_lg_u32 s3, 1
    s_cbranch_scc1 K1_PXO_ok
    s_lshl_b32 s11, s78, 7
    s_add_u32 s11, s11, 0xb40000
    v_mov_b32 v3, 0
    s_mov_b32 s72, 0
    s_mov_b64 exec, 1

K1_PXO:
    buffer_load_dword v2, v3, s[56:59], s11 offen sc1
    s_add_u32 s72, s72, 1
    s_waitcnt vmcnt(0)
    v_readfirstlane_b32 s12, v2
    s_cmp_eq_u32 s12, 1
    s_cbranch_scc1 K1_PXO_ok
    s_cmp_gt_u32 s72, 0x8000
    s_cbranch_scc1 K1_PXO_ok
    s_sleep 4
    s_branch K1_PXO

K1_PXO_ok:
    s_mov_b64 exec, -1
    s_waitcnt lgkmcnt(0)
    s_barrier
    v_lshlrev_b32 v2, 4, v0
    v_subrev_u32 v5, 4, v2
    v_and_b32 v4, 31, v1
    v_lshlrev_b32 v4, 2, v4
    s_mul_i32 s11, s78, 8704
    s_add_u32 s11, s11, 0x240000
    s_add_u32 s52, s46, s11
    s_addc_u32 s53, s47, 0
    s_and_b32 s53, s53, 0xffff
    s_mov_b32 s54, 4096
    s_mov_b32 s55, 0x20000
    s_add_u32 s68, s52, 4352
    s_addc_u32 s69, s53, 0
    s_mov_b32 s70, 4096
    s_mov_b32 s71, 0x20000
    s_lshl_b32 s11, s4, 8
    s_add_u32 s11, s11, 0xb20000

    buffer_load_dword v145, v5, s[52:55], 0 offen sc1
    buffer_load_dwordx4 v[146:149], v2, s[52:55], 0 offen sc1
    buffer_load_dword v153, v5, s[68:71], 0 offen sc1
    buffer_load_dwordx4 v[154:157], v2, s[68:71], 0 offen sc1
    s_cmp_lg_u32 s3, 1
    s_cbranch_scc1 K1_NOSEL_7
    s_cmp_gt_u32 s4, 9
    s_cbranch_scc1 K1_PEND_6
    s_cmp_eq_u32 s4, 9
    s_cbranch_scc1 K1_ZF_8
    s_lshl_b32 s11, s4, 4
    v_add_u32 v12, s11, v10
    v_mul_u32_u24 v12, 57, v12
    v_lshrrev_b32 v12, 10, v12
    v_lshrrev_b32 v13, 1, v12
    v_cmp_eq_u32 vcc, v13, v11
    v_and_b32 v13, 1, v12
    v_lshlrev_b32 v13, 4, v13
    v_mov_b32 v14, 0x3f80
    v_lshlrev_b32 v13, v13, v14
    v_cndmask_b32 v16, 0, v13, vcc
    v_mov_b32 v17, v16
    v_mov_b32 v18, v16
    v_mov_b32 v19, v16
    v_lshlrev_b32 v12, 4, v1
    s_lshl_b32 s11, s4, 10
    s_add_u32 s11, s11, 0xb18000
    buffer_store_dwordx4 v[16:19], v12, s[56:59], s11 offen
    s_branch K1_PEND_6

K1_ZF_8:
    v_mov_b32 v16, 0
    v_mov_b32 v17, 0
    v_mov_b32 v18, 0
    v_mov_b32 v19, 0
    v_lshlrev_b32 v12, 4, v1
    s_mov_b32 s11, 0xb34000
    buffer_store_dwordx4 v[16:19], v12, s[56:59], s11 offen
    buffer_store_dwordx4 v[16:19], v12, s[56:59], s11 offen offset:1024
    buffer_store_dwordx4 v[16:19], v12, s[56:59], s11 offen offset:2048
    buffer_store_dwordx4 v[16:19], v12, s[56:59], s11 offen offset:3072
    s_add_u32 s11, s11, 4096
    buffer_store_dwordx4 v[16:19], v12, s[56:59], s11 offen
    s_branch K1_PEND_6

K1_NOSEL_7:
    s_cmp_eq_u32 s14, 0
    s_cbranch_scc1 K1_PEND_6
    s_mov_b32 s62, 0x3f803f80
    v_mov_b32 v12, 0
    v_mov_b32 v13, 0
    s_waitcnt vmcnt(5)
    v_and_b32 v20, 0xffff, v212
    v_and_b32 v21, 0xffff0000, v212
    v_and_b32 v22, 0xffff, v213
    v_and_b32 v23, 0xffff0000, v213
    v_and_b32 v24, 0xffff, v214
    v_and_b32 v25, 0xffff0000, v214
    v_and_b32 v26, 0xffff, v215
    v_and_b32 v27, 0xffff0000, v215
    v_dot2_f32_bf16 v30, v176, v20, 0
    v_dot2_f32_bf16 v31, v176, v21, 0
    v_dot2_f32_bf16 v32, v177, v22, 0
    v_dot2_f32_bf16 v33, v177, v23, 0
    v_dot2_f32_bf16 v34, v178, v24, 0
    v_dot2_f32_bf16 v35, v178, v25, 0
    v_dot2_f32_bf16 v36, v179, v26, 0
    v_dot2_f32_bf16 v37, v179, v27, 0
    s_nop 2
    v_cvt_pk_bf16_f32 v40, v30, v31
    v_cvt_pk_bf16_f32 v41, v32, v33
    v_cvt_pk_bf16_f32 v42, v34, v35
    v_cvt_pk_bf16_f32 v43, v36, v37
    v_dot2_f32_bf16 v12, v40, s62, v12
    v_dot2_f32_bf16 v13, v41, s62, v13
    v_dot2_f32_bf16 v12, v42, s62, v12
    v_dot2_f32_bf16 v13, v43, s62, v13
    v_and_b32 v20, 0xffff, v216
    v_and_b32 v21, 0xffff0000, v216
    v_and_b32 v22, 0xffff, v217
    v_and_b32 v23, 0xffff0000, v217
    v_and_b32 v24, 0xffff, v218
    v_and_b32 v25, 0xffff0000, v218
    v_and_b32 v26, 0xffff, v219
    v_and_b32 v27, 0xffff0000, v219
    v_dot2_f32_bf16 v30, v180, v20, 0
    v_dot2_f32_bf16 v31, v180, v21, 0
    v_dot2_f32_bf16 v32, v181, v22, 0
    v_dot2_f32_bf16 v33, v181, v23, 0
    v_dot2_f32_bf16 v34, v182, v24, 0
    v_dot2_f32_bf16 v35, v182, v25, 0
    v_dot2_f32_bf16 v36, v183, v26, 0
    v_dot2_f32_bf16 v37, v183, v27, 0
    s_nop 2
    v_cvt_pk_bf16_f32 v40, v30, v31
    v_cvt_pk_bf16_f32 v41, v32, v33
    v_cvt_pk_bf16_f32 v42, v34, v35
    v_cvt_pk_bf16_f32 v43, v36, v37
    v_dot2_f32_bf16 v12, v40, s62, v12
    v_dot2_f32_bf16 v13, v41, s62, v13
    v_dot2_f32_bf16 v12, v42, s62, v12
    v_dot2_f32_bf16 v13, v43, s62, v13
    v_and_b32 v20, 0xffff, v220
    v_and_b32 v21, 0xffff0000, v220
    v_and_b32 v22, 0xffff, v221
    v_and_b32 v23, 0xffff0000, v221
    v_and_b32 v24, 0xffff, v222
    v_and_b32 v25, 0xffff0000, v222
    v_and_b32 v26, 0xffff, v223
    v_and_b32 v27, 0xffff0000, v223
    v_dot2_f32_bf16 v30, v184, v20, 0
    v_dot2_f32_bf16 v31, v184, v21, 0
    v_dot2_f32_bf16 v32, v185, v22, 0
    v_dot2_f32_bf16 v33, v185, v23, 0
    v_dot2_f32_bf16 v34, v186, v24, 0
    v_dot2_f32_bf16 v35, v186, v25, 0
    v_dot2_f32_bf16 v36, v187, v26, 0
    v_dot2_f32_bf16 v37, v187, v27, 0
    s_nop 2
    v_cvt_pk_bf16_f32 v40, v30, v31
    v_cvt_pk_bf16_f32 v41, v32, v33
    v_cvt_pk_bf16_f32 v42, v34, v35
    v_cvt_pk_bf16_f32 v43, v36, v37
    v_dot2_f32_bf16 v12, v40, s62, v12
    v_dot2_f32_bf16 v13, v41, s62, v13
    v_dot2_f32_bf16 v12, v42, s62, v12
    v_dot2_f32_bf16 v13, v43, s62, v13
    v_and_b32 v20, 0xffff, v224
    v_and_b32 v21, 0xffff0000, v224
    v_and_b32 v22, 0xffff, v225
    v_and_b32 v23, 0xffff0000, v225
    v_and_b32 v24, 0xffff, v226
    v_and_b32 v25, 0xffff0000, v226
    v_and_b32 v26, 0xffff, v227
    v_and_b32 v27, 0xffff0000, v227
    v_dot2_f32_bf16 v30, v188, v20, 0
    v_dot2_f32_bf16 v31, v188, v21, 0
    v_dot2_f32_bf16 v32, v189, v22, 0
    v_dot2_f32_bf16 v33, v189, v23, 0
    v_dot2_f32_bf16 v34, v190, v24, 0
    v_dot2_f32_bf16 v35, v190, v25, 0
    v_dot2_f32_bf16 v36, v191, v26, 0
    v_dot2_f32_bf16 v37, v191, v27, 0
    s_nop 2
    v_cvt_pk_bf16_f32 v40, v30, v31
    v_cvt_pk_bf16_f32 v41, v32, v33
    v_cvt_pk_bf16_f32 v42, v34, v35
    v_cvt_pk_bf16_f32 v43, v36, v37
    v_dot2_f32_bf16 v12, v40, s62, v12
    v_dot2_f32_bf16 v13, v41, s62, v13
    v_dot2_f32_bf16 v12, v42, s62, v12
    v_dot2_f32_bf16 v13, v43, s62, v13
    v_and_b32 v20, 0xffff, v228
    v_and_b32 v21, 0xffff0000, v228
    v_and_b32 v22, 0xffff, v229
    v_and_b32 v23, 0xffff0000, v229
    v_and_b32 v24, 0xffff, v230
    v_and_b32 v25, 0xffff0000, v230
    v_and_b32 v26, 0xffff, v231
    v_and_b32 v27, 0xffff0000, v231
    v_dot2_f32_bf16 v30, v192, v20, 0
    v_dot2_f32_bf16 v31, v192, v21, 0
    v_dot2_f32_bf16 v32, v193, v22, 0
    v_dot2_f32_bf16 v33, v193, v23, 0
    v_dot2_f32_bf16 v34, v194, v24, 0
    v_dot2_f32_bf16 v35, v194, v25, 0
    v_dot2_f32_bf16 v36, v195, v26, 0
    v_dot2_f32_bf16 v37, v195, v27, 0
    s_nop 2
    v_cvt_pk_bf16_f32 v40, v30, v31
    v_cvt_pk_bf16_f32 v41, v32, v33
    v_cvt_pk_bf16_f32 v42, v34, v35
    v_cvt_pk_bf16_f32 v43, v36, v37
    v_dot2_f32_bf16 v12, v40, s62, v12
    v_dot2_f32_bf16 v13, v41, s62, v13
    v_dot2_f32_bf16 v12, v42, s62, v12
    v_dot2_f32_bf16 v13, v43, s62, v13
    v_and_b32 v20, 0xffff, v232
    v_and_b32 v21, 0xffff0000, v232
    v_and_b32 v22, 0xffff, v233
    v_and_b32 v23, 0xffff0000, v233
    v_and_b32 v24, 0xffff, v234
    v_and_b32 v25, 0xffff0000, v234
    v_and_b32 v26, 0xffff, v235
    v_and_b32 v27, 0xffff0000, v235
    v_dot2_f32_bf16 v30, v196, v20, 0
    v_dot2_f32_bf16 v31, v196, v21, 0
    v_dot2_f32_bf16 v32, v197, v22, 0
    v_dot2_f32_bf16 v33, v197, v23, 0
    v_dot2_f32_bf16 v34, v198, v24, 0
    v_dot2_f32_bf16 v35, v198, v25, 0
    v_dot2_f32_bf16 v36, v199, v26, 0
    v_dot2_f32_bf16 v37, v199, v27, 0
    s_nop 2
    v_cvt_pk_bf16_f32 v40, v30, v31
    v_cvt_pk_bf16_f32 v41, v32, v33
    v_cvt_pk_bf16_f32 v42, v34, v35
    v_cvt_pk_bf16_f32 v43, v36, v37
    v_dot2_f32_bf16 v12, v40, s62, v12
    v_dot2_f32_bf16 v13, v41, s62, v13
    v_dot2_f32_bf16 v12, v42, s62, v12
    v_dot2_f32_bf16 v13, v43, s62, v13
    v_and_b32 v20, 0xffff, v236
    v_and_b32 v21, 0xffff0000, v236
    v_and_b32 v22, 0xffff, v237
    v_and_b32 v23, 0xffff0000, v237
    v_and_b32 v24, 0xffff, v238
    v_and_b32 v25, 0xffff0000, v238
    v_and_b32 v26, 0xffff, v239
    v_and_b32 v27, 0xffff0000, v239
    v_dot2_f32_bf16 v30, v200, v20, 0
    v_dot2_f32_bf16 v31, v200, v21, 0
    v_dot2_f32_bf16 v32, v201, v22, 0
    v_dot2_f32_bf16 v33, v201, v23, 0
    v_dot2_f32_bf16 v34, v202, v24, 0
    v_dot2_f32_bf16 v35, v202, v25, 0
    v_dot2_f32_bf16 v36, v203, v26, 0
    v_dot2_f32_bf16 v37, v203, v27, 0
    s_nop 2
    v_cvt_pk_bf16_f32 v40, v30, v31
    v_cvt_pk_bf16_f32 v41, v32, v33
    v_cvt_pk_bf16_f32 v42, v34, v35
    v_cvt_pk_bf16_f32 v43, v36, v37
    v_dot2_f32_bf16 v12, v40, s62, v12
    v_dot2_f32_bf16 v13, v41, s62, v13
    v_dot2_f32_bf16 v12, v42, s62, v12
    v_dot2_f32_bf16 v13, v43, s62, v13
    v_and_b32 v20, 0xffff, v240
    v_and_b32 v21, 0xffff0000, v240
    v_and_b32 v22, 0xffff, v241
    v_and_b32 v23, 0xffff0000, v241
    v_and_b32 v24, 0xffff, v242
    v_and_b32 v25, 0xffff0000, v242
    v_and_b32 v26, 0xffff, v243
    v_and_b32 v27, 0xffff0000, v243
    v_dot2_f32_bf16 v30, v204, v20, 0
    v_dot2_f32_bf16 v31, v204, v21, 0
    v_dot2_f32_bf16 v32, v205, v22, 0
    v_dot2_f32_bf16 v33, v205, v23, 0
    v_dot2_f32_bf16 v34, v206, v24, 0
    v_dot2_f32_bf16 v35, v206, v25, 0
    v_dot2_f32_bf16 v36, v207, v26, 0
    v_dot2_f32_bf16 v37, v207, v27, 0
    s_nop 2
    v_cvt_pk_bf16_f32 v40, v30, v31
    v_cvt_pk_bf16_f32 v41, v32, v33
    v_cvt_pk_bf16_f32 v42, v34, v35
    v_cvt_pk_bf16_f32 v43, v36, v37
    v_dot2_f32_bf16 v12, v40, s62, v12
    v_dot2_f32_bf16 v13, v41, s62, v13
    v_dot2_f32_bf16 v12, v42, s62, v12
    v_dot2_f32_bf16 v13, v43, s62, v13
    v_and_b32 v20, 0xffff, v244
    v_and_b32 v21, 0xffff0000, v244
    v_and_b32 v22, 0xffff, v245
    v_and_b32 v23, 0xffff0000, v245
    v_and_b32 v24, 0xffff, v246
    v_and_b32 v25, 0xffff0000, v246
    v_and_b32 v26, 0xffff, v247
    v_and_b32 v27, 0xffff0000, v247
    v_dot2_f32_bf16 v30, v208, v20, 0
    v_dot2_f32_bf16 v31, v208, v21, 0
    v_dot2_f32_bf16 v32, v209, v22, 0
    v_dot2_f32_bf16 v33, v209, v23, 0
    v_dot2_f32_bf16 v34, v210, v24, 0
    v_dot2_f32_bf16 v35, v210, v25, 0
    v_dot2_f32_bf16 v36, v211, v26, 0
    v_dot2_f32_bf16 v37, v211, v27, 0
    s_nop 2
    v_cvt_pk_bf16_f32 v40, v30, v31
    v_cvt_pk_bf16_f32 v41, v32, v33
    v_cvt_pk_bf16_f32 v42, v34, v35
    v_cvt_pk_bf16_f32 v43, v36, v37
    v_dot2_f32_bf16 v12, v40, s62, v12
    v_dot2_f32_bf16 v13, v41, s62, v13
    v_dot2_f32_bf16 v12, v42, s62, v12
    v_dot2_f32_bf16 v13, v43, s62, v13
    s_nop 2
    v_add_f32 v12, v12, v13
    s_nop 1
    v_add_f32_dpp v12, v12, v12 quad_perm:[1,0,3,2] row_mask:0xf bank_mask:0xf
    s_nop 1
    v_add_f32_dpp v12, v12, v12 quad_perm:[2,3,0,1] row_mask:0xf bank_mask:0xf
    s_nop 1
    v_add_f32_dpp v12, v12, v12 row_half_mirror row_mask:0xf bank_mask:0xf
    v_cvt_pk_bf16_f32 v12, v12, v12
    v_lshlrev_b32 v12, 16, v12
    v_mul_f32 v12, 0xbfb8aa3b, v12
    v_exp_f32 v12, v12
    s_nop 0
    v_add_f32 v12, 1.0, v12
    v_rcp_f32 v12, v12
    s_nop 0
    v_cvt_pk_bf16_f32 v12, v12, v12
    v_lshlrev_b32 v12, 16, v12
    v_lshrrev_b32 v13, 3, v1
    v_lshlrev_b32 v13, 2, v13
    s_lshl_b32 s11, s4, 5
    s_add_u32 s11, s11, 0xb1c000
    v_and_b32 v14, 7, v1
    v_cmp_eq_u32 vcc, 0, v14
    s_and_saveexec_b64 s[74:75], vcc
    buffer_store_dword v12, v13, s[56:59], s11 offen

    s_mov_b64 exec, -1
K1_PEND_6:
    s_branch K1_CONV
K1_EVEN_5:
    s_add_u32 s11, s10, 14416
    v_add_u32 v9, s11, v9
    s_barrier
    ds_read_b128 v[12:15], v9 offset:0
    ds_read_b128 v[16:19], v9 offset:1024
    ds_read_b128 v[20:23], v9 offset:2048
    v_lshlrev_b32 v2, 4, v0
    v_subrev_u32 v5, 4, v2
    v_and_b32 v4, 31, v1
    v_lshlrev_b32 v4, 2, v4
    s_mul_i32 s11, s78, 8704
    s_add_u32 s11, s11, 0x240000
    s_add_u32 s52, s46, s11
    s_addc_u32 s53, s47, 0
    s_and_b32 s53, s53, 0xffff
    s_mov_b32 s54, 4096
    s_mov_b32 s55, 0x20000
    s_add_u32 s68, s52, 4352
    s_addc_u32 s69, s53, 0
    s_mov_b32 s70, 4096
    s_mov_b32 s71, 0x20000
    s_lshl_b32 s11, s4, 8
    s_add_u32 s11, s11, 0xb20000

    buffer_load_dword v145, v5, s[52:55], 0 offen sc1
    buffer_load_dwordx4 v[146:149], v2, s[52:55], 0 offen sc1
    buffer_load_dword v153, v5, s[68:71], 0 offen sc1
    buffer_load_dwordx4 v[154:157], v2, s[68:71], 0 offen sc1
    s_mov_b32 s64, 1
    s_mov_b32 s65, -1
    s_mov_b32 s66, -1
    s_mov_b32 s67, 0
    s_waitcnt lgkmcnt(0)

    v_pk_add_f32 v[80:81], v[80:81], v[12:13]
    v_pk_add_f32 v[82:83], v[82:83], v[14:15]
    v_pk_add_f32 v[84:85], v[84:85], v[16:17]
    v_pk_add_f32 v[86:87], v[86:87], v[18:19]
    v_pk_add_f32 v[88:89], v[88:89], v[20:21]
    v_pk_add_f32 v[90:91], v[90:91], v[22:23]
    v_cndmask_b32 v84, 0, v84, s[64:65]
    v_cndmask_b32 v89, 0, v89, s[66:67]
    v_cndmask_b32 v90, 0, v90, s[66:67]
    v_cndmask_b32 v91, 0, v91, s[66:67]
    v_max3_f32 v12, abs(v80), abs(v81), abs(v82)
    v_max3_f32 v13, abs(v83), abs(v84), abs(v85)
    v_max3_f32 v14, abs(v86), abs(v87), abs(v88)
    v_max3_f32 v15, abs(v89), abs(v90), abs(v91)
    v_max3_f32 v12, v12, v13, v14
    v_max_f32 v12, v12, v15
    s_nop 1
    v_max_f32_dpp v12, v12, v12 quad_perm:[1,0,3,2] row_mask:0xf bank_mask:0xf
    s_nop 1
    v_max_f32_dpp v12, v12, v12 quad_perm:[2,3,0,1] row_mask:0xf bank_mask:0xf
    s_nop 1
    v_max_f32_dpp v12, v12, v12 row_half_mirror row_mask:0xf bank_mask:0xf
    s_nop 1
    v_max_f32_dpp v12, v12, v12 row_mirror row_mask:0xf bank_mask:0xf
    s_nop 1
    v_readlane_b32 s64, v12, 0
    v_readlane_b32 s65, v12, 16
    v_readlane_b32 s66, v12, 32
    v_readlane_b32 s67, v12, 48
    s_nop 3
    s_max_u32 s64, s64, s65
    s_max_u32 s66, s66, s67
    s_max_u32 s64, s64, s66
    s_lshr_b32 s64, s64, 23
    s_sub_u32 s64, 268, s64
    s_min_u32 s64, s64, 254
    s_lshl_b32 s66, s64, 23
    s_mov_b32 s67, s66

    v_pk_mul_f32 v[80:81], v[80:81], s[66:67]
    v_pk_mul_f32 v[82:83], v[82:83], s[66:67]
    v_pk_mul_f32 v[84:85], v[84:85], s[66:67]
    v_pk_mul_f32 v[86:87], v[86:87], s[66:67]
    v_pk_mul_f32 v[88:89], v[88:89], s[66:67]
    v_pk_mul_f32 v[90:91], v[90:91], s[66:67]
    v_cvt_pk_f16_f32 v12, v80, v81
    v_cvt_pk_f16_f32 v13, v82, v83
    v_cvt_pk_f16_f32 v14, v84, v85
    v_cvt_pk_f16_f32 v15, v86, v87
    v_cvt_pk_f16_f32 v16, v88, v89
    v_cvt_pk_f16_f32 v17, v90, v91
    v_and_b32 v8, 31, v1
    v_lshlrev_b32 v8, 1, v8
    v_lshrrev_b32 v9, 5, v1
    v_lshl_add_u32 v8, v9, 8, v8
    v_add_u32 v8, s10, v8
    s_mul_i32 s11, s7, 4608

    ds_write_b16 v8, v12 offset:0
    ds_write_b16_d16_hi v8, v12 offset:64
    ds_write_b16 v8, v13 offset:128
    ds_write_b16_d16_hi v8, v13 offset:192
    ds_write_b16 v8, v14 offset:512
    ds_write_b16_d16_hi v8, v14 offset:576
    ds_write_b16 v8, v15 offset:640
    ds_write_b16_d16_hi v8, v15 offset:704
    ds_write_b16 v8, v16 offset:1024
    ds_write_b16_d16_hi v8, v16 offset:1088
    ds_write_b16 v8, v17 offset:1152
    ds_write_b16_d16_hi v8, v17 offset:1216
    v_lshl_add_u32 v8, v1, 1, s10
    s_mov_b32 s66, -1
    s_mov_b32 s67, 0
    ds_read_u16 v20, v8 offset:0
    v_mov_b32 v9, 0
    v_mov_b32 v11, 1088
    v_cndmask_b32 v9, v9, v11, s[66:67]
    v_add_u32 v9, v9, v8
    ds_read_u16 v21, v9
    ds_read_u16 v22, v8 offset:832
    v_mov_b32 v9, 576
    v_mov_b32 v11, 1152
    v_cndmask_b32 v9, v9, v11, s[66:67]
    v_add_u32 v9, v9, v8
    ds_read_u16 v23, v9
    ds_read_u16 v24, v8 offset:576
    v_mov_b32 v9, 576
    v_mov_b32 v11, 1216
    v_cndmask_b32 v9, v9, v11, s[66:67]
    v_add_u32 v9, v9, v8
    ds_read_u16 v25, v9
    ds_read_u16 v26, v8 offset:960
    v_mov_b32 v9, 2
    v_mov_b32 v11, 1280
    v_cndmask_b32 v9, v9, v11, s[66:67]
    v_add_u32 v9, v9, v8
    ds_read_u16 v27, v9
    ds_read_u16 v28, v8 offset:128
    ds_read_u16 v29, v8 offset:704
    ds_read_u16 v30, v8 offset:130
    ds_read_u16 v31, v8 offset:256
    ds_read_u16 v32, v8 offset:258
    ds_read_u16 v33, v8 offset:384
    ds_read_u16 v34, v8 offset:386
    v_lshl_add_u32 v9, v1, 4, s11
    v_and_b32 v11, 1, v1
    v_cmp_eq_u32 vcc, 0, v11
    v_mov_b32 v56, 0
    v_mov_b32 v57, 0
    v_mov_b32 v58, 0
    v_mov_b32 v59, 0
    s_mov_b32 s66, 0x10001
    s_waitcnt lgkmcnt(0)

    v_lshl_or_b32 v40, v26, 16, v27
    v_lshl_or_b32 v41, v24, 16, v25
    v_lshl_or_b32 v42, v22, 16, v23
    v_lshl_or_b32 v43, v20, 16, v21
    v_mul_lo_u32 v44, v30, s66
    v_mul_lo_u32 v45, v29, s66
    v_lshl_or_b32 v46, v28, 16, v29
    v_mul_lo_u32 v47, v28, s66
    v_mul_lo_u32 v48, v32, s66
    v_cndmask_b32 v11, v32, v31, vcc
    v_mul_lo_u32 v50, v31, s66
    v_lshl_or_b32 v49, v11, 16, v32
    v_mov_b32 v51, v50
    v_mul_lo_u32 v52, v34, s66
    v_cndmask_b32 v11, v34, v33, vcc
    v_mul_lo_u32 v54, v33, s66
    v_lshl_or_b32 v53, v11, 16, v34
    v_mov_b32 v55, v54
    ds_write_b128 v9, v[40:43] offset:480
    ds_write_b128 v9, v[44:47] offset:1504
    ds_write_b128 v9, v[48:51] offset:2528
    ds_write_b128 v9, v[52:55] offset:3552
    s_mov_b64 exec, 0x3fffffff
    ds_write_b128 v9, v[56:59]
    v_mov_b32 v60, s64
    s_mov_b64 exec, 1
    ds_write_b32 v9, v60 offset:4576
    s_mov_b64 exec, -1
    v_lshrrev_b32 v11, 4, v1

K1_CONV:
    s_setprio 2
    s_waitcnt lgkmcnt(0)
    s_barrier
    v_lshlrev_b32 v3, 4, v1
    v_lshrrev_b32 v12, 2, v10
    v_add_u32 v248, 9248, v2
    v_add_u32 v249, 17572, v2
    v_not_b32 v13, v10
    v_and_b32 v13, 3, v13
    v_mul_u32_u24 v13, 4160, v13
    v_lshl_add_u32 v13, v12, 3, v13
    v_lshlrev_b32 v14, 4, v11
    v_sub_u32 v13, v13, v14
    s_lshl_b32 s9, s3, 6
    s_add_u32 s11, s9, 9272
    v_add_u32 v250, s11, v13
    v_lshl_add_u32 v13, v10, 5, v14
    s_sub_u32 s11, 192, s9
    v_add_u32 v251, s11, v13
    v_lshl_add_u32 v13, v10, 2, v11
    v_bfe_u32 v14, v10, 1, 2
    v_xor_b32 v13, v13, v14
    s_lshl_b32 s9, s3, 10
    s_add_u32 s9, s9, 42496
    v_lshl_add_u32 v252, v13, 4, s9
    v_and_b32 v13, 31, v1
    v_lshlrev_b32 v13, 1, v13
    v_bfe_u32 v14, v13, 3, 2
    v_xor_b32 v13, v13, v14
    v_lshlrev_b32 v13, 4, v13
    v_lshrrev_b32 v14, 5, v1
    v_lshl_add_u32 v13, v14, 12, v13
    s_lshl_b32 s9, s3, 13
    s_add_u32 s9, s9, 42496
    v_add_u32 v253, s9, v13
    v_lshrrev_b32 v12, 1, v1
    v_mul_u32_u24 v12, 4160, v12
    v_and_b32 v13, 1, v1
    v_lshl_add_u32 v12, v13, 4, v12
    v_add_u32 v12, 9216, v12
    v_and_b32 v13, 1, v1
    v_bfe_u32 v14, v1, 1, 1
    v_lshl_add_u32 v13, v14, 2, v13
    v_add_u32 v13, 2, v13
    v_mul_u32_u24 v13, 4160, v13
    v_add_u32 v13, 9248, v13
    v_mov_b32 v16, 0
    v_mov_b32 v17, 0
    v_mov_b32 v18, 0
    v_mov_b32 v19, 0
    v_mov_b32 v15, 4576
    ds_read_b32 v20, v15
    ds_read_b32 v21, v15 offset:4608
    s_mov_b64 exec, 0xffff
    ds_write_b128 v12, v[16:19]
    s_mov_b64 exec, 15
    ds_write_b32 v13, v16
    s_mov_b64 exec, -1
    s_waitcnt vmcnt(0) lgkmcnt(0)
    v_readfirstlane_b32 s76, v20
    v_readfirstlane_b32 s77, v21

    s_mov_b32 s8, 0x7fff7fff
    v_and_b32 v16, s8, v146
    v_and_b32 v17, s8, v147
    v_and_b32 v18, s8, v148
    v_and_b32 v19, s8, v149
    v_and_b32 v20, s8, v154
    v_and_b32 v21, s8, v155
    v_and_b32 v22, s8, v156
    v_and_b32 v23, s8, v157
    v_pk_max_u16 v16, v16, v17
    v_pk_max_u16 v18, v18, v19
    v_pk_max_u16 v20, v20, v21
    v_pk_max_u16 v22, v22, v23
    v_pk_max_u16 v16, v16, v18
    v_pk_max_u16 v20, v20, v22
    v_and_b32 v17, 0xffff, v16
    v_lshl_or_b32 v17, v20, 16, v17
    v_lshrrev_b32 v18, 16, v16
    v_and_b32 v19, 0xffff0000, v20
    v_or_b32 v18, v18, v19
    v_pk_max_u16 v16, v17, v18
    s_nop 1
    v_mov_b32_dpp v17, v16 quad_perm:[1,0,3,2] row_mask:0xf bank_mask:0xf
    v_pk_max_u16 v16, v16, v17
    s_nop 1
    v_mov_b32_dpp v17, v16 quad_perm:[2,3,0,1] row_mask:0xf bank_mask:0xf
    v_pk_max_u16 v16, v16, v17
    s_nop 1
    v_mov_b32_dpp v17, v16 row_half_mirror row_mask:0xf bank_mask:0xf
    v_pk_max_u16 v16, v16, v17
    s_nop 1
    v_mov_b32_dpp v17, v16 row_mirror row_mask:0xf bank_mask:0xf
    v_pk_max_u16 v16, v16, v17
    v_lshrrev_b32 v17, 4, v0
    v_lshlrev_b32 v17, 2, v17
    v_add_u32 v17, 42496, v17
    v_cmp_eq_u32 vcc, 0, v10
    v_lshlrev_b32 v18, 2, v10
    v_add_u32 v18, 42496, v18
    s_and_saveexec_b64 s[74:75], vcc
    ds_write_b32 v17, v16
    s_mov_b64 exec, s[74:75]
    s_waitcnt lgkmcnt(0)
    s_barrier
    ds_read_b32 v16, v18
    s_waitcnt lgkmcnt(0)

    s_nop 1
    v_mov_b32_dpp v17, v16 quad_perm:[1,0,3,2] row_mask:0xf bank_mask:0xf
    v_pk_max_u16 v16, v16, v17
    s_nop 1
    v_mov_b32_dpp v17, v16 quad_perm:[2,3,0,1] row_mask:0xf bank_mask:0xf
    v_pk_max_u16 v16, v16, v17
    s_nop 1
    v_mov_b32_dpp v17, v16 row_half_mirror row_mask:0xf bank_mask:0xf
    v_pk_max_u16 v16, v16, v17
    s_nop 1
    v_mov_b32_dpp v17, v16 row_mirror row_mask:0xf bank_mask:0xf
    v_pk_max_u16 v16, v16, v17
    s_nop 0
    v_readfirstlane_b32 s15, v16
    s_lshl_b32 s12, s97, 16
    s_and_b32 s14, s15, 0xffff
    s_mul_i32 s79, s78, 8704
    s_add_u32 s79, s79, 0x4b0000
    s_mov_b32 s73, 0
K1_CLOOP:
    v_lshlrev_b32 v16, 16, v146
    v_and_b32 v17, 0xffff0000, v146
    v_lshlrev_b32 v18, 16, v147
    v_and_b32 v19, 0xffff0000, v147
    v_lshlrev_b32 v20, 16, v148
    v_and_b32 v21, 0xffff0000, v148
    v_lshlrev_b32 v22, 16, v149
    v_and_b32 v23, 0xffff0000, v149
    v_and_b32 v24, 0xffff0000, v145
    s_nop 0
    s_mov_b32 s13, s12
    s_mov_b32 s8, s14
    s_lshr_b32 s8, s8, 7
    s_sub_u32 s8, 268, s8
    s_min_u32 s8, s8, 254
    s_add_u32 s76, s8, s76
    s_sub_u32 s76, 254, s76
    s_lshl_b32 s8, s8, 23
    s_mov_b32 s9, s8

    v_pk_mul_f32 v[176:177], v[16:17], s[12:13]
    v_pk_mul_f32 v[178:179], v[18:19], s[12:13]
    v_pk_mul_f32 v[180:181], v[20:21], s[12:13]
    v_pk_mul_f32 v[182:183], v[22:23], s[12:13]
    v_pk_mul_f32 v[16:17], v[16:17], s[8:9]
    v_pk_mul_f32 v[18:19], v[18:19], s[8:9]
    v_pk_mul_f32 v[20:21], v[20:21], s[8:9]
    v_pk_mul_f32 v[22:23], v[22:23], s[8:9]
    v_mul_f32 v24, s8, v24
    v_cvt_pk_f16_f32 v32, v16, v17
    v_cvt_pk_f16_f32 v33, v18, v19
    v_cvt_pk_f16_f32 v34, v20, v21
    v_cvt_pk_f16_f32 v35, v22, v23
    v_cvt_pk_f16_f32 v31, v24, v24
    ds_write_b128 v248, v[32:35] offset:0
    ds_write2_b32 v249, v32, v33 offset0:0 offset1:1
    ds_write2_b32 v249, v34, v35 offset0:2 offset1:3
    v_alignbit_b32 v36, v32, v31, 16
    v_alignbit_b32 v37, v33, v32, 16
    v_alignbit_b32 v38, v34, v33, 16
    v_alignbit_b32 v39, v35, v34, 16
    v_add_u32 v13, 4160, v249
    ds_write_b128 v248, v[36:39] offset:4160
    ds_write2_b32 v13, v36, v37 offset0:0 offset1:1
    ds_write2_b32 v13, v38, v39 offset0:2 offset1:3
    v_cvt_pk_bf16_f32 v16, v176, v177
    v_cvt_pk_bf16_f32 v17, v178, v179
    v_cvt_pk_bf16_f32 v18, v180, v181
    v_cvt_pk_bf16_f32 v19, v182, v183
    v_lshlrev_b32 v176, 16, v16
    v_and_b32 v177, 0xffff0000, v16
    v_lshlrev_b32 v178, 16, v17
    v_and_b32 v179, 0xffff0000, v17
    v_lshlrev_b32 v180, 16, v18
    v_and_b32 v181, 0xffff0000, v18
    v_lshlrev_b32 v182, 16, v19
    v_and_b32 v183, 0xffff0000, v19
    s_waitcnt lgkmcnt(0)
    s_barrier
    ds_read_b64 v[104:105], v250 offset:0
    ds_read_b64 v[106:107], v250 offset:8
    ds_read_b128 v[44:47], v251 offset:256
    ds_read_b128 v[52:55], v251 offset:768
    ds_read_b128 v[60:63], v251 offset:1280
    ds_read_b128 v[68:71], v251 offset:1792
    ds_read_b128 v[76:79], v251 offset:2304
    ds_read_b128 v[84:87], v251 offset:2816
    ds_read_b128 v[92:95], v251 offset:3328
    ds_read_b128 v[100:103], v251 offset:3840
    ds_read_b64 v[108:109], v250 offset:256
    ds_read_b64 v[110:111], v250 offset:264
    ds_read_b128 v[40:43], v251 offset:0
    ds_read_b128 v[48:51], v251 offset:512
    ds_read_b128 v[56:59], v251 offset:1024
    ds_read_b128 v[64:67], v251 offset:1536
    ds_read_b128 v[72:75], v251 offset:2048
    ds_read_b128 v[80:83], v251 offset:2560
    ds_read_b128 v[88:91], v251 offset:3072
    ds_read_b128 v[96:99], v251 offset:3584
    s_waitcnt lgkmcnt(15)
    v_mfma_f32_16x16x32_f16 v[216:219], v[104:107], v[44:47], 0
    v_mfma_f32_16x16x32_f16 v[220:223], v[104:107], v[52:55], 0
    s_waitcnt lgkmcnt(14)
    v_mfma_f32_16x16x32_f16 v[224:227], v[104:107], v[60:63], 0
    v_mfma_f32_16x16x32_f16 v[228:231], v[104:107], v[68:71], 0
    s_waitcnt lgkmcnt(12)
    v_mfma_f32_16x16x32_f16 v[232:235], v[104:107], v[76:79], 0
    v_mfma_f32_16x16x32_f16 v[236:239], v[104:107], v[84:87], 0
    s_waitcnt lgkmcnt(10)
    v_mfma_f32_16x16x32_f16 v[240:243], v[104:107], v[92:95], 0
    v_mfma_f32_16x16x32_f16 v[244:247], v[104:107], v[100:103], 0
    ds_read_b64 v[112:113], v250 offset:512
    ds_read_b64 v[114:115], v250 offset:520
    ds_read_b64 v[116:117], v250 offset:768
    ds_read_b64 v[118:119], v250 offset:776
    ds_read_b64 v[120:121], v250 offset:1024
    ds_read_b64 v[122:123], v250 offset:1032
    ds_read_b64 v[104:105], v250 offset:2048
    ds_read_b64 v[106:107], v250 offset:2056
    s_waitcnt lgkmcnt(15)
    s_waitcnt lgkmcnt(14)
    v_mfma_f32_16x16x32_f16 v[216:219], v[108:111], v[40:43], v[216:219]
    v_mfma_f32_16x16x32_f16 v[220:223], v[108:111], v[48:51], v[220:223]
    s_waitcnt lgkmcnt(12)
    v_mfma_f32_16x16x32_f16 v[224:227], v[108:111], v[56:59], v[224:227]
    v_mfma_f32_16x16x32_f16 v[228:231], v[108:111], v[64:67], v[228:231]
    s_waitcnt lgkmcnt(10)
    v_mfma_f32_16x16x32_f16 v[232:235], v[108:111], v[72:75], v[232:235]
    v_mfma_f32_16x16x32_f16 v[236:239], v[108:111], v[80:83], v[236:239]
    s_waitcnt lgkmcnt(8)
    v_mfma_f32_16x16x32_f16 v[240:243], v[108:111], v[88:91], v[240:243]
    v_mfma_f32_16x16x32_f16 v[244:247], v[108:111], v[96:99], v[244:247]
    ds_read_b64 v[124:125], v250 offset:1280
    ds_read_b64 v[126:127], v250 offset:1288
    ds_read_b64 v[128:129], v250 offset:1536
    ds_read_b64 v[130:131], v250 offset:1544
    ds_read_b64 v[132:133], v250 offset:1792
    ds_read_b64 v[134:135], v250 offset:1800
    ds_read_b64 v[108:109], v250 offset:2304
    ds_read_b64 v[110:111], v250 offset:2312
    s_waitcnt lgkmcnt(14)
    v_mfma_f32_16x16x32_f16 v[220:223], v[112:115], v[44:47], v[220:223]
    v_mfma_f32_16x16x32_f16 v[224:227], v[112:115], v[52:55], v[224:227]
    v_mfma_f32_16x16x32_f16 v[228:231], v[112:115], v[60:63], v[228:231]
    v_mfma_f32_16x16x32_f16 v[232:235], v[112:115], v[68:71], v[232:235]
    v_mfma_f32_16x16x32_f16 v[236:239], v[112:115], v[76:79], v[236:239]
    v_mfma_f32_16x16x32_f16 v[240:243], v[112:115], v[84:87], v[240:243]
    v_mfma_f32_16x16x32_f16 v[244:247], v[112:115], v[92:95], v[244:247]
    ds_read_b64 v[112:113], v250 offset:2560
    ds_read_b64 v[114:115], v250 offset:2568
    s_waitcnt lgkmcnt(14)
    v_mfma_f32_16x16x32_f16 v[220:223], v[116:119], v[40:43], v[220:223]
    v_mfma_f32_16x16x32_f16 v[224:227], v[116:119], v[48:51], v[224:227]
    v_mfma_f32_16x16x32_f16 v[228:231], v[116:119], v[56:59], v[228:231]
    v_mfma_f32_16x16x32_f16 v[232:235], v[116:119], v[64:67], v[232:235]
    v_mfma_f32_16x16x32_f16 v[236:239], v[116:119], v[72:75], v[236:239]
    v_mfma_f32_16x16x32_f16 v[240:243], v[116:119], v[80:83], v[240:243]
    v_mfma_f32_16x16x32_f16 v[244:247], v[116:119], v[88:91], v[244:247]
    ds_read_b64 v[116:117], v250 offset:2816
    ds_read_b64 v[118:119], v250 offset:2824
    s_waitcnt lgkmcnt(14)
    v_mfma_f32_16x16x32_f16 v[224:227], v[120:123], v[44:47], v[224:227]
    v_mfma_f32_16x16x32_f16 v[228:231], v[120:123], v[52:55], v[228:231]
    v_mfma_f32_16x16x32_f16 v[232:235], v[120:123], v[60:63], v[232:235]
    v_mfma_f32_16x16x32_f16 v[236:239], v[120:123], v[68:71], v[236:239]
    v_mfma_f32_16x16x32_f16 v[240:243], v[120:123], v[76:79], v[240:243]
    v_mfma_f32_16x16x32_f16 v[244:247], v[120:123], v[84:87], v[244:247]
    ds_read_b64 v[120:121], v250 offset:3072
    ds_read_b64 v[122:123], v250 offset:3080
    s_waitcnt lgkmcnt(12)
    v_mfma_f32_16x16x32_f16 v[224:227], v[124:127], v[40:43], v[224:227]
    v_mfma_f32_16x16x32_f16 v[228:231], v[124:127], v[48:51], v[228:231]
    v_mfma_f32_16x16x32_f16 v[232:235], v[124:127], v[56:59], v[232:235]
    v_mfma_f32_16x16x32_f16 v[236:239], v[124:127], v[64:67], v[236:239]
    v_mfma_f32_16x16x32_f16 v[240:243], v[124:127], v[72:75], v[240:243]
    v_mfma_f32_16x16x32_f16 v[244:247], v[124:127], v[80:83], v[244:247]
    ds_read_b64 v[124:125], v250 offset:3328
    ds_read_b64 v[126:127], v250 offset:3336
    s_waitcnt lgkmcnt(12)
    v_mfma_f32_16x16x32_f16 v[228:231], v[128:131], v[44:47], v[228:231]
    v_mfma_f32_16x16x32_f16 v[232:235], v[128:131], v[52:55], v[232:235]
    v_mfma_f32_16x16x32_f16 v[236:239], v[128:131], v[60:63], v[236:239]
    v_mfma_f32_16x16x32_f16 v[240:243], v[128:131], v[68:71], v[240:243]
    v_mfma_f32_16x16x32_f16 v[244:247], v[128:131], v[76:79], v[244:247]
    ds_read_b64 v[128:129], v250 offset:3584
    ds_read_b64 v[130:131], v250 offset:3592
    s_waitcnt lgkmcnt(12)
    v_mfma_f32_16x16x32_f16 v[228:231], v[132:135], v[40:43], v[228:231]
    v_mfma_f32_16x16x32_f16 v[232:235], v[132:135], v[48:51], v[232:235]
    v_mfma_f32_16x16x32_f16 v[236:239], v[132:135], v[56:59], v[236:239]
    v_mfma_f32_16x16x32_f16 v[240:243], v[132:135], v[64:67], v[240:243]
    v_mfma_f32_16x16x32_f16 v[244:247], v[132:135], v[72:75], v[244:247]
    ds_read_b64 v[132:133], v250 offset:3840
    ds_read_b64 v[134:135], v250 offset:3848
    v_mfma_f32_16x16x32_f16 v[232:235], v[104:107], v[44:47], v[232:235]
    v_mfma_f32_16x16x32_f16 v[236:239], v[104:107], v[52:55], v[236:239]
    v_mfma_f32_16x16x32_f16 v[240:243], v[104:107], v[60:63], v[240:243]
    v_mfma_f32_16x16x32_f16 v[244:247], v[104:107], v[68:71], v[244:247]
    s_waitcnt lgkmcnt(12)
    v_mfma_f32_16x16x32_f16 v[232:235], v[108:111], v[40:43], v[232:235]
    v_mfma_f32_16x16x32_f16 v[236:239], v[108:111], v[48:51], v[236:239]
    v_mfma_f32_16x16x32_f16 v[240:243], v[108:111], v[56:59], v[240:243]
    v_mfma_f32_16x16x32_f16 v[244:247], v[108:111], v[64:67], v[244:247]
    s_waitcnt lgkmcnt(10)
    v_mfma_f32_16x16x32_f16 v[236:239], v[112:115], v[44:47], v[236:239]
    v_mfma_f32_16x16x32_f16 v[240:243], v[112:115], v[52:55], v[240:243]
    v_mfma_f32_16x16x32_f16 v[244:247], v[112:115], v[60:63], v[244:247]
    s_waitcnt lgkmcnt(8)
    v_mfma_f32_16x16x32_f16 v[236:239], v[116:119], v[40:43], v[236:239]
    v_mfma_f32_16x16x32_f16 v[240:243], v[116:119], v[48:51], v[240:243]
    v_mfma_f32_16x16x32_f16 v[244:247], v[116:119], v[56:59], v[244:247]
    s_waitcnt lgkmcnt(6)
    v_mfma_f32_16x16x32_f16 v[240:243], v[120:123], v[44:47], v[240:243]
    v_mfma_f32_16x16x32_f16 v[244:247], v[120:123], v[52:55], v[244:247]
    s_waitcnt lgkmcnt(4)
    v_mfma_f32_16x16x32_f16 v[240:243], v[124:127], v[40:43], v[240:243]
    v_mfma_f32_16x16x32_f16 v[244:247], v[124:127], v[48:51], v[244:247]
    s_waitcnt lgkmcnt(2)
    v_mfma_f32_16x16x32_f16 v[244:247], v[128:131], v[44:47], v[244:247]
    s_waitcnt lgkmcnt(0)
    v_mfma_f32_16x16x32_f16 v[244:247], v[132:135], v[40:43], v[244:247]
    s_nop 7
    ds_write_b128 v252, v[216:219] offset:0
    ds_write_b128 v252, v[220:223] offset:4096
    ds_write_b128 v252, v[224:227] offset:8192
    ds_write_b128 v252, v[228:231] offset:12288
    ds_write_b128 v252, v[232:235] offset:16384
    ds_write_b128 v252, v[236:239] offset:20480
    ds_write_b128 v252, v[240:243] offset:24576
    ds_write_b128 v252, v[244:247] offset:28672
    v_xor_b32 v12, 16, v253
    s_waitcnt lgkmcnt(0)
    s_barrier
    ds_read_b128 v[40:43], v253 offset:0
    ds_read_b128 v[44:47], v12 offset:0
    ds_read_b128 v[48:51], v253 offset:1024
    ds_read_b128 v[52:55], v12 offset:1024
    ds_read_b128 v[56:59], v253 offset:2048
    ds_read_b128 v[60:63], v12 offset:2048
    ds_read_b128 v[64:67], v253 offset:3072
    ds_read_b128 v[68:71], v12 offset:3072
    s_mov_b32 s8, s79
    s_waitcnt lgkmcnt(4)
    v_pk_add_f32 v[40:41], v[40:41], v[48:49]
    v_pk_add_f32 v[42:43], v[42:43], v[50:51]
    v_pk_add_f32 v[44:45], v[44:45], v[52:53]
    v_pk_add_f32 v[46:47], v[46:47], v[54:55]
    s_waitcnt lgkmcnt(0)
    v_pk_add_f32 v[56:57], v[56:57], v[64:65]
    v_pk_add_f32 v[58:59], v[58:59], v[66:67]
    v_pk_add_f32 v[60:61], v[60:61], v[68:69]
    v_pk_add_f32 v[62:63], v[62:63], v[70:71]
    v_pk_add_f32 v[40:41], v[40:41], v[56:57]
    v_pk_add_f32 v[42:43], v[42:43], v[58:59]
    v_pk_add_f32 v[44:45], v[44:45], v[60:61]
    v_pk_add_f32 v[46:47], v[46:47], v[62:63]
    v_ldexp_f32 v40, v40, s76
    v_ldexp_f32 v41, v41, s76
    v_ldexp_f32 v42, v42, s76
    v_ldexp_f32 v43, v43, s76
    v_ldexp_f32 v44, v44, s76
    v_ldexp_f32 v45, v45, s76
    v_ldexp_f32 v46, v46, s76
    v_ldexp_f32 v47, v47, s76
    v_cvt_pk_bf16_f32 v48, v40, v41
    v_cvt_pk_bf16_f32 v49, v42, v43
    v_cvt_pk_bf16_f32 v50, v44, v45
    v_cvt_pk_bf16_f32 v51, v46, v47
    v_lshlrev_b32 v40, 16, v48
    v_and_b32 v41, 0xffff0000, v48
    v_lshlrev_b32 v42, 16, v49
    v_and_b32 v43, 0xffff0000, v49
    v_lshlrev_b32 v44, 16, v50
    v_and_b32 v45, 0xffff0000, v50
    v_lshlrev_b32 v46, 16, v51
    v_and_b32 v47, 0xffff0000, v51
    v_pk_add_f32 v[40:41], v[40:41], v[176:177]
    v_pk_add_f32 v[42:43], v[42:43], v[178:179]
    v_pk_add_f32 v[44:45], v[44:45], v[180:181]
    v_pk_add_f32 v[46:47], v[46:47], v[182:183]
    v_cvt_pk_bf16_f32 v168, v40, v41
    v_cvt_pk_bf16_f32 v169, v42, v43
    v_cvt_pk_bf16_f32 v170, v44, v45
    v_cvt_pk_bf16_f32 v171, v46, v47
    buffer_store_dwordx4 v[168:171], v2, s[56:59], s8 offen sc1
    s_cmp_lg_u32 s73, 0
    s_cbranch_scc1 K1_CEND
    v_mov_b32 v145, v153
    v_mov_b32 v146, v154
    v_mov_b32 v147, v155
    v_mov_b32 v148, v156
    v_mov_b32 v149, v157
    s_mov_b32 s73, 1
    s_and_b32 s12, s97, 0xffff0000
    s_lshr_b32 s14, s15, 16
    s_mov_b32 s76, s77
    s_add_u32 s79, s79, 4352
    v_add_u32 v251, 4608, v251
    s_branch K1_CLOOP

K1_CEND:
    s_endpgm
K1_EXIT:
    s_endpgm
.globl km_kernel
.p2align 8
.type km_kernel,@function
km_kernel:
    s_cmp_ge_u32 s2, 256
    s_cbranch_scc1 KM_EXIT
    s_load_dwordx16 s[16:31], s[0:1], 0
    s_load_dwordx16 s[32:47], s[0:1], 64
    v_lshrrev_b32 v2, 6, v0
    v_and_b32 v1, 63, v0
    s_nop 0
    v_readfirstlane_b32 s3, v2
    s_and_b32 s4, s2, 7
    s_lshr_b32 s5, s2, 3
    s_lshl_b32 s4, s4, 3
    s_and_b32 s6, s5, 7
    s_add_u32 s4, s4, s6
    s_lshl_b32 s4, s4, 5
    s_lshr_b32 s14, s5, 3
    s_mul_i32 s5, s14, 144
    v_and_b32 v10, 15, v1
    v_lshrrev_b32 v11, 4, v1
    s_mul_i32 s6, s3, 144
    s_mul_i32 s7, s3, 27648
    s_add_u32 s7, s7, 0
    s_and_b32 s12, s3, 1
    s_lshr_b32 s13, s3, 1
    s_lshr_b32 s97, s2, 6
    s_and_b32 s98, s2, 63
    s_mul_i32 s99, s97, 144
    s_add_u32 s99, s99, s98
    v_lshlrev_b32 v2, 4, v0
    v_lshlrev_b32 v3, 4, v1
    s_waitcnt lgkmcnt(0)

    s_mov_b32 s48, s20
    s_and_b32 s49, s21, 0xffff
    s_mov_b32 s50, 0xa2000
    s_mov_b32 s51, 0x20000
    s_mov_b32 s52, s46
    s_and_b32 s53, s47, 0xffff
    s_mov_b32 s54, 0xb70000
    s_mov_b32 s55, 0x20000
    s_mov_b32 s56, s42
    s_and_b32 s57, s43, 0xffff
    s_mov_b32 s58, 0x240000
    s_mov_b32 s59, 0x20000
    s_lshl_b32 s9, s3, 3
    s_add_u32 s8, s9, s4
    s_mul_i32 s8, s8, 1152
    s_lshl_b32 s11, s3, 13
    s_add_u32 s11, s11, 110592
    s_and_b32 s9, s9, 15
    v_xor_b32 v12, s9, v1

    v_xor_b32 v13, 0, v12
    s_add_u32 m0, s11, 0
    v_lshlrev_b32 v13, 4, v13
    buffer_load_dwordx4 v13, s[52:55], s8 offen lds
    s_add_u32 s8, s8, 1152
    v_xor_b32 v13, 1, v12
    s_add_u32 m0, s11, 1024
    v_lshlrev_b32 v13, 4, v13
    buffer_load_dwordx4 v13, s[52:55], s8 offen lds
    s_add_u32 s8, s8, 1152
    v_xor_b32 v13, 2, v12
    s_add_u32 m0, s11, 2048
    v_lshlrev_b32 v13, 4, v13
    buffer_load_dwordx4 v13, s[52:55], s8 offen lds
    s_add_u32 s8, s8, 1152
    v_xor_b32 v13, 3, v12
    s_add_u32 m0, s11, 3072
    v_lshlrev_b32 v13, 4, v13
    buffer_load_dwordx4 v13, s[52:55], s8 offen lds
    s_add_u32 s8, s8, 1152
    v_xor_b32 v13, 4, v12
    s_add_u32 m0, s11, 4096
    v_lshlrev_b32 v13, 4, v13
    buffer_load_dwordx4 v13, s[52:55], s8 offen lds
    s_add_u32 s8, s8, 1152
    v_xor_b32 v13, 5, v12
    s_add_u32 m0, s11, 5120
    v_lshlrev_b32 v13, 4, v13
    buffer_load_dwordx4 v13, s[52:55], s8 offen lds
    s_add_u32 s8, s8, 1152
    v_xor_b32 v13, 6, v12
    s_add_u32 m0, s11, 6144
    v_lshlrev_b32 v13, 4, v13
    buffer_load_dwordx4 v13, s[52:55], s8 offen lds
    s_add_u32 s8, s8, 1152
    v_xor_b32 v13, 7, v12
    s_add_u32 m0, s11, 7168
    v_lshlrev_b32 v13, 4, v13
    buffer_load_dwordx4 v13, s[52:55], s8 offen lds
    s_add_u32 s8, s8, 1152
    v_lshrrev_b32 v12, 3, v1
    v_and_b32 v13, 7, v1
    v_xor_b32 v13, v13, v12
    v_mul_u32_u24 v12, 1152, v12
    v_lshl_add_u32 v13, v13, 4, v12
    s_sub_u32 s8, s8, 8192
    s_lshl_b32 s11, s3, 10
    s_add_u32 m0, s11, 143360
    s_nop 0
    buffer_load_dwordx4 v13, s[52:55], s8 offen lds

    s_mul_i32 s8, s3, 22528
    s_add_u32 s8, s8, 0xb00000
    buffer_load_dwordx4 a[232:235], v3, s[52:55], s8 offen offset:0
    buffer_load_dwordx4 a[236:239], v3, s[52:55], s8 offen offset:1024
    buffer_load_dwordx4 a[240:243], v3, s[52:55], s8 offen offset:2048
    buffer_load_dwordx4 a[244:247], v3, s[52:55], s8 offen offset:3072
    s_add_u32 s8, s8, 4096
    buffer_load_dwordx4 a[248:251], v3, s[52:55], s8 offen offset:0
    buffer_load_dwordx4 a[164:167], v3, s[52:55], s8 offen offset:1024
    buffer_load_dwordx4 a[168:171], v3, s[52:55], s8 offen offset:2048
    buffer_load_dwordx4 a[172:175], v3, s[52:55], s8 offen offset:3072
    s_add_u32 s8, s8, 4096
    buffer_load_dwordx4 a[176:179], v3, s[52:55], s8 offen offset:0
    buffer_load_dwordx4 a[180:183], v3, s[52:55], s8 offen offset:1024
    buffer_load_dwordx4 a[184:187], v3, s[52:55], s8 offen offset:2048
    buffer_load_dwordx4 a[188:191], v3, s[52:55], s8 offen offset:3072
    s_add_u32 s8, s8, 4096
    buffer_load_dwordx4 a[192:195], v3, s[52:55], s8 offen offset:0
    buffer_load_dwordx4 a[196:199], v3, s[52:55], s8 offen offset:1024
    buffer_load_dwordx4 a[200:203], v3, s[52:55], s8 offen offset:2048
    buffer_load_dwordx4 a[204:207], v3, s[52:55], s8 offen offset:3072
    s_add_u32 s8, s8, 4096
    buffer_load_dwordx4 a[208:211], v3, s[52:55], s8 offen offset:0
    buffer_load_dwordx4 a[212:215], v3, s[52:55], s8 offen offset:1024
    buffer_load_dwordx4 a[216:219], v3, s[52:55], s8 offen offset:2048
    buffer_load_dwordx4 a[220:223], v3, s[52:55], s8 offen offset:3072
    s_add_u32 s8, s8, 4096
    buffer_load_dwordx4 a[224:227], v3, s[52:55], s8 offen offset:0
    buffer_load_dwordx4 a[228:231], v3, s[52:55], s8 offen offset:1024
    s_mul_i32 s8, s6, 1152
    s_lshl_b32 s9, s5, 1
    s_add_u32 s8, s8, s9
    v_mul_u32_u24 v13, 57, v1
    v_lshrrev_b32 v13, 10, v13
    v_mul_u32_u24 v14, 18, v13
    v_sub_u32 v14, v1, v14
    v_mul_u32_u24 v13, 1152, v13
    v_lshl_add_u32 v13, v14, 4, v13
    v_add_u32 v240, s8, v13
    v_mov_b32 v15, 864

    v_add_u32 v14, 10, v14
    v_cmp_le_u32 vcc, 18, v14
    v_add_u32 v241, 3616, v240
    v_subrev_u32 v13, 18, v14
    v_cndmask_b32 v12, 0, v15, vcc
    v_cndmask_b32 v14, v14, v13, vcc
    v_add_u32 v241, v241, v12

    v_add_u32 v14, 10, v14
    v_cmp_le_u32 vcc, 18, v14
    v_add_u32 v242, 3616, v241
    v_subrev_u32 v13, 18, v14
    v_cndmask_b32 v12, 0, v15, vcc
    v_cndmask_b32 v14, v14, v13, vcc
    v_add_u32 v242, v242, v12

    v_add_u32 v14, 10, v14
    v_cmp_le_u32 vcc, 18, v14
    v_add_u32 v243, 3616, v242
    v_subrev_u32 v13, 18, v14
    v_cndmask_b32 v12, 0, v15, vcc
    v_cndmask_b32 v14, v14, v13, vcc
    v_add_u32 v243, v243, v12

    v_add_u32 v14, 10, v14
    v_cmp_le_u32 vcc, 18, v14
    v_add_u32 v244, 3616, v243
    v_subrev_u32 v13, 18, v14
    v_cndmask_b32 v12, 0, v15, vcc
    v_cndmask_b32 v14, v14, v13, vcc
    v_add_u32 v244, v244, v12

    v_add_u32 v14, 10, v14
    v_cmp_le_u32 vcc, 18, v14
    v_add_u32 v245, 3616, v244
    v_subrev_u32 v13, 18, v14
    v_cndmask_b32 v12, 0, v15, vcc
    v_cndmask_b32 v14, v14, v13, vcc
    v_add_u32 v245, v245, v12

    v_add_u32 v14, 10, v14
    v_cmp_le_u32 vcc, 18, v14
    v_add_u32 v246, 3616, v245
    v_subrev_u32 v13, 18, v14
    v_cndmask_b32 v12, 0, v15, vcc
    v_cndmask_b32 v14, v14, v13, vcc
    v_add_u32 v246, v246, v12

    v_add_u32 v14, 10, v14
    v_cmp_le_u32 vcc, 18, v14
    v_add_u32 v247, 3616, v246
    v_subrev_u32 v13, 18, v14
    v_cndmask_b32 v12, 0, v15, vcc
    v_cndmask_b32 v14, v14, v13, vcc
    v_add_u32 v247, v247, v12

    v_add_u32 v14, 10, v14
    v_cmp_le_u32 vcc, 18, v14
    v_add_u32 v248, 3616, v247
    v_subrev_u32 v13, 18, v14
    v_cndmask_b32 v12, 0, v15, vcc
    v_cndmask_b32 v14, v14, v13, vcc
    v_add_u32 v248, v248, v12

    s_lshl_b32 s9, s12, 4
    s_add_u32 s9, s9, s4
    v_add_u32 v12, s9, v10
    v_lshlrev_b32 v12, 2, v12
    s_mov_b32 s9, 0xb1c000
    buffer_load_dword v8, v12, s[52:55], s9 offen

    v_lshrrev_b32 v12, 2, v10
    v_lshl_add_u32 v13, v11, 2, v12
    v_mul_u32_u24 v14, 288, v13
    v_and_b32 v15, 3, v1
    v_lshl_add_u32 v14, v15, 3, v14
    v_add_u32 v6, s7, v14
    v_lshlrev_b32 v14, 6, v13
    v_lshl_add_u32 v14, v15, 3, v14
    s_lshl_b32 s9, s12, 5
    s_lshl_b32 s11, s13, 10
    s_add_u32 s9, s9, s11
    s_add_u32 s9, s9, 147456
    v_add_u32 v7, s9, v14
    v_lshlrev_b32 v12, 10, v10
    v_add_u32 v12, 110592, v12
    v_lshlrev_b32 v15, 7, v10
    v_add_u32 v15, 143360, v15
    v_and_b32 v13, 7, v10
    s_mul_i32 s9, s3, 18

    v_add_u32 v14, 0, v11
    v_add_u32 v14, s9, v14
    v_cmp_le_u32 vcc, 64, v14
    v_xor_b32 v16, v14, v10
    v_lshl_add_u32 v16, v16, 4, v12
    v_add_u32 v17, 16384, v16
    v_xor_b32 v14, v14, v13
    v_and_b32 v14, 7, v14
    v_lshl_add_u32 v14, v14, 4, v15
    v_add_u32 v18, 2048, v14
    v_cndmask_b32 v249, v16, v14, vcc
    v_cndmask_b32 v228, v17, v18, vcc
    v_add_u32 v14, 4, v11
    v_add_u32 v14, s9, v14
    v_cmp_le_u32 vcc, 64, v14
    v_xor_b32 v16, v14, v10
    v_lshl_add_u32 v16, v16, 4, v12
    v_add_u32 v17, 16384, v16
    v_xor_b32 v14, v14, v13
    v_and_b32 v14, 7, v14
    v_lshl_add_u32 v14, v14, 4, v15
    v_add_u32 v18, 2048, v14
    v_cndmask_b32 v250, v16, v14, vcc
    v_cndmask_b32 v229, v17, v18, vcc
    v_add_u32 v14, 8, v11
    v_add_u32 v14, s9, v14
    v_cmp_le_u32 vcc, 64, v14
    v_xor_b32 v16, v14, v10
    v_lshl_add_u32 v16, v16, 4, v12
    v_add_u32 v17, 16384, v16
    v_xor_b32 v14, v14, v13
    v_and_b32 v14, 7, v14
    v_lshl_add_u32 v14, v14, 4, v15
    v_add_u32 v18, 2048, v14
    v_cndmask_b32 v251, v16, v14, vcc
    v_cndmask_b32 v230, v17, v18, vcc
    v_add_u32 v14, 12, v11
    v_add_u32 v14, s9, v14
    v_cmp_le_u32 vcc, 64, v14
    v_xor_b32 v16, v14, v10
    v_lshl_add_u32 v16, v16, 4, v12
    v_add_u32 v17, 16384, v16
    v_xor_b32 v14, v14, v13
    v_and_b32 v14, 7, v14
    v_lshl_add_u32 v14, v14, 4, v15
    v_add_u32 v18, 2048, v14
    v_cndmask_b32 v252, v16, v14, vcc
    v_cndmask_b32 v231, v17, v18, vcc
    v_and_b32 v14, 1, v11
    v_add_u32 v14, 16, v14
    v_add_u32 v14, s9, v14
    v_cmp_le_u32 vcc, 64, v14
    v_xor_b32 v16, v14, v10
    v_lshl_add_u32 v16, v16, 4, v12
    v_add_u32 v17, 16384, v16
    v_xor_b32 v14, v14, v13
    v_and_b32 v14, 7, v14
    v_lshl_add_u32 v14, v14, 4, v15
    v_add_u32 v18, 2048, v14
    v_cndmask_b32 v253, v16, v14, vcc
    v_cndmask_b32 v232, v17, v18, vcc
    s_mov_b32 s76, 0xb18000
    buffer_load_dwordx4 v[56:59], v3, s[52:55], s76 offen offset:0
    buffer_load_dwordx4 v[60:63], v3, s[52:55], s76 offen offset:1024
    buffer_load_dwordx4 v[64:67], v3, s[52:55], s76 offen offset:2048
    buffer_load_dwordx4 v[68:71], v3, s[52:55], s76 offen offset:3072
    s_add_u32 s76, s76, 4096
    buffer_load_dwordx4 v[72:75], v3, s[52:55], s76 offen offset:0
    buffer_load_dwordx4 v[76:79], v3, s[52:55], s76 offen offset:1024
    buffer_load_dwordx4 v[80:83], v3, s[52:55], s76 offen offset:2048
    buffer_load_dwordx4 v[84:87], v3, s[52:55], s76 offen offset:3072
    s_add_u32 s76, s76, 4096
    buffer_load_dwordx4 v[88:91], v3, s[52:55], s76 offen offset:0
    s_mov_b32 s73, 0x0
    s_add_u32 m0, s7, 0x0
    s_nop 0
    buffer_load_dwordx4 v240, s[48:51], s73 offen lds
    s_add_u32 m0, s7, 0x400
    s_nop 0
    buffer_load_dwordx4 v241, s[48:51], s73 offen lds
    s_add_u32 m0, s7, 0x800
    s_nop 0
    buffer_load_dwordx4 v242, s[48:51], s73 offen lds
    s_add_u32 m0, s7, 0xc00
    s_nop 0
    buffer_load_dwordx4 v243, s[48:51], s73 offen lds
    s_add_u32 m0, s7, 0x1000
    s_nop 0
    buffer_load_dwordx4 v244, s[48:51], s73 offen lds
    s_add_u32 m0, s7, 0x1400
    s_nop 0
    buffer_load_dwordx4 v245, s[48:51], s73 offen lds
    s_add_u32 m0, s7, 0x1800
    s_nop 0
    buffer_load_dwordx4 v246, s[48:51], s73 offen lds
    s_add_u32 m0, s7, 0x1c00
    s_nop 0
    buffer_load_dwordx4 v247, s[48:51], s73 offen lds
    s_add_u32 m0, s7, 0x2000
    s_nop 0
    buffer_load_dwordx4 v248, s[48:51], s73 offen lds
    s_mov_b32 s73, 0x9000
    s_add_u32 m0, s7, 0x2400
    s_nop 0
    buffer_load_dwordx4 v240, s[48:51], s73 offen lds
    s_add_u32 m0, s7, 0x2800
    s_waitcnt vmcnt(42)
    s_barrier
    ds_read_b128 v[16:19], v249
    ds_read_b128 v[20:23], v228
    ds_read_b128 v[24:27], v250
    ds_read_b128 v[28:31], v229
    ds_read_b128 v[32:35], v251
    ds_read_b128 v[36:39], v230
    ds_read_b128 v[40:43], v252
    ds_read_b128 v[44:47], v231
    ds_read_b128 v[48:51], v253
    ds_read_b128 v[52:55], v232
    s_mov_b32 s66, 0x0000bf80
    s_mov_b32 s67, 0xbf800000
    s_mov_b32 s68, 0x358637bd
    s_waitcnt lgkmcnt(0)
    s_waitcnt vmcnt(41)
    v_mfma_f32_16x16x32_bf16 v[216:219], a[232:235], v[16:19], 0
    s_nop 0
    buffer_load_dwordx4 v241, s[48:51], s73 offen lds
    v_mfma_f32_16x16x32_bf16 v[220:223], a[232:235], v[20:23], 0
    s_add_u32 m0, s7, 0x2c00
    s_nop 0
    s_waitcnt vmcnt(41)
    v_mfma_f32_16x16x32_bf16 v[216:219], a[236:239], v[24:27], v[216:219]
    buffer_load_dwordx4 v242, s[48:51], s73 offen lds
    s_add_u32 m0, s7, 0x3000
    v_mfma_f32_16x16x32_bf16 v[220:223], a[236:239], v[28:31], v[220:223]
    s_nop 0
    buffer_load_dwordx4 v243, s[48:51], s73 offen lds
    s_waitcnt vmcnt(42)
    v_mfma_f32_16x16x32_bf16 v[216:219], a[240:243], v[32:35], v[216:219]
    s_add_u32 m0, s7, 0x3400
    s_nop 0
    v_mfma_f32_16x16x32_bf16 v[220:223], a[240:243], v[36:39], v[220:223]
    buffer_load_dwordx4 v244, s[48:51], s73 offen lds
    s_add_u32 m0, s7, 0x3800
    s_waitcnt vmcnt(42)
    v_mfma_f32_16x16x32_bf16 v[216:219], a[244:247], v[40:43], v[216:219]
    s_nop 0
    buffer_load_dwordx4 v245, s[48:51], s73 offen lds
    v_mfma_f32_16x16x32_bf16 v[220:223], a[244:247], v[44:47], v[220:223]
    s_add_u32 m0, s7, 0x3c00
    s_nop 0
    s_waitcnt vmcnt(42)
    v_mfma_f32_16x16x32_bf16 v[216:219], a[248:251], v[48:51], v[216:219]
    buffer_load_dwordx4 v246, s[48:51], s73 offen lds
    s_add_u32 m0, s7, 0x4000
    v_mfma_f32_16x16x32_bf16 v[220:223], a[248:251], v[52:55], v[220:223]
    s_nop 0
    buffer_load_dwordx4 v247, s[48:51], s73 offen lds
    s_waitcnt vmcnt(43)
    v_mfma_f32_16x16x32_bf16 v[144:147], a[164:167], v[16:19], 0
    s_add_u32 m0, s7, 0x4400
    s_nop 0
    v_mfma_f32_16x16x32_bf16 v[148:151], a[164:167], v[20:23], 0
    buffer_load_dwordx4 v248, s[48:51], s73 offen lds
    s_mov_b32 s73, 0x12000
    s_waitcnt vmcnt(43)
    v_mfma_f32_16x16x32_bf16 v[152:155], a[168:171], v[16:19], 0
    s_add_u32 m0, s7, 0x4800
    s_nop 0
    v_mfma_f32_16x16x32_bf16 v[156:159], a[168:171], v[20:23], 0
    buffer_load_dwordx4 v240, s[48:51], s73 offen lds
    s_add_u32 m0, s7, 0x4c00
    s_waitcnt vmcnt(43)
    v_mfma_f32_16x16x32_bf16 v[152:155], a[172:175], v[24:27], v[152:155]
    s_nop 0
    buffer_load_dwordx4 v241, s[48:51], s73 offen lds
    v_mfma_f32_16x16x32_bf16 v[156:159], a[172:175], v[28:31], v[156:159]
    s_add_u32 m0, s7, 0x5000
    s_nop 0
    s_waitcnt vmcnt(43)
    v_mfma_f32_16x16x32_bf16 v[160:163], a[176:179], v[16:19], 0
    buffer_load_dwordx4 v242, s[48:51], s73 offen lds
    s_add_u32 m0, s7, 0x5400
    v_mfma_f32_16x16x32_bf16 v[164:167], a[176:179], v[20:23], 0
    s_nop 0
    buffer_load_dwordx4 v243, s[48:51], s73 offen lds
    s_waitcnt vmcnt(44)
    v_mfma_f32_16x16x32_bf16 v[160:163], a[180:183], v[24:27], v[160:163]
    s_add_u32 m0, s7, 0x5800
    s_nop 0
    v_mfma_f32_16x16x32_bf16 v[164:167], a[180:183], v[28:31], v[164:167]
    buffer_load_dwordx4 v244, s[48:51], s73 offen lds
    s_add_u32 m0, s7, 0x5c00
    s_waitcnt vmcnt(44)
    v_mfma_f32_16x16x32_bf16 v[168:171], a[184:187], v[24:27], 0
    s_nop 0
    buffer_load_dwordx4 v245, s[48:51], s73 offen lds
    v_mfma_f32_16x16x32_bf16 v[172:175], a[184:187], v[28:31], 0
    s_add_u32 m0, s7, 0x6000
    s_nop 0
    s_waitcnt vmcnt(44)
    v_mfma_f32_16x16x32_bf16 v[168:171], a[188:191], v[32:35], v[168:171]
    buffer_load_dwordx4 v246, s[48:51], s73 offen lds
    s_add_u32 m0, s7, 0x6400
    v_mfma_f32_16x16x32_bf16 v[172:175], a[188:191], v[36:39], v[172:175]
    s_nop 0
    buffer_load_dwordx4 v247, s[48:51], s73 offen lds
    v_cvt_pk_bf16_f32 v132, v216, v217
    v_cvt_pk_bf16_f32 v138, v220, v221
    v_lshlrev_b32 v134, 16, v132
    v_and_b32 v135, 0xffff0000, v132
    v_lshlrev_b32 v140, 16, v138
    v_and_b32 v141, 0xffff0000, v138
    v_add_f32 v134, s68, v134
    v_add_f32 v135, s68, v135
    v_add_f32 v140, s68, v140
    v_add_f32 v141, s68, v141
    v_cvt_pk_bf16_f32 v132, v134, v135
    v_cvt_pk_bf16_f32 v138, v140, v141
    v_lshlrev_b32 v134, 16, v132
    v_and_b32 v135, 0xffff0000, v132
    v_lshlrev_b32 v140, 16, v138
    v_and_b32 v141, 0xffff0000, v138
    v_rcp_f32 v134, v134
    v_rcp_f32 v135, v135
    v_rcp_f32 v140, v140
    v_rcp_f32 v141, v141
    s_nop 0
    v_cvt_pk_bf16_f32 v124, v134, v135
    v_cvt_pk_bf16_f32 v128, v140, v141
    v_dot2_f32_bf16 v134, v124, s66, v134
    v_dot2_f32_bf16 v135, v124, s67, v135
    v_dot2_f32_bf16 v140, v128, s66, v140
    v_dot2_f32_bf16 v141, v128, s67, v141
    s_nop 2
    v_cvt_pk_bf16_f32 v125, v134, v135
    v_cvt_pk_bf16_f32 v129, v140, v141
    v_dot2_f32_bf16 v134, v125, s66, v134
    v_dot2_f32_bf16 v135, v125, s67, v135
    v_dot2_f32_bf16 v140, v129, s66, v140
    v_dot2_f32_bf16 v141, v129, s67, v141
    s_nop 2
    v_cvt_pk_bf16_f32 v126, v134, v135
    v_cvt_pk_bf16_f32 v130, v140, v141
    v_mov_b32 v127, 0
    v_mov_b32 v131, 0
    s_waitcnt vmcnt(45)
    v_mfma_f32_16x16x32_bf16 v[176:179], a[192:195], v[24:27], 0
    s_add_u32 m0, s7, 0x6800
    s_nop 0
    v_mfma_f32_16x16x32_bf16 v[180:183], a[192:195], v[28:31], 0
    buffer_load_dwordx4 v248, s[48:51], s73 offen lds
    s_mul_i32 s76, s5, 4352
    s_waitcnt vmcnt(45)
    v_mfma_f32_16x16x32_bf16 v[176:179], a[196:199], v[32:35], v[176:179]
    s_lshl_b32 s77, s4, 1
    s_add_u32 s76, s76, s77
    v_mfma_f32_16x16x32_bf16 v[180:183], a[196:199], v[36:39], v[180:183]
    s_add_u32 s76, s76, 0x4b0000
    v_lshrrev_b32 v234, 2, v1
    s_waitcnt vmcnt(44)
    v_mfma_f32_16x16x32_bf16 v[184:187], a[200:203], v[32:35], 0
    v_mul_u32_u24 v234, 4352, v234
    v_and_b32 v235, 3, v1
    v_mfma_f32_16x16x32_bf16 v[188:191], a[200:203], v[36:39], 0
    v_lshl_add_u32 v234, v235, 4, v234
    s_mul_i32 s77, s3, 139264
    s_waitcnt vmcnt(43)
    v_mfma_f32_16x16x32_bf16 v[184:187], a[204:207], v[40:43], v[184:187]
    s_add_u32 s77, s77, s76
    s_lshl_b32 s78, s3, 11
    v_mfma_f32_16x16x32_bf16 v[188:191], a[204:207], v[44:47], v[188:191]
    s_add_u32 m0, s78, 147456
    s_nop 0
    s_waitcnt vmcnt(42)
    v_mfma_f32_16x16x32_bf16 v[192:195], a[208:211], v[32:35], 0
    buffer_load_dwordx4 v234, s[52:55], s77 offen lds
    s_add_u32 s77, s77, 69632
    v_mfma_f32_16x16x32_bf16 v[196:199], a[208:211], v[36:39], 0
    s_add_u32 m0, s78, 148480
    s_nop 0
    s_waitcnt vmcnt(41)
    v_mfma_f32_16x16x32_bf16 v[192:195], a[212:215], v[40:43], v[192:195]
    buffer_load_dwordx4 v234, s[52:55], s77 offen lds
    s_add_u32 s77, s76, 557056
    v_mfma_f32_16x16x32_bf16 v[196:199], a[212:215], v[44:47], v[196:199]
    s_mov_b32 m0, 155648
    s_nop 0
    s_waitcnt vmcnt(40)
    v_mfma_f32_16x16x32_bf16 v[200:203], a[216:219], v[40:43], 0
    buffer_load_dwordx4 v234, s[52:55], s77 offen lds
    v_mfma_f32_16x16x32_bf16 v[204:207], a[216:219], v[44:47], 0
    s_waitcnt vmcnt(42)
    v_mfma_f32_16x16x32_bf16 v[200:203], a[220:223], v[48:51], v[200:203]
    v_mfma_f32_16x16x32_bf16 v[204:207], a[220:223], v[52:55], v[204:207]
    s_waitcnt vmcnt(41)
    v_mfma_f32_16x16x32_bf16 v[208:211], a[224:227], v[40:43], 0
    v_mfma_f32_16x16x32_bf16 v[212:215], a[224:227], v[44:47], 0
    s_waitcnt vmcnt(40)
    v_mfma_f32_16x16x32_bf16 v[208:211], a[228:231], v[48:51], v[208:211]
    v_mfma_f32_16x16x32_bf16 v[212:215], a[228:231], v[52:55], v[212:215]
    s_waitcnt vmcnt(30)
    v_mfma_f32_16x16x32_bf16 v[100:103], v[56:59], v[124:127], 0
    v_mfma_f32_16x16x32_bf16 v[104:107], v[56:59], v[128:131], 0
    v_mfma_f32_16x16x32_bf16 v[108:111], v[60:63], v[124:127], 0
    v_mfma_f32_16x16x32_bf16 v[112:115], v[60:63], v[128:131], 0
    v_cvt_pk_bf16_f32 v144, v144, v145
    v_cvt_pk_bf16_f32 v146, v146, v147
    v_cvt_pk_bf16_f32 v148, v148, v149
    v_cvt_pk_bf16_f32 v150, v150, v151
    v_lshlrev_b32 v116, 16, v144
    v_and_b32 v117, 0xffff0000, v144
    v_lshlrev_b32 v118, 16, v146
    v_and_b32 v119, 0xffff0000, v146
    v_lshlrev_b32 v120, 16, v148
    v_and_b32 v121, 0xffff0000, v148
    v_lshlrev_b32 v122, 16, v150
    v_and_b32 v123, 0xffff0000, v150
    v_pk_mul_f32 v[116:117], v[116:117], v[100:101]
    v_pk_mul_f32 v[118:119], v[118:119], v[102:103]
    v_pk_mul_f32 v[120:121], v[120:121], v[104:105]
    v_pk_mul_f32 v[122:123], v[122:123], v[106:107]
    v_cvt_pk_bf16_f32 v16, v116, v117
    v_cvt_pk_bf16_f32 v17, v118, v119
    v_cvt_pk_bf16_f32 v34, v120, v121
    v_cvt_pk_bf16_f32 v35, v122, v123
    v_mfma_f32_16x16x32_bf16 v[100:103], v[64:67], v[124:127], 0
    v_mfma_f32_16x16x32_bf16 v[104:107], v[64:67], v[128:131], 0
    v_cvt_pk_bf16_f32 v152, v152, v153
    v_cvt_pk_bf16_f32 v154, v154, v155
    v_cvt_pk_bf16_f32 v156, v156, v157
    v_cvt_pk_bf16_f32 v158, v158, v159
    v_lshlrev_b32 v116, 16, v152
    v_and_b32 v117, 0xffff0000, v152
    v_lshlrev_b32 v118, 16, v154
    v_and_b32 v119, 0xffff0000, v154
    v_lshlrev_b32 v120, 16, v156
    v_and_b32 v121, 0xffff0000, v156
    v_lshlrev_b32 v122, 16, v158
    v_and_b32 v123, 0xffff0000, v158
    v_pk_mul_f32 v[116:117], v[116:117], v[108:109]
    v_pk_mul_f32 v[118:119], v[118:119], v[110:111]
    v_pk_mul_f32 v[120:121], v[120:121], v[112:113]
    v_pk_mul_f32 v[122:123], v[122:123], v[114:115]
    v_cvt_pk_bf16_f32 v18, v116, v117
    v_cvt_pk_bf16_f32 v19, v118, v119
    v_cvt_pk_bf16_f32 v36, v120, v121
    v_cvt_pk_bf16_f32 v37, v122, v123
    s_waitcnt vmcnt(21)
    ds_read_b64_tr_b16 a[0:1], v6 offset:0
    ds_read_b64_tr_b16 a[2:3], v6 offset:4608
    ds_read_b64_tr_b16 a[4:5], v6 offset:32
    ds_read_b64_tr_b16 a[6:7], v6 offset:4640
    ds_read_b64_tr_b16 a[8:9], v6 offset:64
    ds_read_b64_tr_b16 a[10:11], v6 offset:4672
    ds_read_b64_tr_b16 a[12:13], v6 offset:96
    ds_read_b64_tr_b16 a[14:15], v6 offset:4704
    ds_read_b64_tr_b16 a[16:17], v6 offset:128
    ds_read_b64_tr_b16 a[18:19], v6 offset:4736
    ds_read_b64_tr_b16 a[20:21], v6 offset:160
    v_mfma_f32_16x16x32_bf16 v[108:111], v[68:71], v[124:127], 0
    v_mfma_f32_16x16x32_bf16 v[112:115], v[68:71], v[128:131], 0
    v_cvt_pk_bf16_f32 v160, v160, v161
    v_cvt_pk_bf16_f32 v162, v162, v163
    v_cvt_pk_bf16_f32 v164, v164, v165
    v_cvt_pk_bf16_f32 v166, v166, v167
    v_lshlrev_b32 v116, 16, v160
    v_and_b32 v117, 0xffff0000, v160
    v_lshlrev_b32 v118, 16, v162
    v_and_b32 v119, 0xffff0000, v162
    v_lshlrev_b32 v120, 16, v164
    v_and_b32 v121, 0xffff0000, v164
    v_lshlrev_b32 v122, 16, v166
    v_and_b32 v123, 0xffff0000, v166
    v_pk_mul_f32 v[116:117], v[116:117], v[100:101]
    v_pk_mul_f32 v[118:119], v[118:119], v[102:103]
    v_pk_mul_f32 v[120:121], v[120:121], v[104:105]
    v_pk_mul_f32 v[122:123], v[122:123], v[106:107]
    v_cvt_pk_bf16_f32 v20, v116, v117
    v_cvt_pk_bf16_f32 v21, v118, v119
    v_cvt_pk_bf16_f32 v38, v120, v121
    v_cvt_pk_bf16_f32 v39, v122, v123
    ds_read_b64_tr_b16 a[22:23], v6 offset:4768
    ds_read_b64_tr_b16 a[24:25], v6 offset:192
    ds_read_b64_tr_b16 a[26:27], v6 offset:4800
    ds_read_b64_tr_b16 a[28:29], v6 offset:224
    ds_read_b64_tr_b16 a[30:31], v6 offset:4832
    ds_read_b64_tr_b16 a[32:33], v6 offset:256
    ds_read_b64_tr_b16 a[34:35], v6 offset:4864
    s_waitcnt lgkmcnt(0)
    s_mov_b32 s73, 0x1b000
    s_add_u32 m0, s7, 0x0
    s_nop 0
    buffer_load_dwordx4 v240, s[48:51], s73 offen lds
    v_mfma_f32_16x16x32_bf16 v[100:103], v[72:75], v[124:127], 0
    v_mfma_f32_16x16x32_bf16 v[104:107], v[72:75], v[128:131], 0
    v_cvt_pk_bf16_f32 v168, v168, v169
    v_cvt_pk_bf16_f32 v170, v170, v171
    v_cvt_pk_bf16_f32 v172, v172, v173
    v_cvt_pk_bf16_f32 v174, v174, v175
    v_lshlrev_b32 v116, 16, v168
    v_and_b32 v117, 0xffff0000, v168
    v_lshlrev_b32 v118, 16, v170
    v_and_b32 v119, 0xffff0000, v170
    v_lshlrev_b32 v120, 16, v172
    v_and_b32 v121, 0xffff0000, v172
    v_lshlrev_b32 v122, 16, v174
    v_and_b32 v123, 0xffff0000, v174
    v_pk_mul_f32 v[116:117], v[116:117], v[108:109]
    v_pk_mul_f32 v[118:119], v[118:119], v[110:111]
    v_pk_mul_f32 v[120:121], v[120:121], v[112:113]
    v_pk_mul_f32 v[122:123], v[122:123], v[114:115]
    v_cvt_pk_bf16_f32 v22, v116, v117
    v_cvt_pk_bf16_f32 v23, v118, v119
    v_cvt_pk_bf16_f32 v40, v120, v121
    v_cvt_pk_bf16_f32 v41, v122, v123
    s_add_u32 m0, s7, 0x400
    s_nop 0
    buffer_load_dwordx4 v241, s[48:51], s73 offen lds
    s_add_u32 m0, s7, 0x800
    s_nop 0
    buffer_load_dwordx4 v242, s[48:51], s73 offen lds
    s_add_u32 m0, s7, 0xc00
    s_nop 0
    buffer_load_dwordx4 v243, s[48:51], s73 offen lds
    s_add_u32 m0, s7, 0x1000
    s_nop 0
    buffer_load_dwordx4 v244, s[48:51], s73 offen lds
    v_mfma_f32_16x16x32_bf16 v[108:111], v[76:79], v[124:127], 0
    v_mfma_f32_16x16x32_bf16 v[112:115], v[76:79], v[128:131], 0
    v_cvt_pk_bf16_f32 v176, v176, v177
    v_cvt_pk_bf16_f32 v178, v178, v179
    v_cvt_pk_bf16_f32 v180, v180, v181
    v_cvt_pk_bf16_f32 v182, v182, v183
    v_lshlrev_b32 v116, 16, v176
    v_and_b32 v117, 0xffff0000, v176
    v_lshlrev_b32 v118, 16, v178
    v_and_b32 v119, 0xffff0000, v178
    v_lshlrev_b32 v120, 16, v180
    v_and_b32 v121, 0xffff0000, v180
    v_lshlrev_b32 v122, 16, v182
    v_and_b32 v123, 0xffff0000, v182
    v_pk_mul_f32 v[116:117], v[116:117], v[100:101]
    v_pk_mul_f32 v[118:119], v[118:119], v[102:103]
    v_pk_mul_f32 v[120:121], v[120:121], v[104:105]
    v_pk_mul_f32 v[122:123], v[122:123], v[106:107]
    v_cvt_pk_bf16_f32 v24, v116, v117
    v_cvt_pk_bf16_f32 v25, v118, v119
    v_cvt_pk_bf16_f32 v42, v120, v121
    v_cvt_pk_bf16_f32 v43, v122, v123
    s_add_u32 m0, s7, 0x1400
    s_nop 0
    buffer_load_dwordx4 v245, s[48:51], s73 offen lds
    s_add_u32 m0, s7, 0x1800
    s_nop 0
    buffer_load_dwordx4 v246, s[48:51], s73 offen lds
    s_add_u32 m0, s7, 0x1c00
    s_nop 0
    buffer_load_dwordx4 v247, s[48:51], s73 offen lds
    s_add_u32 m0, s7, 0x2000
    s_nop 0
    buffer_load_dwordx4 v248, s[48:51], s73 offen lds
    v_mfma_f32_16x16x32_bf16 v[100:103], v[80:83], v[124:127], 0
    v_mfma_f32_16x16x32_bf16 v[104:107], v[80:83], v[128:131], 0
    v_cvt_pk_bf16_f32 v184, v184, v185
    v_cvt_pk_bf16_f32 v186, v186, v187
    v_cvt_pk_bf16_f32 v188, v188, v189
    v_cvt_pk_bf16_f32 v190, v190, v191
    v_lshlrev_b32 v116, 16, v184
    v_and_b32 v117, 0xffff0000, v184
    v_lshlrev_b32 v118, 16, v186
    v_and_b32 v119, 0xffff0000, v186
    v_lshlrev_b32 v120, 16, v188
    v_and_b32 v121, 0xffff0000, v188
    v_lshlrev_b32 v122, 16, v190
    v_and_b32 v123, 0xffff0000, v190
    v_pk_mul_f32 v[116:117], v[116:117], v[108:109]
    v_pk_mul_f32 v[118:119], v[118:119], v[110:111]
    v_pk_mul_f32 v[120:121], v[120:121], v[112:113]
    v_pk_mul_f32 v[122:123], v[122:123], v[114:115]
    v_cvt_pk_bf16_f32 v26, v116, v117
    v_cvt_pk_bf16_f32 v27, v118, v119
    v_cvt_pk_bf16_f32 v44, v120, v121
    v_cvt_pk_bf16_f32 v45, v122, v123
    s_waitcnt vmcnt(21)
    ds_read_b64_tr_b16 a[36:37], v6 offset:9216
    ds_read_b64_tr_b16 a[38:39], v6 offset:13824
    ds_read_b64_tr_b16 a[40:41], v6 offset:9248
    ds_read_b64_tr_b16 a[42:43], v6 offset:13856
    ds_read_b64_tr_b16 a[44:45], v6 offset:9280
    ds_read_b64_tr_b16 a[46:47], v6 offset:13888
    ds_read_b64_tr_b16 a[48:49], v6 offset:9312
    ds_read_b64_tr_b16 a[50:51], v6 offset:13920
    ds_read_b64_tr_b16 a[52:53], v6 offset:9344
    ds_read_b64_tr_b16 a[54:55], v6 offset:13952
    ds_read_b64_tr_b16 a[56:57], v6 offset:9376
    v_mfma_f32_16x16x32_bf16 v[108:111], v[84:87], v[124:127], 0
    v_mfma_f32_16x16x32_bf16 v[112:115], v[84:87], v[128:131], 0
    v_cvt_pk_bf16_f32 v192, v192, v193
    v_cvt_pk_bf16_f32 v194, v194, v195
    v_cvt_pk_bf16_f32 v196, v196, v197
    v_cvt_pk_bf16_f32 v198, v198, v199
    v_lshlrev_b32 v116, 16, v192
    v_and_b32 v117, 0xffff0000, v192
    v_lshlrev_b32 v118, 16, v194
    v_and_b32 v119, 0xffff0000, v194
    v_lshlrev_b32 v120, 16, v196
    v_and_b32 v121, 0xffff0000, v196
    v_lshlrev_b32 v122, 16, v198
    v_and_b32 v123, 0xffff0000, v198
    v_pk_mul_f32 v[116:117], v[116:117], v[100:101]
    v_pk_mul_f32 v[118:119], v[118:119], v[102:103]
    v_pk_mul_f32 v[120:121], v[120:121], v[104:105]
    v_pk_mul_f32 v[122:123], v[122:123], v[106:107]
    v_cvt_pk_bf16_f32 v28, v116, v117
    v_cvt_pk_bf16_f32 v29, v118, v119
    v_cvt_pk_bf16_f32 v46, v120, v121
    v_cvt_pk_bf16_f32 v47, v122, v123
    ds_read_b64_tr_b16 a[58:59], v6 offset:13984
    ds_read_b64_tr_b16 a[60:61], v6 offset:9408
    ds_read_b64_tr_b16 a[62:63], v6 offset:14016
    ds_read_b64_tr_b16 a[64:65], v6 offset:9440
    ds_read_b64_tr_b16 a[66:67], v6 offset:14048
    ds_read_b64_tr_b16 a[68:69], v6 offset:9472
    ds_read_b64_tr_b16 a[70:71], v6 offset:14080
    s_waitcnt lgkmcnt(0)
    s_mov_b32 s73, 0x24000
    s_add_u32 m0, s7, 0x2400
    s_nop 0
    buffer_load_dwordx4 v240, s[48:51], s73 offen lds
    v_mfma_f32_16x16x32_bf16 v[100:103], v[88:91], v[124:127], 0
    v_mfma_f32_16x16x32_bf16 v[104:107], v[88:91], v[128:131], 0
    v_cvt_pk_bf16_f32 v200, v200, v201
    v_cvt_pk_bf16_f32 v202, v202, v203
    v_cvt_pk_bf16_f32 v204, v204, v205
    v_cvt_pk_bf16_f32 v206, v206, v207
    v_lshlrev_b32 v116, 16, v200
    v_and_b32 v117, 0xffff0000, v200
    v_lshlrev_b32 v118, 16, v202
    v_and_b32 v119, 0xffff0000, v202
    v_lshlrev_b32 v120, 16, v204
    v_and_b32 v121, 0xffff0000, v204
    v_lshlrev_b32 v122, 16, v206
    v_and_b32 v123, 0xffff0000, v206
    v_pk_mul_f32 v[116:117], v[116:117], v[108:109]
    v_pk_mul_f32 v[118:119], v[118:119], v[110:111]
    v_pk_mul_f32 v[120:121], v[120:121], v[112:113]
    v_pk_mul_f32 v[122:123], v[122:123], v[114:115]
    v_cvt_pk_bf16_f32 v30, v116, v117
    v_cvt_pk_bf16_f32 v31, v118, v119
    v_cvt_pk_bf16_f32 v48, v120, v121
    v_cvt_pk_bf16_f32 v49, v122, v123
    s_add_u32 m0, s7, 0x2800
    s_nop 0
    buffer_load_dwordx4 v241, s[48:51], s73 offen lds
    s_add_u32 m0, s7, 0x2c00
    s_nop 0
    buffer_load_dwordx4 v242, s[48:51], s73 offen lds
    s_add_u32 m0, s7, 0x3000
    s_nop 0
    buffer_load_dwordx4 v243, s[48:51], s73 offen lds
    s_add_u32 m0, s7, 0x3400
    s_nop 0
    buffer_load_dwordx4 v244, s[48:51], s73 offen lds
    s_nop 3
    v_cvt_pk_bf16_f32 v208, v208, v209
    v_cvt_pk_bf16_f32 v210, v210, v211
    v_cvt_pk_bf16_f32 v212, v212, v213
    v_cvt_pk_bf16_f32 v214, v214, v215
    v_lshlrev_b32 v116, 16, v208
    v_and_b32 v117, 0xffff0000, v208
    v_lshlrev_b32 v118, 16, v210
    v_and_b32 v119, 0xffff0000, v210
    v_lshlrev_b32 v120, 16, v212
    v_and_b32 v121, 0xffff0000, v212
    v_lshlrev_b32 v122, 16, v214
    v_and_b32 v123, 0xffff0000, v214
    v_pk_mul_f32 v[116:117], v[116:117], v[100:101]
    v_pk_mul_f32 v[118:119], v[118:119], v[102:103]
    v_pk_mul_f32 v[120:121], v[120:121], v[104:105]
    v_pk_mul_f32 v[122:123], v[122:123], v[106:107]
    v_cvt_pk_bf16_f32 v32, v116, v117
    v_cvt_pk_bf16_f32 v33, v118, v119
    v_cvt_pk_bf16_f32 v50, v120, v121
    v_cvt_pk_bf16_f32 v51, v122, v123
    s_waitcnt vmcnt(17)
    ds_read_b64_tr_b16 a[72:73], v6 offset:18432
    ds_read_b64_tr_b16 a[74:75], v6 offset:23040
    ds_read_b64_tr_b16 a[76:77], v6 offset:18464
    ds_read_b64_tr_b16 a[78:79], v6 offset:23072
    ds_read_b64_tr_b16 a[80:81], v6 offset:18496
    ds_read_b64_tr_b16 a[82:83], v6 offset:23104
    ds_read_b64_tr_b16 a[84:85], v6 offset:18528
    ds_read_b64_tr_b16 a[86:87], v6 offset:23136
    ds_read_b64_tr_b16 a[88:89], v6 offset:18560
    ds_read_b64_tr_b16 a[90:91], v6 offset:23168
    ds_read_b64_tr_b16 a[92:93], v6 offset:18592
    ds_read_b64_tr_b16 a[94:95], v6 offset:23200
    ds_read_b64_tr_b16 a[96:97], v6 offset:18624
    ds_read_b64_tr_b16 a[98:99], v6 offset:23232
    ds_read_b64_tr_b16 a[100:101], v6 offset:18656
    ds_read_b64_tr_b16 a[102:103], v6 offset:23264
    ds_read_b64_tr_b16 a[104:105], v6 offset:18688
    ds_read_b64_tr_b16 a[106:107], v6 offset:23296
    v_mfma_f32_16x16x32_bf16 v[144:147], a[0:3], v[16:19], 0
    v_mfma_f32_16x16x32_bf16 v[148:151], a[0:3], v[34:37], 0
    v_mfma_f32_16x16x32_bf16 v[152:155], a[4:7], v[16:19], 0
    v_mfma_f32_16x16x32_bf16 v[156:159], a[4:7], v[34:37], 0
    v_mfma_f32_16x16x32_bf16 v[160:163], a[8:11], v[16:19], 0
    v_mfma_f32_16x16x32_bf16 v[164:167], a[8:11], v[34:37], 0
    v_mfma_f32_16x16x32_bf16 v[168:171], a[12:15], v[16:19], 0
    v_mfma_f32_16x16x32_bf16 v[172:175], a[12:15], v[34:37], 0
    v_mfma_f32_16x16x32_bf16 v[176:179], a[16:19], v[16:19], 0
    v_mfma_f32_16x16x32_bf16 v[180:183], a[16:19], v[34:37], 0
    v_mfma_f32_16x16x32_bf16 v[184:187], a[20:23], v[16:19], 0
    v_mfma_f32_16x16x32_bf16 v[188:191], a[20:23], v[34:37], 0
    v_mfma_f32_16x16x32_bf16 v[192:195], a[24:27], v[16:19], 0
    v_mfma_f32_16x16x32_bf16 v[196:199], a[24:27], v[34:37], 0
    v_mfma_f32_16x16x32_bf16 v[200:203], a[28:31], v[16:19], 0
    v_mfma_f32_16x16x32_bf16 v[204:207], a[28:31], v[34:37], 0
    v_mfma_f32_16x16x32_bf16 v[208:211], a[32:35], v[16:19], 0
    v_mfma_f32_16x16x32_bf16 v[212:215], a[32:35], v[34:37], 0
    s_waitcnt vmcnt(5)
    ds_read_b64_tr_b16 a[108:109], v6 offset:0
    ds_read_b64_tr_b16 a[110:111], v6 offset:4608
    ds_read_b64_tr_b16 a[112:113], v6 offset:32
    ds_read_b64_tr_b16 a[114:115], v6 offset:4640
    ds_read_b64_tr_b16 a[116:117], v6 offset:64
    ds_read_b64_tr_b16 a[118:119], v6 offset:4672
    ds_read_b64_tr_b16 a[120:121], v6 offset:96
    ds_read_b64_tr_b16 a[122:123], v6 offset:4704
    ds_read_b64_tr_b16 a[124:125], v6 offset:128
    ds_read_b64_tr_b16 a[126:127], v6 offset:4736
    ds_read_b64_tr_b16 a[128:129], v6 offset:160
    ds_read_b64_tr_b16 a[130:131], v6 offset:4768
    ds_read_b64_tr_b16 a[132:133], v6 offset:192
    ds_read_b64_tr_b16 a[134:135], v6 offset:4800
    ds_read_b64_tr_b16 a[136:137], v6 offset:224
    ds_read_b64_tr_b16 a[138:139], v6 offset:4832
    ds_read_b64_tr_b16 a[140:141], v6 offset:256
    ds_read_b64_tr_b16 a[142:143], v6 offset:4864
    v_mfma_f32_16x16x32_bf16 v[144:147], a[36:39], v[20:23], v[144:147]
    v_mfma_f32_16x16x32_bf16 v[148:151], a[36:39], v[38:41], v[148:151]
    v_mfma_f32_16x16x32_bf16 v[152:155], a[40:43], v[20:23], v[152:155]
    v_mfma_f32_16x16x32_bf16 v[156:159], a[40:43], v[38:41], v[156:159]
    v_mfma_f32_16x16x32_bf16 v[160:163], a[44:47], v[20:23], v[160:163]
    v_mfma_f32_16x16x32_bf16 v[164:167], a[44:47], v[38:41], v[164:167]
    v_mfma_f32_16x16x32_bf16 v[168:171], a[48:51], v[20:23], v[168:171]
    v_mfma_f32_16x16x32_bf16 v[172:175], a[48:51], v[38:41], v[172:175]
    v_mfma_f32_16x16x32_bf16 v[176:179], a[52:55], v[20:23], v[176:179]
    v_mfma_f32_16x16x32_bf16 v[180:183], a[52:55], v[38:41], v[180:183]
    v_mfma_f32_16x16x32_bf16 v[184:187], a[56:59], v[20:23], v[184:187]
    v_mfma_f32_16x16x32_bf16 v[188:191], a[56:59], v[38:41], v[188:191]
    v_mfma_f32_16x16x32_bf16 v[192:195], a[60:63], v[20:23], v[192:195]
    v_mfma_f32_16x16x32_bf16 v[196:199], a[60:63], v[38:41], v[196:199]
    v_mfma_f32_16x16x32_bf16 v[200:203], a[64:67], v[20:23], v[200:203]
    v_mfma_f32_16x16x32_bf16 v[204:207], a[64:67], v[38:41], v[204:207]
    v_mfma_f32_16x16x32_bf16 v[208:211], a[68:71], v[20:23], v[208:211]
    v_mfma_f32_16x16x32_bf16 v[212:215], a[68:71], v[38:41], v[212:215]
    s_waitcnt vmcnt(0)
    ds_read_b64_tr_b16 a[144:145], v6 offset:9216
    ds_read_b64_tr_b16 a[146:147], v6 offset:9248
    ds_read_b64_tr_b16 a[148:149], v6 offset:9280
    ds_read_b64_tr_b16 a[150:151], v6 offset:9312
    ds_read_b64_tr_b16 a[152:153], v6 offset:9344
    ds_read_b64_tr_b16 a[154:155], v6 offset:9376
    ds_read_b64_tr_b16 a[156:157], v6 offset:9408
    ds_read_b64_tr_b16 a[158:159], v6 offset:9440
    ds_read_b64_tr_b16 a[160:161], v6 offset:9472
    s_waitcnt lgkmcnt(15)
    v_mfma_f32_16x16x32_bf16 v[144:147], a[72:75], v[24:27], v[144:147]
    v_mfma_f32_16x16x32_bf16 v[148:151], a[72:75], v[42:45], v[148:151]
    v_mfma_f32_16x16x32_bf16 v[152:155], a[76:79], v[24:27], v[152:155]
    v_mfma_f32_16x16x32_bf16 v[156:159], a[76:79], v[42:45], v[156:159]
    v_mfma_f32_16x16x32_bf16 v[160:163], a[80:83], v[24:27], v[160:163]
    v_mfma_f32_16x16x32_bf16 v[164:167], a[80:83], v[42:45], v[164:167]
    v_mfma_f32_16x16x32_bf16 v[168:171], a[84:87], v[24:27], v[168:171]
    v_mfma_f32_16x16x32_bf16 v[172:175], a[84:87], v[42:45], v[172:175]
    v_mfma_f32_16x16x32_bf16 v[176:179], a[88:91], v[24:27], v[176:179]
    v_mfma_f32_16x16x32_bf16 v[180:183], a[88:91], v[42:45], v[180:183]
    v_mfma_f32_16x16x32_bf16 v[184:187], a[92:95], v[24:27], v[184:187]
    v_mfma_f32_16x16x32_bf16 v[188:191], a[92:95], v[42:45], v[188:191]
    v_mfma_f32_16x16x32_bf16 v[192:195], a[96:99], v[24:27], v[192:195]
    v_mfma_f32_16x16x32_bf16 v[196:199], a[96:99], v[42:45], v[196:199]
    v_mfma_f32_16x16x32_bf16 v[200:203], a[100:103], v[24:27], v[200:203]
    v_mfma_f32_16x16x32_bf16 v[204:207], a[100:103], v[42:45], v[204:207]
    v_mfma_f32_16x16x32_bf16 v[208:211], a[104:107], v[24:27], v[208:211]
    v_mfma_f32_16x16x32_bf16 v[212:215], a[104:107], v[42:45], v[212:215]
    s_waitcnt lgkmcnt(9)
    v_mfma_f32_16x16x32_bf16 v[144:147], a[108:111], v[28:31], v[144:147]
    v_mfma_f32_16x16x32_bf16 v[148:151], a[108:111], v[46:49], v[148:151]
    v_mfma_f32_16x16x32_bf16 v[152:155], a[112:115], v[28:31], v[152:155]
    v_mfma_f32_16x16x32_bf16 v[156:159], a[112:115], v[46:49], v[156:159]
    v_mfma_f32_16x16x32_bf16 v[160:163], a[116:119], v[28:31], v[160:163]
    v_mfma_f32_16x16x32_bf16 v[164:167], a[116:119], v[46:49], v[164:167]
    v_mfma_f32_16x16x32_bf16 v[168:171], a[120:123], v[28:31], v[168:171]
    v_mfma_f32_16x16x32_bf16 v[172:175], a[120:123], v[46:49], v[172:175]
    v_mfma_f32_16x16x32_bf16 v[176:179], a[124:127], v[28:31], v[176:179]
    v_mfma_f32_16x16x32_bf16 v[180:183], a[124:127], v[46:49], v[180:183]
    v_mfma_f32_16x16x32_bf16 v[184:187], a[128:131], v[28:31], v[184:187]
    v_mfma_f32_16x16x32_bf16 v[188:191], a[128:131], v[46:49], v[188:191]
    v_mfma_f32_16x16x32_bf16 v[192:195], a[132:135], v[28:31], v[192:195]
    v_mfma_f32_16x16x32_bf16 v[196:199], a[132:135], v[46:49], v[196:199]
    v_mfma_f32_16x16x32_bf16 v[200:203], a[136:139], v[28:31], v[200:203]
    v_mfma_f32_16x16x32_bf16 v[204:207], a[136:139], v[46:49], v[204:207]
    v_mfma_f32_16x16x32_bf16 v[208:211], a[140:143], v[28:31], v[208:211]
    v_mfma_f32_16x16x32_bf16 v[212:215], a[140:143], v[46:49], v[212:215]
    s_waitcnt lgkmcnt(0)
    v_mfma_f32_16x16x16_bf16 v[144:147], a[144:145], v[32:33], v[144:147]
    v_mfma_f32_16x16x16_bf16 v[148:151], a[144:145], v[50:51], v[148:151]
    v_mfma_f32_16x16x16_bf16 v[152:155], a[146:147], v[32:33], v[152:155]
    v_mfma_f32_16x16x16_bf16 v[156:159], a[146:147], v[50:51], v[156:159]
    v_mfma_f32_16x16x16_bf16 v[160:163], a[148:149], v[32:33], v[160:163]
    v_mfma_f32_16x16x16_bf16 v[164:167], a[148:149], v[50:51], v[164:167]
    v_mfma_f32_16x16x16_bf16 v[168:171], a[150:151], v[32:33], v[168:171]
    v_mfma_f32_16x16x16_bf16 v[172:175], a[150:151], v[50:51], v[172:175]
    v_mfma_f32_16x16x16_bf16 v[176:179], a[152:153], v[32:33], v[176:179]
    v_mfma_f32_16x16x16_bf16 v[180:183], a[152:153], v[50:51], v[180:183]
    v_mfma_f32_16x16x16_bf16 v[184:187], a[154:155], v[32:33], v[184:187]
    v_mfma_f32_16x16x16_bf16 v[188:191], a[154:155], v[50:51], v[188:191]
    v_mfma_f32_16x16x16_bf16 v[192:195], a[156:157], v[32:33], v[192:195]
    v_mfma_f32_16x16x16_bf16 v[196:199], a[156:157], v[50:51], v[196:199]
    v_mfma_f32_16x16x16_bf16 v[200:203], a[158:159], v[32:33], v[200:203]
    v_mfma_f32_16x16x16_bf16 v[204:207], a[158:159], v[50:51], v[204:207]
    v_mfma_f32_16x16x16_bf16 v[208:211], a[160:161], v[32:33], v[208:211]
    v_mfma_f32_16x16x16_bf16 v[212:215], a[160:161], v[50:51], v[212:215]
    s_lshl_b32 s9, s3, 10
    v_add_u32 v13, s9, v3
    v_add_u32 v14, 0x9000, v13
    s_waitcnt vmcnt(0)
    s_nop 4
    s_barrier

    ds_write_b128 v13, v[144:147] offset:0
    ds_write_b128 v13, v[148:151] offset:4096
    ds_write_b128 v13, v[152:155] offset:8192
    ds_write_b128 v13, v[156:159] offset:12288
    ds_write_b128 v13, v[160:163] offset:16384
    ds_write_b128 v13, v[164:167] offset:20480
    ds_write_b128 v13, v[168:171] offset:24576
    ds_write_b128 v13, v[172:175] offset:28672
    ds_write_b128 v13, v[176:179] offset:32768
    ds_write_b128 v14, v[180:183] offset:0
    ds_write_b128 v14, v[184:187] offset:4096
    ds_write_b128 v14, v[188:191] offset:8192
    ds_write_b128 v14, v[192:195] offset:12288
    ds_write_b128 v14, v[196:199] offset:16384
    ds_write_b128 v14, v[200:203] offset:20480
    ds_write_b128 v14, v[204:207] offset:24576
    ds_write_b128 v14, v[208:211] offset:28672
    ds_write_b128 v14, v[212:215] offset:32768
    s_lshl_b32 s9, s3, 12
    v_add_u32 v13, s9, v3
    v_add_u32 v14, 0x8000, v13
    s_lshl_b32 s9, s12, 4
    v_add_u32 v15, s9, v10
    v_mul_u32_u24 v15, 304, v15
    v_lshl_add_u32 v15, v11, 3, v15
    s_lshl_b32 s9, s13, 5
    s_add_u32 s9, s9, 110592
    v_add_u32 v15, s9, v15
    v_sub_f32 v9, 1.0, v8
    v_cvt_pk_bf16_f32 v9, v9, v9
    v_lshlrev_b32 v9, 16, v9
    s_mul_i32 s8, s4, 1152
    s_lshl_b32 s9, s5, 1
    s_add_u32 s8, s8, s9
    s_mov_b32 s11, 110592

    v_add_u32 v12, 0, v0
    v_mul_u32_u24 v4, 3641, v12
    v_lshrrev_b32 v4, 16, v4
    v_mul_u32_u24 v5, 18, v4
    v_sub_u32 v5, v12, v5
    v_lshlrev_b32 v5, 4, v5
    v_mul_u32_u24 v12, 304, v4
    v_add3_u32 v228, v12, v5, s11
    v_mul_u32_u24 v4, 1152, v4
    v_add_u32 v232, v4, v5

    v_add_u32 v12, 256, v0
    v_mul_u32_u24 v4, 3641, v12
    v_lshrrev_b32 v4, 16, v4
    v_mul_u32_u24 v5, 18, v4
    v_sub_u32 v5, v12, v5
    v_lshlrev_b32 v5, 4, v5
    v_mul_u32_u24 v12, 304, v4
    v_add3_u32 v229, v12, v5, s11
    v_mul_u32_u24 v4, 1152, v4
    v_add_u32 v233, v4, v5

    v_add_u32 v12, 512, v0
    v_mul_u32_u24 v4, 3641, v12
    v_lshrrev_b32 v4, 16, v4
    v_mul_u32_u24 v5, 18, v4
    v_sub_u32 v5, v12, v5
    v_lshlrev_b32 v5, 4, v5
    v_mul_u32_u24 v12, 304, v4
    v_add3_u32 v230, v12, v5, s11
    v_mul_u32_u24 v4, 1152, v4
    v_add_u32 v234, v4, v5

    s_waitcnt lgkmcnt(0)
    s_barrier
    ds_read_b128 v[16:19], v13 offset:0
    ds_read_b128 v[20:23], v13 offset:1024
    ds_read_b128 v[24:27], v13 offset:2048
    ds_read_b128 v[28:31], v13 offset:3072
    ds_read_b64_tr_b16 v[32:33], v7 offset:0
    ds_read_b128 v[40:43], v13 offset:16384
    ds_read_b128 v[44:47], v13 offset:17408
    ds_read_b128 v[48:51], v13 offset:18432
    ds_read_b128 v[52:55], v13 offset:19456
    ds_read_b64_tr_b16 v[56:57], v7 offset:2048
    ds_read_b128 v[64:67], v14 offset:0
    ds_read_b128 v[68:71], v14 offset:1024
    ds_read_b128 v[72:75], v14 offset:2048
    ds_read_b128 v[76:79], v14 offset:3072
    ds_read_b64_tr_b16 v[80:81], v7 offset:4096
    ds_read_b128 v[88:91], v14 offset:16384
    ds_read_b128 v[92:95], v14 offset:17408
    ds_read_b128 v[96:99], v14 offset:18432
    ds_read_b128 v[100:103], v14 offset:19456
    ds_read_b64_tr_b16 v[104:105], v7 offset:6144
    s_waitcnt lgkmcnt(10)
    v_pk_add_f32 v[16:17], v[16:17], v[20:21]
    v_pk_add_f32 v[24:25], v[24:25], v[28:29]
    v_pk_add_f32 v[18:19], v[18:19], v[22:23]
    v_pk_add_f32 v[26:27], v[26:27], v[30:31]
    v_pk_add_f32 v[40:41], v[40:41], v[44:45]
    v_pk_add_f32 v[48:49], v[48:49], v[52:53]
    v_pk_add_f32 v[42:43], v[42:43], v[46:47]
    v_pk_add_f32 v[50:51], v[50:51], v[54:55]
    v_pk_add_f32 v[16:17], v[16:17], v[24:25]
    v_pk_add_f32 v[18:19], v[18:19], v[26:27]
    v_pk_add_f32 v[40:41], v[40:41], v[48:49]
    v_pk_add_f32 v[42:43], v[42:43], v[50:51]
    v_cvt_pk_bf16_f32 v20, v16, v17
    v_cvt_pk_bf16_f32 v21, v18, v19
    v_cvt_pk_bf16_f32 v44, v40, v41
    v_cvt_pk_bf16_f32 v45, v42, v43
    v_lshlrev_b32 v16, 16, v20
    v_and_b32 v17, 0xffff0000, v20
    v_lshlrev_b32 v24, 16, v32
    v_and_b32 v25, 0xffff0000, v32
    v_lshlrev_b32 v18, 16, v21
    v_and_b32 v19, 0xffff0000, v21
    v_lshlrev_b32 v26, 16, v33
    v_and_b32 v27, 0xffff0000, v33
    v_lshlrev_b32 v40, 16, v44
    v_and_b32 v41, 0xffff0000, v44
    v_lshlrev_b32 v48, 16, v56
    v_and_b32 v49, 0xffff0000, v56
    v_lshlrev_b32 v42, 16, v45
    v_and_b32 v43, 0xffff0000, v45
    v_lshlrev_b32 v50, 16, v57
    v_and_b32 v51, 0xffff0000, v57
    v_pk_mul_f32 v[16:17], v[16:17], v[8:9] op_sel_hi:[1,0]
    v_pk_mul_f32 v[24:25], v[24:25], v[8:9] op_sel:[0,1] op_sel_hi:[1,1]
    v_pk_mul_f32 v[18:19], v[18:19], v[8:9] op_sel_hi:[1,0]
    v_pk_mul_f32 v[26:27], v[26:27], v[8:9] op_sel:[0,1] op_sel_hi:[1,1]
    v_pk_mul_f32 v[40:41], v[40:41], v[8:9] op_sel_hi:[1,0]
    v_pk_mul_f32 v[48:49], v[48:49], v[8:9] op_sel:[0,1] op_sel_hi:[1,1]
    v_pk_mul_f32 v[42:43], v[42:43], v[8:9] op_sel_hi:[1,0]
    v_pk_mul_f32 v[50:51], v[50:51], v[8:9] op_sel:[0,1] op_sel_hi:[1,1]
    v_cvt_pk_bf16_f32 v20, v16, v17
    v_cvt_pk_bf16_f32 v22, v24, v25
    v_cvt_pk_bf16_f32 v21, v18, v19
    v_cvt_pk_bf16_f32 v23, v26, v27
    v_cvt_pk_bf16_f32 v44, v40, v41
    v_cvt_pk_bf16_f32 v46, v48, v49
    v_cvt_pk_bf16_f32 v45, v42, v43
    v_cvt_pk_bf16_f32 v47, v50, v51
    v_lshlrev_b32 v16, 16, v20
    v_and_b32 v17, 0xffff0000, v20
    v_lshlrev_b32 v24, 16, v22
    v_and_b32 v25, 0xffff0000, v22
    v_lshlrev_b32 v18, 16, v21
    v_and_b32 v19, 0xffff0000, v21
    v_lshlrev_b32 v26, 16, v23
    v_and_b32 v27, 0xffff0000, v23
    v_lshlrev_b32 v40, 16, v44
    v_and_b32 v41, 0xffff0000, v44
    v_lshlrev_b32 v48, 16, v46
    v_and_b32 v49, 0xffff0000, v46
    v_lshlrev_b32 v42, 16, v45
    v_and_b32 v43, 0xffff0000, v45
    v_lshlrev_b32 v50, 16, v47
    v_and_b32 v51, 0xffff0000, v47
    v_pk_add_f32 v[16:17], v[16:17], v[24:25]
    v_pk_add_f32 v[18:19], v[18:19], v[26:27]
    v_pk_add_f32 v[40:41], v[40:41], v[48:49]
    v_pk_add_f32 v[42:43], v[42:43], v[50:51]
    v_cvt_pk_bf16_f32 v34, v16, v17
    v_cvt_pk_bf16_f32 v35, v18, v19
    v_cvt_pk_bf16_f32 v58, v40, v41
    v_cvt_pk_bf16_f32 v59, v42, v43
    ds_write_b64 v15, v[34:35] offset:0
    ds_write_b64 v15, v[58:59] offset:64
    s_waitcnt lgkmcnt(2)
    v_pk_add_f32 v[64:65], v[64:65], v[68:69]
    v_pk_add_f32 v[72:73], v[72:73], v[76:77]
    v_pk_add_f32 v[66:67], v[66:67], v[70:71]
    v_pk_add_f32 v[74:75], v[74:75], v[78:79]
    v_pk_add_f32 v[88:89], v[88:89], v[92:93]
    v_pk_add_f32 v[96:97], v[96:97], v[100:101]
    v_pk_add_f32 v[90:91], v[90:91], v[94:95]
    v_pk_add_f32 v[98:99], v[98:99], v[102:103]
    v_pk_add_f32 v[64:65], v[64:65], v[72:73]
    v_pk_add_f32 v[66:67], v[66:67], v[74:75]
    v_pk_add_f32 v[88:89], v[88:89], v[96:97]
    v_pk_add_f32 v[90:91], v[90:91], v[98:99]
    v_cvt_pk_bf16_f32 v68, v64, v65
    v_cvt_pk_bf16_f32 v69, v66, v67
    v_cvt_pk_bf16_f32 v92, v88, v89
    v_cvt_pk_bf16_f32 v93, v90, v91
    v_lshlrev_b32 v64, 16, v68
    v_and_b32 v65, 0xffff0000, v68
    v_lshlrev_b32 v72, 16, v80
    v_and_b32 v73, 0xffff0000, v80
    v_lshlrev_b32 v66, 16, v69
    v_and_b32 v67, 0xffff0000, v69
    v_lshlrev_b32 v74, 16, v81
    v_and_b32 v75, 0xffff0000, v81
    v_lshlrev_b32 v88, 16, v92
    v_and_b32 v89, 0xffff0000, v92
    v_lshlrev_b32 v96, 16, v104
    v_and_b32 v97, 0xffff0000, v104
    v_lshlrev_b32 v90, 16, v93
    v_and_b32 v91, 0xffff0000, v93
    v_lshlrev_b32 v98, 16, v105
    v_and_b32 v99, 0xffff0000, v105
    v_pk_mul_f32 v[64:65], v[64:65], v[8:9] op_sel_hi:[1,0]
    v_pk_mul_f32 v[72:73], v[72:73], v[8:9] op_sel:[0,1] op_sel_hi:[1,1]
    v_pk_mul_f32 v[66:67], v[66:67], v[8:9] op_sel_hi:[1,0]
    v_pk_mul_f32 v[74:75], v[74:75], v[8:9] op_sel:[0,1] op_sel_hi:[1,1]
    v_pk_mul_f32 v[88:89], v[88:89], v[8:9] op_sel_hi:[1,0]
    v_pk_mul_f32 v[96:97], v[96:97], v[8:9] op_sel:[0,1] op_sel_hi:[1,1]
    v_pk_mul_f32 v[90:91], v[90:91], v[8:9] op_sel_hi:[1,0]
    v_pk_mul_f32 v[98:99], v[98:99], v[8:9] op_sel:[0,1] op_sel_hi:[1,1]
    v_cvt_pk_bf16_f32 v68, v64, v65
    v_cvt_pk_bf16_f32 v70, v72, v73
    v_cvt_pk_bf16_f32 v69, v66, v67
    v_cvt_pk_bf16_f32 v71, v74, v75
    v_cvt_pk_bf16_f32 v92, v88, v89
    v_cvt_pk_bf16_f32 v94, v96, v97
    v_cvt_pk_bf16_f32 v93, v90, v91
    v_cvt_pk_bf16_f32 v95, v98, v99
    v_lshlrev_b32 v64, 16, v68
    v_and_b32 v65, 0xffff0000, v68
    v_lshlrev_b32 v72, 16, v70
    v_and_b32 v73, 0xffff0000, v70
    v_lshlrev_b32 v66, 16, v69
    v_and_b32 v67, 0xffff0000, v69
    v_lshlrev_b32 v74, 16, v71
    v_and_b32 v75, 0xffff0000, v71
    v_lshlrev_b32 v88, 16, v92
    v_and_b32 v89, 0xffff0000, v92
    v_lshlrev_b32 v96, 16, v94
    v_and_b32 v97, 0xffff0000, v94
    v_lshlrev_b32 v90, 16, v93
    v_and_b32 v91, 0xffff0000, v93
    v_lshlrev_b32 v98, 16, v95
    v_and_b32 v99, 0xffff0000, v95
    v_pk_add_f32 v[64:65], v[64:65], v[72:73]
    v_pk_add_f32 v[66:67], v[66:67], v[74:75]
    v_pk_add_f32 v[88:89], v[88:89], v[96:97]
    v_pk_add_f32 v[90:91], v[90:91], v[98:99]
    v_cvt_pk_bf16_f32 v82, v64, v65
    v_cvt_pk_bf16_f32 v83, v66, v67
    v_cvt_pk_bf16_f32 v106, v88, v89
    v_cvt_pk_bf16_f32 v107, v90, v91
    ds_write_b64 v15, v[82:83] offset:128
    ds_write_b64 v15, v[106:107] offset:192
    s_cmp_ge_u32 s3, 2
    s_cbranch_scc1 KM_S4
    ds_read_b128 v[112:115], v14 offset:32768
    ds_read_b128 v[116:119], v14 offset:33792
    ds_read_b128 v[120:123], v14 offset:34816
    ds_read_b128 v[124:127], v14 offset:35840
    ds_read_b64_tr_b16 v[128:129], v7 offset:8192
    s_waitcnt lgkmcnt(0)
    v_pk_add_f32 v[112:113], v[112:113], v[116:117]
    v_pk_add_f32 v[120:121], v[120:121], v[124:125]
    v_pk_add_f32 v[114:115], v[114:115], v[118:119]
    v_pk_add_f32 v[122:123], v[122:123], v[126:127]
    v_pk_add_f32 v[112:113], v[112:113], v[120:121]
    v_pk_add_f32 v[114:115], v[114:115], v[122:123]
    v_cvt_pk_bf16_f32 v116, v112, v113
    v_cvt_pk_bf16_f32 v117, v114, v115
    v_lshlrev_b32 v112, 16, v116
    v_and_b32 v113, 0xffff0000, v116
    v_lshlrev_b32 v120, 16, v128
    v_and_b32 v121, 0xffff0000, v128
    v_lshlrev_b32 v114, 16, v117
    v_and_b32 v115, 0xffff0000, v117
    v_lshlrev_b32 v122, 16, v129
    v_and_b32 v123, 0xffff0000, v129
    v_pk_mul_f32 v[112:113], v[112:113], v[8:9] op_sel_hi:[1,0]
    v_pk_mul_f32 v[120:121], v[120:121], v[8:9] op_sel:[0,1] op_sel_hi:[1,1]
    v_pk_mul_f32 v[114:115], v[114:115], v[8:9] op_sel_hi:[1,0]
    v_pk_mul_f32 v[122:123], v[122:123], v[8:9] op_sel:[0,1] op_sel_hi:[1,1]
    v_cvt_pk_bf16_f32 v116, v112, v113
    v_cvt_pk_bf16_f32 v118, v120, v121
    v_cvt_pk_bf16_f32 v117, v114, v115
    v_cvt_pk_bf16_f32 v119, v122, v123
    v_lshlrev_b32 v112, 16, v116
    v_and_b32 v113, 0xffff0000, v116
    v_lshlrev_b32 v120, 16, v118
    v_and_b32 v121, 0xffff0000, v118
    v_lshlrev_b32 v114, 16, v117
    v_and_b32 v115, 0xffff0000, v117
    v_lshlrev_b32 v122, 16, v119
    v_and_b32 v123, 0xffff0000, v119
    v_pk_add_f32 v[112:113], v[112:113], v[120:121]
    v_pk_add_f32 v[114:115], v[114:115], v[122:123]
    v_cvt_pk_bf16_f32 v130, v112, v113
    v_cvt_pk_bf16_f32 v131, v114, v115
    ds_write_b64 v15, v[130:131] offset:256
KM_S4:
    s_waitcnt lgkmcnt(0)
    s_barrier
    ds_read_b128 v[16:19], v228
    ds_read_b128 v[20:23], v229
    s_waitcnt lgkmcnt(1)
    buffer_store_dwordx4 v[16:19], v232, s[56:59], s8 offen
    s_waitcnt lgkmcnt(0)
    buffer_store_dwordx4 v[20:23], v233, s[56:59], s8 offen
    s_cmp_lg_u32 s3, 0
    s_cbranch_scc1 KM_FIN
    ds_read_b128 v[24:27], v230
    s_waitcnt lgkmcnt(0)
    buffer_store_dwordx4 v[24:27], v234, s[56:59], s8 offen

KM_FIN:
    s_endpgm
KM_EXIT:
    s_endpgm
.section .rodata,"a"
.p2align 6
.amdhsa_kernel k1_kernel
  .amdhsa_next_free_vgpr 256
  .amdhsa_next_free_sgpr 100
  .amdhsa_accum_offset 256
  .amdhsa_group_segment_fixed_size 0
  .amdhsa_kernarg_size 128
  .amdhsa_user_sgpr_count 2
  .amdhsa_user_sgpr_kernarg_segment_ptr 1
  .amdhsa_system_sgpr_workgroup_id_x 1
  .amdhsa_float_denorm_mode_32 3
  .amdhsa_float_denorm_mode_16_64 3
  .amdhsa_fp16_overflow 1
.end_amdhsa_kernel
.section .rodata,"a"
.p2align 6
.amdhsa_kernel km_kernel
  .amdhsa_next_free_vgpr 512
  .amdhsa_next_free_sgpr 102
  .amdhsa_accum_offset 256
  .amdhsa_group_segment_fixed_size 0
  .amdhsa_kernarg_size 128
  .amdhsa_user_sgpr_count 2
  .amdhsa_user_sgpr_kernarg_segment_ptr 1
  .amdhsa_system_sgpr_workgroup_id_x 1
  .amdhsa_float_denorm_mode_32 3
  .amdhsa_float_denorm_mode_16_64 3
  .amdhsa_fp16_overflow 1
.end_amdhsa_kernel
```
